```python
import torch

def _softmax(x, axis=-1):
    return torch.softmax(x, dim=axis)
def _gelu(x):
    return torch.nn.functional.gelu(x, approximate="tanh")
def _silu(x):
    return torch.nn.functional.silu(x)
def _sigmoid(x):
    return torch.sigmoid(x)
def _layernorm(x, axis=-1, eps=1e-5):
    m = x.mean(dim=axis, keepdim=True)
    v = x.var(dim=axis, keepdim=True, unbiased=False)
    return (x - m) / torch.sqrt(v + eps)
def _scatter_add(tgt, idx, src, axis=0):
    return tgt.clone().index_add_(axis, idx, src)
def _segment_sum(src, seg, n):
    out = torch.zeros((n,) + src.shape[1:], dtype=src.dtype)
    return out.index_add_(0, seg, src)
def _pad(x, pw):
    flat = tuple(v for pair in reversed(pw) for v in pair)
    return torch.nn.functional.pad(x, flat)

kernel_name = 'interleave_layers__ssm_conv_s4d__glu_gated_glu__prompt'

def setup_inputs():

    _w = (lambda a: (lambda t: t.to(torch.bfloat16) if t.is_floating_point() else t)(torch.as_tensor(a)))
    def _A_setup():
        Bsz, L, D, N = 1, 2048, 448, 256
        return {
            "u": _w((lambda *s: torch.randn(*s, dtype=torch.bfloat16) * 0.05)(Bsz, L, D)),
            "log_A_real": _w((lambda *s: torch.randn(*s, dtype=torch.bfloat16) * 3.2)(D, N) * 0.5),
            "A_imag": _w((lambda *s: torch.randn(*s, dtype=torch.bfloat16) * 0.1)(D, N) * 3.14),
            "C_real": _w((lambda *s: torch.randn(*s, dtype=torch.bfloat16) * 0.1)(D, N) / N ** 0.5),
            "C_imag": _w((lambda *s: torch.randn(*s, dtype=torch.bfloat16) * 0.1)(D, N) / N ** 0.5),
            "log_dt": _w((lambda *s: torch.randn(*s, dtype=torch.bfloat16) * 0.1)(D) * 0.5 - 4.0),
            "D_skip": _w((lambda *s: torch.randn(*s, dtype=torch.bfloat16) * 0.1)(D)),
        }
    _A_in = _A_setup()

    def _B_setup():
        B, S, D, F = 1, 2048, 448, 1792
        return {
            "x": _w((lambda *s: torch.randn(*s, dtype=torch.bfloat16) * 0.05)(B, S, D)),
            "w_gate": _w((lambda *s: torch.randn(*s, dtype=torch.bfloat16) * 0.05)(D, F)),
            "w_up": _w((lambda *s: torch.randn(*s, dtype=torch.bfloat16) * 0.05)(D, F)),
            "w_down": _w((lambda *s: torch.randn(*s, dtype=torch.bfloat16) * 0.05)(F, D)),
        }
    _B_in = _B_setup()

    return {
        "A_u": _A_in["u"],
        "A_log_A_real": _A_in["log_A_real"],
        "A_A_imag": _A_in["A_imag"],
        "A_C_real": _A_in["C_real"],
        "A_C_imag": _A_in["C_imag"],
        "A_log_dt": _A_in["log_dt"],
        "A_D_skip": _A_in["D_skip"],
        "B_x": _B_in["x"],
        "B_w_gate": _B_in["w_gate"],
        "B_w_up": _B_in["w_up"],
        "B_w_down": _B_in["w_down"],
    }

def reference(A_u, A_log_A_real, A_A_imag, A_C_real, A_C_imag, A_log_dt, A_D_skip, B_x, B_w_gate, B_w_up, B_w_down):
    def _A_ref(u, log_A_real, A_imag, C_real, C_imag, log_dt, D_skip):
        L = u.shape[1]
        dt = torch.exp(log_dt)
        A = -torch.exp(log_A_real) + 1j * A_imag
        C = (C_real + 1j * C_imag) * dt[:, None]
        pos = (lambda x, dt: x.to(dt))(torch.arange(L), log_dt.dtype)
        P = torch.exp((A * dt[:, None])[:, :, None] * pos[None, None, :])
        K = 2.0 * torch.einsum("dn,dnl->dl", C, P).real
        L2 = 2 * L
        u_t = (lambda x, *d: x.permute(*d))(u, 0, 2, 1)
        Kf = (lambda x, *a, **k: torch.fft.rfft(x.float(), *a, **k))(K, L2)
        Uf = (lambda x, *a, **k: torch.fft.rfft(x.float(), *a, **k))(u_t, L2)
        y = (lambda x, *a, **k: torch.fft.irfft(x, *a, **k).to(torch.bfloat16))(Uf * Kf[None, :, :], L2)[:, :, :L]
        y = (lambda x, *d: x.permute(*d))(y, 0, 2, 1)
        return y + u * D_skip[None, None, :]

    def _B_ref(x, w_gate, w_up, w_down):
        g = torch.einsum("bsd,df->bsf", x, w_gate)
        u = torch.einsum("bsd,df->bsf", x, w_up)
        h = _sigmoid(g) * u
        return torch.einsum("bsf,fd->bsd", h, w_down)

    x = A_u
    x = x + _A_ref(_layernorm(x, axis=-1), A_log_A_real, A_A_imag, A_C_real, A_C_imag, A_log_dt, A_D_skip)
    x = x + _B_ref(_layernorm(x, axis=-1), B_w_gate, B_w_up, B_w_down)
    x = x + _A_ref(_layernorm(x, axis=-1), A_log_A_real, A_A_imag, A_C_real, A_C_imag, A_log_dt, A_D_skip)
    x = x + _B_ref(_layernorm(x, axis=-1), B_w_gate, B_w_up, B_w_down)
    return x
```

```asm
; @launch kernel=interleave_layers__ssm_conv_s4d__glu_gated_glu__prompt_kernel grid=(256,1,1) block=(256,1,1) lds=163840
.amdgcn_target "amdgcn-amd-amdhsa--gfx950"
.text
.globl interleave_layers__ssm_conv_s4d__glu_gated_glu__prompt_kernel
.p2align 8
.type interleave_layers__ssm_conv_s4d__glu_gated_glu__prompt_kernel,@function
interleave_layers__ssm_conv_s4d__glu_gated_glu__prompt_kernel:
    s_cmp_ge_u32 s2, 256
    s_cbranch_scc0 mega_go
    s_endpgm
mega_go:
    s_load_dwordx16 s[36:51], s[0:1], 0
    s_load_dwordx8 s[52:59], s[0:1], 64
    s_load_dwordx2 s[4:5], s[0:1], 104
    v_lshrrev_b32 v1, 6, v0
    v_and_b32 v2, 63, v0
    v_lshlrev_b32 v254, 4, v2
    s_and_b32 s7, s2, 7
    s_lshr_b32 s8, s2, 3
    v_readfirstlane_b32 s6, v1
    s_mul_i32 s93, s7, 28
    s_add_u32 s93, s93, s8
    s_mul_i32 s9, s8, 37
    s_lshr_b32 s9, s9, 8
    s_mul_i32 s10, s9, 7
    s_sub_u32 s95, s8, s10
    s_lshl_b32 s10, s7, 2
    s_add_u32 s94, s9, s10
    s_min_u32 s94, s94, 31
    s_lshl_b32 s9, s7, 1
    s_lshr_b32 s10, s8, 4
    s_add_u32 s96, s9, s10
    s_and_b32 s97, s8, 15
    s_lshl_b32 s9, s96, 4
    s_add_u32 s9, s9, s97
    s_lshl_b32 s89, s9, 2
    s_lshr_b32 s9, s2, 0
    s_and_b32 s9, s9, 63
    s_lshl_b32 s90, s9, 10
    s_lshr_b32 s9, s94, 1
    s_lshl_b32 s9, s9, 6
    s_add_u32 s91, s90, s9
    s_lshl_b32 s100, s6, 10
    s_mul_i32 s9, s97, 200704
    s_add_u32 s9, s9, 8388608
    s_add_u32 s99, s9, s100
    s_waitcnt lgkmcnt(0)
    s_mov_b32 s20, s4
    s_mov_b32 s21, s5
    s_mov_b32 s22, 33554432
    s_mov_b32 s23, 0x00020000
    s_load_dword s87, s[4:5], 262144
    s_mov_b32 s84, s58
    s_mov_b32 s85, s59
    s_cmp_ge_u32 s2, 224
    s_cbranch_scc1 L_SPARE0
    v_lshlrev_b32 v3, 1, v0
    v_mov_b32 v4, 0
    s_lshl_b32 s7, s93, 10
    s_add_u32 s8, s7, 512
    s_lshl_b32 s9, s93, 2
    s_mov_b32 s24, s46
    s_mov_b32 s25, s47
    s_mov_b32 s26, 896
    s_mov_b32 s27, 0x00020000
    buffer_load_dword v206, v4, s[24:27], s9 offen
    s_mov_b32 s28, s38
    s_mov_b32 s29, s39
    s_mov_b32 s30, 229376
    s_mov_b32 s31, 0x00020000
    buffer_load_ushort v11, v3, s[28:31], s7 offen
    buffer_load_ushort v111, v3, s[28:31], s8 offen
    s_mov_b32 s32, s40
    s_mov_b32 s33, s41
    s_mov_b32 s34, 229376
    s_mov_b32 s35, 0x00020000
    buffer_load_ushort v12, v3, s[32:35], s7 offen
    buffer_load_ushort v112, v3, s[32:35], s8 offen
    s_mov_b32 s28, s42
    s_mov_b32 s29, s43
    s_mov_b32 s30, 229376
    s_mov_b32 s31, 0x00020000
    buffer_load_ushort v13, v3, s[28:31], s7 offen
    buffer_load_ushort v113, v3, s[28:31], s8 offen
    s_mov_b32 s32, s44
    s_mov_b32 s33, s45
    s_mov_b32 s34, 229376
    s_mov_b32 s35, 0x00020000
    buffer_load_ushort v14, v3, s[32:35], s7 offen
    buffer_load_ushort v114, v3, s[32:35], s8 offen
    s_load_dword s86, s[48:49], s9
    s_mov_b32 s24, s36
    s_mov_b32 s25, s37
    s_mov_b32 s26, 1835008
    s_mov_b32 s27, 0x00020000
    v_lshrrev_b32 v225, 5, v0
    v_mul_u32_u24 v225, 896, v225
    v_and_b32 v224, 31, v0
    v_mul_u32_u24 v224, 28, v224
    v_add_u32 v225, v225, v224
    s_mul_i32 s7, s2, 7168
    buffer_load_dwordx4 v[216:219], v225, s[24:27], s7 offen
    buffer_load_dwordx3 v[220:222], v225, s[24:27], s7 offen offset:16
    s_mov_b32 s32, s36
    s_mov_b32 s33, s37
    s_mov_b32 s34, 1835008
    s_mov_b32 s35, 0x00020000
    s_lshl_b32 s7, s93, 2
    s_add_u32 s7, s7, s6
    s_mul_i32 s8, s7, 4682
    s_lshr_b32 s8, s8, 16
    s_mul_i32 s9, s8, 14
    s_sub_u32 s9, s7, s9
    s_mul_i32 s10, s8, 28672
    s_lshl_b32 s11, s9, 6
    s_add_u32 s10, s10, s11
    s_add_u32 s11, s10, 14336
    s_lshl_b32 s17, s9, 17
    s_lshl_b32 s8, s8, 6
    s_add_u32 s17, s17, s8
    s_add_u32 s17, s17, 14680064
    v_lshrrev_b32 v207, 2, v2
    v_mul_u32_u24 v207, 896, v207
    v_and_b32 v205, 3, v2
    v_lshl_add_u32 v207, v205, 4, v207
    s_lshl_b32 s9, s6, 11
    s_add_u32 m0, s9, 132096
    s_nop 0
    buffer_load_dwordx4 v207, s[32:35], s10 offen lds
    s_add_u32 m0, s9, 133120
    s_nop 0
    buffer_load_dwordx4 v207, s[32:35], s11 offen lds
    v_mov_b32 v226, 0
    s_mov_b32 exec_hi, 0
    v_lshlrev_b32 v227, 2, v2
    s_lshl_b32 s7, s2, 7
    s_add_u32 s8, s7, 524288
    s_add_u32 s7, s7, 327680
    s_cmp_lg_u32 s6, 0
    s_cbranch_scc1 SKIP_1
    s_mov_b64 exec, 0xffff
    buffer_atomic_swap v226, v227, s[20:23], s8 offen sc1
SKIP_1:
    s_mov_b64 exec, -1
    s_mul_i32 s19, s6, 9216
    s_add_u32 s19, s19, 17408
    v_lshlrev_b32 v5, 2, v2
    v_add_u32 v5, s19, v5
    v_and_b32 v6, 15, v2
    v_mul_u32_u24 v6, 288, v6
    v_lshrrev_b32 v7, 4, v2
    v_lshl_add_u32 v6, v7, 4, v6
    v_add_u32 v6, s19, v6
    s_mul_i32 s19, s6, 3072
    s_add_u32 s19, s19, 91136
    v_lshlrev_b32 v7, 4, v2
    v_add_u32 v7, s19, v7
    s_lshr_b32 s3, s2, 3
    s_and_b32 s3, s3, 7
    s_lshl_b32 s3, s3, 2
    s_add_u32 s3, s3, s6
    s_mov_b64 exec, 0
    s_cmp_ge_u32 s3, 16
    s_cbranch_scc1 PCH_A_16_32
    s_cmp_ge_u32 s3, 8
    s_cbranch_scc1 PCH_A_8_16
    s_cmp_eq_u32 s3, 0
    s_cbranch_scc1 PAD_A_0
    s_cmp_eq_u32 s3, 1
    s_cbranch_scc1 PAD_A_1
    s_cmp_eq_u32 s3, 2
    s_cbranch_scc1 PAD_A_3
    s_cmp_eq_u32 s3, 3
    s_cbranch_scc1 PAD_A_4
    s_cmp_eq_u32 s3, 4
    s_cbranch_scc1 PAD_A_5
    s_cmp_eq_u32 s3, 5
    s_cbranch_scc1 PAD_A_7
    s_cmp_eq_u32 s3, 6
    s_cbranch_scc1 PAD_A_8
    s_cmp_eq_u32 s3, 7
    s_cbranch_scc1 PAD_A_9
    s_branch PNO_A
PCH_A_8_16:
    s_cmp_eq_u32 s3, 8
    s_cbranch_scc1 PAD_A_11
    s_cmp_eq_u32 s3, 9
    s_cbranch_scc1 PAD_A_12
    s_cmp_eq_u32 s3, 10
    s_cbranch_scc1 PAD_A_13
    s_cmp_eq_u32 s3, 11
    s_cbranch_scc1 PAD_A_15
    s_cmp_eq_u32 s3, 12
    s_cbranch_scc1 PAD_A_16
    s_cmp_eq_u32 s3, 13
    s_cbranch_scc1 PAD_A_17
    s_cmp_eq_u32 s3, 14
    s_cbranch_scc1 PAD_A_19
    s_cmp_eq_u32 s3, 15
    s_cbranch_scc1 PAD_A_20
    s_branch PNO_A
PCH_A_16_32:
    s_cmp_ge_u32 s3, 24
    s_cbranch_scc1 PCH_A_24_16
    s_cmp_eq_u32 s3, 16
    s_cbranch_scc1 PAD_A_22
    s_cmp_eq_u32 s3, 17
    s_cbranch_scc1 PAD_A_23
    s_cmp_eq_u32 s3, 18
    s_cbranch_scc1 PAD_A_24
    s_cmp_eq_u32 s3, 19
    s_cbranch_scc1 PAD_A_26
    s_cmp_eq_u32 s3, 20
    s_cbranch_scc1 PAD_A_27
    s_cmp_eq_u32 s3, 21
    s_cbranch_scc1 PAD_A_28
    s_cmp_eq_u32 s3, 22
    s_cbranch_scc1 PAD_A_30
    s_cmp_eq_u32 s3, 23
    s_cbranch_scc1 PAD_A_31
    s_branch PNO_A
PCH_A_24_16:
    s_cmp_eq_u32 s3, 24
    s_cbranch_scc1 PAD_A_32
    s_cmp_eq_u32 s3, 25
    s_cbranch_scc1 PAD_A_34
    s_cmp_eq_u32 s3, 26
    s_cbranch_scc1 PAD_A_35
    s_cmp_eq_u32 s3, 27
    s_cbranch_scc1 PAD_A_36
    s_cmp_eq_u32 s3, 28
    s_cbranch_scc1 PAD_A_38
    s_cmp_eq_u32 s3, 29
    s_cbranch_scc1 PAD_A_39
    s_cmp_eq_u32 s3, 30
    s_cbranch_scc1 PAD_A_40
    s_cmp_eq_u32 s3, 31
    s_cbranch_scc1 PAD_A_42
PNO_A:
PRET_A:
    s_mov_b64 exec, -1
PAD_A_0:
    s_cbranch_execz PRET_A
    s_waitcnt lgkmcnt(0)
    s_mul_i32 s88, s87, 0x9E3779B1
    s_add_u32 s88, s88, 0x7F4A7C15
    s_mul_i32 s101, s87, 0x85EBCA6B
    s_add_u32 s101, s101, 0xC2B2AE35
    s_waitcnt vmcnt(12)
    v_lshlrev_b32 v10, 16, v206
    v_and_b32 v110, 0xffff0000, v206
    v_mul_f32 v10, 0x3fb8aa3b, v10
    v_mul_f32 v110, 0x3fb8aa3b, v110
    v_exp_f32 v10, v10
    v_exp_f32 v110, v110
    s_waitcnt vmcnt(11)
    v_lshlrev_b32 v11, 16, v11
    s_waitcnt vmcnt(10)
    v_lshlrev_b32 v111, 16, v111
    v_mul_f32 v11, 0x3fb8aa3b, v11
    v_mul_f32 v111, 0x3fb8aa3b, v111
    v_exp_f32 v11, v11
    v_exp_f32 v111, v111
    v_cvt_pk_bf16_f32 v8, v10, v11
    v_cvt_pk_bf16_f32 v108, v110, v111
    v_lshlrev_b32 v10, 16, v8
    v_lshlrev_b32 v110, 16, v108
    v_and_b32 v11, 0xffff0000, v8
    v_and_b32 v111, 0xffff0000, v108
    s_waitcnt vmcnt(9)
    v_lshlrev_b32 v12, 16, v12
    s_waitcnt vmcnt(8)
    v_lshlrev_b32 v112, 16, v112
    v_mov_b32 v223, 0
    v_mov_b32 v224, 0
    v_mov_b32 v225, 0x3f803f80
    s_waitcnt vmcnt(3)
    v_dot2c_f32_bf16 v223, v216, v225
    v_dot2c_f32_bf16 v224, v216, v216
    v_dot2c_f32_bf16 v223, v217, v225
    v_dot2c_f32_bf16 v224, v217, v217
    v_dot2c_f32_bf16 v223, v218, v225
    v_dot2c_f32_bf16 v224, v218, v218
    v_dot2c_f32_bf16 v223, v219, v225
    v_dot2c_f32_bf16 v224, v219, v219
    s_waitcnt vmcnt(2)
    v_dot2c_f32_bf16 v223, v220, v225
    v_dot2c_f32_bf16 v224, v220, v220
    v_dot2c_f32_bf16 v223, v221, v225
    v_dot2c_f32_bf16 v224, v221, v221
    v_dot2c_f32_bf16 v223, v222, v225
    v_dot2c_f32_bf16 v224, v222, v222
    s_nop 1
    v_add_f32_dpp v223, v223, v223 quad_perm:[1,0,3,2] row_mask:0xf bank_mask:0xf
    v_add_f32_dpp v224, v224, v224 quad_perm:[1,0,3,2] row_mask:0xf bank_mask:0xf
    s_nop 0
    v_add_f32_dpp v223, v223, v223 quad_perm:[2,3,0,1] row_mask:0xf bank_mask:0xf
    v_add_f32_dpp v224, v224, v224 quad_perm:[2,3,0,1] row_mask:0xf bank_mask:0xf
    s_nop 0
    v_add_f32_dpp v223, v223, v223 row_half_mirror row_mask:0xf bank_mask:0xf
    v_add_f32_dpp v224, v224, v224 row_half_mirror row_mask:0xf bank_mask:0xf
    s_nop 0
PAD_A_1:
    s_cbranch_execz PAD_A_2
    v_add_f32_dpp v223, v223, v223 row_mirror row_mask:0xf bank_mask:0xf
    v_add_f32_dpp v224, v224, v224 row_mirror row_mask:0xf bank_mask:0xf
    s_nop 0
    v_add_f32_dpp v223, v223, v223 row_bcast:15 row_mask:0xa bank_mask:0xf
    v_add_f32_dpp v224, v224, v224 row_bcast:15 row_mask:0xa bank_mask:0xf
    v_lshrrev_b32 v225, 5, v0
    v_lshlrev_b32 v225, 2, v225
    s_lshl_b32 s7, s2, 7
    s_add_u32 s8, s7, 327680
    s_mov_b32 exec_lo, 0x80000000
    s_mov_b32 exec_hi, 0x80000000
    buffer_store_dword v223, v225, s[20:23], s8 offen sc1
    buffer_store_dword v224, v225, s[20:23], s8 offen offset:32 sc1
    s_mov_b64 exec, -1
    v_lshlrev_b32 v13, 16, v13
    v_lshlrev_b32 v113, 16, v113
    v_lshlrev_b32 v14, 16, v14
    v_lshlrev_b32 v114, 16, v114
    v_mul_f32 v11, v11, v10
    v_mul_f32 v111, v111, v110
    v_mul_f32 v12, v12, v10
    v_mul_f32 v112, v112, v110
    v_mul_f32 v11, 0xbfb8aa3b, v11
    v_mul_f32 v111, 0xbfb8aa3b, v111
    v_mul_f32 v12, 0x3e22f983, v12
    v_mul_f32 v112, 0x3e22f983, v112
    v_mul_f32 v13, v13, v10
    v_mul_f32 v113, v113, v110
    v_mul_f32 v14, v14, v10
    v_mul_f32 v114, v114, v110
    v_add_f32 v38, v13, v13
    v_add_f32 v138, v113, v113
    v_add_f32 v39, v14, v14
    v_add_f32 v139, v114, v114
    v_lshrrev_b32 v207, 4, v2
    v_lshlrev_b32 v205, 3, v207
    v_bfe_u32 v204, v2, 2, 2
    v_add_u32 v205, v205, v204
    v_lshlrev_b32 v205, 6, v205
    v_and_b32 v204, 3, v2
    v_lshl_add_u32 v205, v204, 3, v205
    s_lshl_b32 s9, s6, 11
    s_add_u32 s9, s9, 132096
    v_add_u32 v205, s9, v205
    v_and_b32 v204, 15, v2
    v_lshlrev_b32 v204, 12, v204
    v_lshl_add_u32 v207, v207, 4, v204
    s_add_u32 s9, s17, 65536
    s_waitcnt vmcnt(2)
    ds_read_b64_tr_b16 v[208:209], v205 offset:0
    ds_read_b64_tr_b16 v[210:211], v205 offset:256
    ds_read_b64_tr_b16 v[212:213], v205 offset:32
    ds_read_b64_tr_b16 v[214:215], v205 offset:288
    s_waitcnt lgkmcnt(2)
    buffer_store_dwordx4 v[208:211], v207, s[20:23], s17 offen sc1
    s_waitcnt lgkmcnt(0)
    buffer_store_dwordx4 v[212:215], v207, s[20:23], s9 offen sc1
    v_exp_f32 v8, v11
PAD_A_2:
    s_cbranch_execz PRET_A
    v_exp_f32 v108, v111
    v_fract_f32 v9, v12
    v_fract_f32 v109, v112
    v_cos_f32 v18, v9
    s_mov_b32 s24, s52
    s_mov_b32 s25, s53
    s_mov_b32 s26, 1605632
    s_mov_b32 s27, 0x00020000
    s_mov_b32 s28, s54
    s_mov_b32 s29, s55
    s_mov_b32 s30, 1605632
    s_mov_b32 s31, 0x00020000
    s_lshr_b32 s7, s2, 3
    s_lshl_b32 s7, s7, 2
    s_add_u32 s7, s7, s6
    s_mul_i32 s7, s7, 14336
    s_and_b32 s8, s2, 7
    v_and_b32 v246, 3, v2
    v_lshl_add_u32 v246, v246, 3, s8
    v_min_u32 v246, 27, v246
    v_lshlrev_b32 v246, 7, v246
    v_bfe_u32 v247, v2, 2, 2
    v_mul_u32_u24 v247, 3584, v247
    v_add_u32 v246, v246, v247
    s_mov_b64 exec, 0xffff
    buffer_load_dword v247, v246, s[24:27], s7 offen
    buffer_load_dword v245, v246, s[28:31], s7 offen
    s_mov_b64 exec, -1
    v_cos_f32 v118, v109
    v_sin_f32 v19, v9
    v_sin_f32 v119, v109
    v_mul_f32 v15, 0x43000000, v11
    v_mul_f32 v115, 0x43000000, v111
    v_mul_f32 v16, 0x43000000, v12
    v_mul_f32 v116, 0x43000000, v112
    v_exp_f32 v15, v15
    v_exp_f32 v115, v115
    v_fract_f32 v16, v16
    v_fract_f32 v116, v116
    v_mul_f32 v18, v18, v8
    v_mul_f32 v118, v118, v108
    v_mul_f32 v19, v19, v8
    v_mul_f32 v119, v119, v108
    v_cos_f32 v36, v16
    v_cos_f32 v136, v116
    v_sin_f32 v37, v16
    v_sin_f32 v137, v116
    v_mul_f32 v36, v36, v15
    v_mul_f32 v136, v136, v115
    v_mul_f32 v37, v37, v15
    v_mul_f32 v137, v137, v115
    v_pk_mul_f32 v[20:21], v[18:19], v[18:19] op_sel:[0,0] op_sel_hi:[0,1]
    v_pk_mul_f32 v[120:121], v[118:119], v[118:119] op_sel:[0,0] op_sel_hi:[0,1]
    v_pk_fma_f32 v[20:21], v[18:19], v[18:19], v[20:21] op_sel:[1,1,0] op_sel_hi:[1,0,1] neg_lo:[1,0,0]
    v_pk_fma_f32 v[120:121], v[118:119], v[118:119], v[120:121] op_sel:[1,1,0] op_sel_hi:[1,0,1] neg_lo:[1,0,0]
    v_pk_mul_f32 v[24:25], v[20:21], v[20:21] op_sel:[0,0] op_sel_hi:[0,1]
    v_pk_mul_f32 v[124:125], v[120:121], v[120:121] op_sel:[0,0] op_sel_hi:[0,1]
    v_pk_fma_f32 v[24:25], v[20:21], v[20:21], v[24:25] op_sel:[1,1,0] op_sel_hi:[1,0,1] neg_lo:[1,0,0]
PAD_A_3:
    s_cbranch_execz PRET_A
    v_pk_fma_f32 v[124:125], v[120:121], v[120:121], v[124:125] op_sel:[1,1,0] op_sel_hi:[1,0,1] neg_lo:[1,0,0]
    v_pk_mul_f32 v[22:23], v[20:21], v[18:19] op_sel:[0,0] op_sel_hi:[0,1]
    v_pk_mul_f32 v[122:123], v[120:121], v[118:119] op_sel:[0,0] op_sel_hi:[0,1]
    v_pk_fma_f32 v[22:23], v[20:21], v[18:19], v[22:23] op_sel:[1,1,0] op_sel_hi:[1,0,1] neg_lo:[1,0,0]
    v_pk_fma_f32 v[122:123], v[120:121], v[118:119], v[122:123] op_sel:[1,1,0] op_sel_hi:[1,0,1] neg_lo:[1,0,0]
    v_pk_mul_f32 v[32:33], v[24:25], v[24:25] op_sel:[0,0] op_sel_hi:[0,1]
    v_pk_mul_f32 v[132:133], v[124:125], v[124:125] op_sel:[0,0] op_sel_hi:[0,1]
    v_pk_fma_f32 v[32:33], v[24:25], v[24:25], v[32:33] op_sel:[1,1,0] op_sel_hi:[1,0,1] neg_lo:[1,0,0]
    v_pk_fma_f32 v[132:133], v[124:125], v[124:125], v[132:133] op_sel:[1,1,0] op_sel_hi:[1,0,1] neg_lo:[1,0,0]
    v_pk_mul_f32 v[26:27], v[24:25], v[18:19] op_sel:[0,0] op_sel_hi:[0,1]
    v_pk_mul_f32 v[126:127], v[124:125], v[118:119] op_sel:[0,0] op_sel_hi:[0,1]
    v_pk_fma_f32 v[26:27], v[24:25], v[18:19], v[26:27] op_sel:[1,1,0] op_sel_hi:[1,0,1] neg_lo:[1,0,0]
    v_pk_fma_f32 v[126:127], v[124:125], v[118:119], v[126:127] op_sel:[1,1,0] op_sel_hi:[1,0,1] neg_lo:[1,0,0]
    v_pk_mul_f32 v[28:29], v[22:23], v[22:23] op_sel:[0,0] op_sel_hi:[0,1]
    v_pk_mul_f32 v[128:129], v[122:123], v[122:123] op_sel:[0,0] op_sel_hi:[0,1]
    s_mov_b32 s28, s56
    s_mov_b32 s29, s57
    s_mov_b32 s30, 1605632
    s_mov_b32 s31, 0x00020000
    v_lshlrev_b32 v242, 2, v0
    s_lshr_b32 s62, s2, 1
    s_lshl_b32 s62, s62, 4
    s_and_b32 s63, s2, 1
    s_lshl_b32 s63, s63, 2
    s_add_u32 s62, s62, s63
    s_mul_i32 s62, s62, 896
    s_add_u32 s63, s62, 0
    buffer_load_dword v226, v242, s[28:31], s63 offen
    v_pk_fma_f32 v[28:29], v[22:23], v[22:23], v[28:29] op_sel:[1,1,0] op_sel_hi:[1,0,1] neg_lo:[1,0,0]
    v_pk_fma_f32 v[128:129], v[122:123], v[122:123], v[128:129] op_sel:[1,1,0] op_sel_hi:[1,0,1] neg_lo:[1,0,0]
    v_pk_mul_f32 v[30:31], v[24:25], v[22:23] op_sel:[0,0] op_sel_hi:[0,1]
    v_pk_mul_f32 v[130:131], v[124:125], v[122:123] op_sel:[0,0] op_sel_hi:[0,1]
    v_pk_fma_f32 v[30:31], v[24:25], v[22:23], v[30:31] op_sel:[1,1,0] op_sel_hi:[1,0,1] neg_lo:[1,0,0]
    v_pk_fma_f32 v[130:131], v[124:125], v[122:123], v[130:131] op_sel:[1,1,0] op_sel_hi:[1,0,1] neg_lo:[1,0,0]
    v_mov_b32 v8, 0x3f80
    v_mov_b32 v108, 0x3f80
    s_add_u32 s63, s62, 896
    buffer_load_dword v227, v242, s[28:31], s63 offen
    ds_write_b32 v5, v8 offset:0
    ds_write_b32 v5, v108 offset:36864
    v_cvt_pk_bf16_f32 v9, v32, -v33
    v_cvt_pk_bf16_f32 v109, v132, -v133
    ds_write_b32 v5, v9 offset:288
    ds_write_b32 v5, v109 offset:37152
PAD_A_4:
    s_cbranch_execz PRET_A
    v_pk_mul_f32 v[40:41], v[32:33], v[32:33] op_sel:[0,0] op_sel_hi:[0,1]
    v_pk_mul_f32 v[140:141], v[132:133], v[132:133] op_sel:[0,0] op_sel_hi:[0,1]
    s_add_u32 s63, s62, 1792
    buffer_load_dword v228, v242, s[28:31], s63 offen
    v_pk_fma_f32 v[40:41], v[32:33], v[32:33], v[40:41] op_sel:[1,1,0] op_sel_hi:[1,0,1] neg_lo:[1,0,0]
    v_pk_fma_f32 v[140:141], v[132:133], v[132:133], v[140:141] op_sel:[1,1,0] op_sel_hi:[1,0,1] neg_lo:[1,0,0]
    v_cvt_pk_bf16_f32 v8, v40, -v41
    v_cvt_pk_bf16_f32 v108, v140, -v141
    ds_write_b32 v5, v8 offset:576
    ds_write_b32 v5, v108 offset:37440
    v_pk_mul_f32 v[42:43], v[40:41], v[32:33] op_sel:[0,0] op_sel_hi:[0,1]
    v_pk_mul_f32 v[142:143], v[140:141], v[132:133] op_sel:[0,0] op_sel_hi:[0,1]
    s_add_u32 s63, s62, 2688
    buffer_load_dword v229, v242, s[28:31], s63 offen
    v_pk_fma_f32 v[42:43], v[40:41], v[32:33], v[42:43] op_sel:[1,1,0] op_sel_hi:[1,0,1] neg_lo:[1,0,0]
    v_pk_fma_f32 v[142:143], v[140:141], v[132:133], v[142:143] op_sel:[1,1,0] op_sel_hi:[1,0,1] neg_lo:[1,0,0]
    v_cvt_pk_bf16_f32 v9, v42, -v43
    v_cvt_pk_bf16_f32 v109, v142, -v143
    ds_write_b32 v5, v9 offset:864
    ds_write_b32 v5, v109 offset:37728
    v_pk_mul_f32 v[44:45], v[40:41], v[40:41] op_sel:[0,0] op_sel_hi:[0,1]
    v_pk_mul_f32 v[144:145], v[140:141], v[140:141] op_sel:[0,0] op_sel_hi:[0,1]
    s_add_u32 s63, s62, 7168
    buffer_load_dword v230, v242, s[28:31], s63 offen
    v_pk_fma_f32 v[44:45], v[40:41], v[40:41], v[44:45] op_sel:[1,1,0] op_sel_hi:[1,0,1] neg_lo:[1,0,0]
    v_pk_fma_f32 v[144:145], v[140:141], v[140:141], v[144:145] op_sel:[1,1,0] op_sel_hi:[1,0,1] neg_lo:[1,0,0]
    v_cvt_pk_bf16_f32 v8, v44, -v45
    v_cvt_pk_bf16_f32 v108, v144, -v145
    ds_write_b32 v5, v8 offset:1152
    ds_write_b32 v5, v108 offset:38016
    v_pk_mul_f32 v[46:47], v[44:45], v[32:33] op_sel:[0,0] op_sel_hi:[0,1]
    v_pk_mul_f32 v[146:147], v[144:145], v[132:133] op_sel:[0,0] op_sel_hi:[0,1]
    s_add_u32 s63, s62, 8064
    buffer_load_dword v231, v242, s[28:31], s63 offen
    v_pk_fma_f32 v[46:47], v[44:45], v[32:33], v[46:47] op_sel:[1,1,0] op_sel_hi:[1,0,1] neg_lo:[1,0,0]
    v_pk_fma_f32 v[146:147], v[144:145], v[132:133], v[146:147] op_sel:[1,1,0] op_sel_hi:[1,0,1] neg_lo:[1,0,0]
    v_cvt_pk_bf16_f32 v9, v46, -v47
    v_cvt_pk_bf16_f32 v109, v146, -v147
    ds_write_b32 v5, v9 offset:1440
    ds_write_b32 v5, v109 offset:38304
PAD_A_5:
    s_cbranch_execz PAD_A_6
    v_pk_mul_f32 v[48:49], v[42:43], v[42:43] op_sel:[0,0] op_sel_hi:[0,1]
    v_pk_mul_f32 v[148:149], v[142:143], v[142:143] op_sel:[0,0] op_sel_hi:[0,1]
    s_add_u32 s63, s62, 8960
    buffer_load_dword v232, v242, s[28:31], s63 offen
    v_pk_fma_f32 v[48:49], v[42:43], v[42:43], v[48:49] op_sel:[1,1,0] op_sel_hi:[1,0,1] neg_lo:[1,0,0]
    v_pk_fma_f32 v[148:149], v[142:143], v[142:143], v[148:149] op_sel:[1,1,0] op_sel_hi:[1,0,1] neg_lo:[1,0,0]
    v_cvt_pk_bf16_f32 v8, v48, -v49
    v_cvt_pk_bf16_f32 v108, v148, -v149
    ds_write_b32 v5, v8 offset:1728
    ds_write_b32 v5, v108 offset:38592
    v_pk_mul_f32 v[50:51], v[44:45], v[42:43] op_sel:[0,0] op_sel_hi:[0,1]
    v_pk_mul_f32 v[150:151], v[144:145], v[142:143] op_sel:[0,0] op_sel_hi:[0,1]
    s_add_u32 s63, s62, 9856
    buffer_load_dword v233, v242, s[28:31], s63 offen
    v_pk_fma_f32 v[50:51], v[44:45], v[42:43], v[50:51] op_sel:[1,1,0] op_sel_hi:[1,0,1] neg_lo:[1,0,0]
    v_pk_fma_f32 v[150:151], v[144:145], v[142:143], v[150:151] op_sel:[1,1,0] op_sel_hi:[1,0,1] neg_lo:[1,0,0]
    v_cvt_pk_bf16_f32 v9, v50, -v51
    v_cvt_pk_bf16_f32 v109, v150, -v151
    ds_write_b32 v5, v9 offset:2016
    ds_write_b32 v5, v109 offset:38880
    v_pk_mul_f32 v[52:53], v[44:45], v[44:45] op_sel:[0,0] op_sel_hi:[0,1]
    v_pk_mul_f32 v[152:153], v[144:145], v[144:145] op_sel:[0,0] op_sel_hi:[0,1]
    v_pk_fma_f32 v[52:53], v[44:45], v[44:45], v[52:53] op_sel:[1,1,0] op_sel_hi:[1,0,1] neg_lo:[1,0,0]
    v_pk_fma_f32 v[152:153], v[144:145], v[144:145], v[152:153] op_sel:[1,1,0] op_sel_hi:[1,0,1] neg_lo:[1,0,0]
    v_cvt_pk_bf16_f32 v8, v52, -v53
    v_cvt_pk_bf16_f32 v108, v152, -v153
    ds_write_b32 v5, v8 offset:2304
    ds_write_b32 v5, v108 offset:39168
    v_pk_mul_f32 v[56:57], v[52:53], v[32:33] op_sel:[0,0] op_sel_hi:[0,1]
    v_pk_mul_f32 v[156:157], v[152:153], v[132:133] op_sel:[0,0] op_sel_hi:[0,1]
    v_pk_fma_f32 v[56:57], v[52:53], v[32:33], v[56:57] op_sel:[1,1,0] op_sel_hi:[1,0,1] neg_lo:[1,0,0]
    v_pk_fma_f32 v[156:157], v[152:153], v[132:133], v[156:157] op_sel:[1,1,0] op_sel_hi:[1,0,1] neg_lo:[1,0,0]
    v_cvt_pk_bf16_f32 v9, v56, -v57
    v_cvt_pk_bf16_f32 v109, v156, -v157
    ds_write_b32 v5, v9 offset:2592
    ds_write_b32 v5, v109 offset:39456
    v_pk_mul_f32 v[54:55], v[46:47], v[46:47] op_sel:[0,0] op_sel_hi:[0,1]
    v_pk_mul_f32 v[154:155], v[146:147], v[146:147] op_sel:[0,0] op_sel_hi:[0,1]
    v_pk_fma_f32 v[54:55], v[46:47], v[46:47], v[54:55] op_sel:[1,1,0] op_sel_hi:[1,0,1] neg_lo:[1,0,0]
    v_pk_fma_f32 v[154:155], v[146:147], v[146:147], v[154:155] op_sel:[1,1,0] op_sel_hi:[1,0,1] neg_lo:[1,0,0]
PAD_A_6:
    s_cbranch_execz PRET_A
    v_cvt_pk_bf16_f32 v8, v54, -v55
    v_cvt_pk_bf16_f32 v108, v154, -v155
    ds_write_b32 v5, v8 offset:2880
    ds_write_b32 v5, v108 offset:39744
    v_pk_mul_f32 v[56:57], v[52:53], v[42:43] op_sel:[0,0] op_sel_hi:[0,1]
    v_pk_mul_f32 v[156:157], v[152:153], v[142:143] op_sel:[0,0] op_sel_hi:[0,1]
    v_pk_fma_f32 v[56:57], v[52:53], v[42:43], v[56:57] op_sel:[1,1,0] op_sel_hi:[1,0,1] neg_lo:[1,0,0]
    v_pk_fma_f32 v[156:157], v[152:153], v[142:143], v[156:157] op_sel:[1,1,0] op_sel_hi:[1,0,1] neg_lo:[1,0,0]
    v_cvt_pk_bf16_f32 v9, v56, -v57
    v_cvt_pk_bf16_f32 v109, v156, -v157
    ds_write_b32 v5, v9 offset:3168
    ds_write_b32 v5, v109 offset:40032
    v_pk_mul_f32 v[54:55], v[48:49], v[48:49] op_sel:[0,0] op_sel_hi:[0,1]
    v_pk_mul_f32 v[154:155], v[148:149], v[148:149] op_sel:[0,0] op_sel_hi:[0,1]
    v_pk_fma_f32 v[54:55], v[48:49], v[48:49], v[54:55] op_sel:[1,1,0] op_sel_hi:[1,0,1] neg_lo:[1,0,0]
    v_pk_fma_f32 v[154:155], v[148:149], v[148:149], v[154:155] op_sel:[1,1,0] op_sel_hi:[1,0,1] neg_lo:[1,0,0]
    v_cvt_pk_bf16_f32 v8, v54, -v55
    v_cvt_pk_bf16_f32 v108, v154, -v155
    ds_write_b32 v5, v8 offset:3456
    ds_write_b32 v5, v108 offset:40320
    v_pk_mul_f32 v[56:57], v[52:53], v[46:47] op_sel:[0,0] op_sel_hi:[0,1]
    v_pk_mul_f32 v[156:157], v[152:153], v[146:147] op_sel:[0,0] op_sel_hi:[0,1]
    v_pk_fma_f32 v[56:57], v[52:53], v[46:47], v[56:57] op_sel:[1,1,0] op_sel_hi:[1,0,1] neg_lo:[1,0,0]
    v_pk_fma_f32 v[156:157], v[152:153], v[146:147], v[156:157] op_sel:[1,1,0] op_sel_hi:[1,0,1] neg_lo:[1,0,0]
    v_cvt_pk_bf16_f32 v9, v56, -v57
    v_cvt_pk_bf16_f32 v109, v156, -v157
    ds_write_b32 v5, v9 offset:3744
    ds_write_b32 v5, v109 offset:40608
    v_pk_mul_f32 v[54:55], v[50:51], v[50:51] op_sel:[0,0] op_sel_hi:[0,1]
    v_pk_mul_f32 v[154:155], v[150:151], v[150:151] op_sel:[0,0] op_sel_hi:[0,1]
    v_pk_fma_f32 v[54:55], v[50:51], v[50:51], v[54:55] op_sel:[1,1,0] op_sel_hi:[1,0,1] neg_lo:[1,0,0]
    v_pk_fma_f32 v[154:155], v[150:151], v[150:151], v[154:155] op_sel:[1,1,0] op_sel_hi:[1,0,1] neg_lo:[1,0,0]
    v_cvt_pk_bf16_f32 v8, v54, -v55
    v_cvt_pk_bf16_f32 v108, v154, -v155
    ds_write_b32 v5, v8 offset:4032
    ds_write_b32 v5, v108 offset:40896
    v_pk_mul_f32 v[56:57], v[52:53], v[50:51] op_sel:[0,0] op_sel_hi:[0,1]
    v_pk_mul_f32 v[156:157], v[152:153], v[150:151] op_sel:[0,0] op_sel_hi:[0,1]
    v_pk_fma_f32 v[56:57], v[52:53], v[50:51], v[56:57] op_sel:[1,1,0] op_sel_hi:[1,0,1] neg_lo:[1,0,0]
    v_pk_fma_f32 v[156:157], v[152:153], v[150:151], v[156:157] op_sel:[1,1,0] op_sel_hi:[1,0,1] neg_lo:[1,0,0]
PAD_A_7:
    s_cbranch_execz PRET_A
    v_cvt_pk_bf16_f32 v9, v56, -v57
    v_cvt_pk_bf16_f32 v109, v156, -v157
    ds_write_b32 v5, v9 offset:4320
    ds_write_b32 v5, v109 offset:41184
    ds_read_b128 v[60:63], v6 offset:0
    ds_read_b128 v[160:163], v6 offset:36864
    ds_read_b128 v[64:67], v6 offset:64
    ds_read_b128 v[164:167], v6 offset:36928
    ds_read_b128 v[68:71], v6 offset:128
    ds_read_b128 v[168:171], v6 offset:36992
    ds_read_b128 v[72:75], v6 offset:192
    ds_read_b128 v[172:175], v6 offset:37056
    v_cvt_pk_bf16_f32 v8, v38, v39
    v_cvt_pk_bf16_f32 v108, v138, v139
    ds_write_b32 v5, v8 offset:4608
    ds_write_b32 v5, v108 offset:41472
    v_pk_mul_f32 v[56:57], v[38:39], v[18:19] op_sel:[0,0] op_sel_hi:[0,1]
    v_pk_mul_f32 v[156:157], v[138:139], v[118:119] op_sel:[0,0] op_sel_hi:[0,1]
    v_pk_fma_f32 v[56:57], v[38:39], v[18:19], v[56:57] op_sel:[1,1,0] op_sel_hi:[1,0,1] neg_lo:[1,0,0]
    v_pk_fma_f32 v[156:157], v[138:139], v[118:119], v[156:157] op_sel:[1,1,0] op_sel_hi:[1,0,1] neg_lo:[1,0,0]
    v_cvt_pk_bf16_f32 v9, v56, v57
    v_cvt_pk_bf16_f32 v109, v156, v157
    ds_write_b32 v5, v9 offset:4896
    ds_write_b32 v5, v109 offset:41760
    v_pk_mul_f32 v[54:55], v[38:39], v[20:21] op_sel:[0,0] op_sel_hi:[0,1]
    v_pk_mul_f32 v[154:155], v[138:139], v[120:121] op_sel:[0,0] op_sel_hi:[0,1]
    v_pk_fma_f32 v[54:55], v[38:39], v[20:21], v[54:55] op_sel:[1,1,0] op_sel_hi:[1,0,1] neg_lo:[1,0,0]
    v_pk_fma_f32 v[154:155], v[138:139], v[120:121], v[154:155] op_sel:[1,1,0] op_sel_hi:[1,0,1] neg_lo:[1,0,0]
    v_cvt_pk_bf16_f32 v8, v54, v55
    v_cvt_pk_bf16_f32 v108, v154, v155
    ds_write_b32 v5, v8 offset:5184
    ds_write_b32 v5, v108 offset:42048
    v_pk_mul_f32 v[56:57], v[38:39], v[22:23] op_sel:[0,0] op_sel_hi:[0,1]
    v_pk_mul_f32 v[156:157], v[138:139], v[122:123] op_sel:[0,0] op_sel_hi:[0,1]
    v_pk_fma_f32 v[56:57], v[38:39], v[22:23], v[56:57] op_sel:[1,1,0] op_sel_hi:[1,0,1] neg_lo:[1,0,0]
    v_pk_fma_f32 v[156:157], v[138:139], v[122:123], v[156:157] op_sel:[1,1,0] op_sel_hi:[1,0,1] neg_lo:[1,0,0]
    v_cvt_pk_bf16_f32 v9, v56, v57
    v_cvt_pk_bf16_f32 v109, v156, v157
    ds_write_b32 v5, v9 offset:5472
    ds_write_b32 v5, v109 offset:42336
PAD_A_8:
    s_cbranch_execz PRET_A
    v_pk_mul_f32 v[54:55], v[38:39], v[24:25] op_sel:[0,0] op_sel_hi:[0,1]
    v_pk_mul_f32 v[154:155], v[138:139], v[124:125] op_sel:[0,0] op_sel_hi:[0,1]
    v_pk_fma_f32 v[54:55], v[38:39], v[24:25], v[54:55] op_sel:[1,1,0] op_sel_hi:[1,0,1] neg_lo:[1,0,0]
    v_pk_fma_f32 v[154:155], v[138:139], v[124:125], v[154:155] op_sel:[1,1,0] op_sel_hi:[1,0,1] neg_lo:[1,0,0]
    v_cvt_pk_bf16_f32 v8, v54, v55
    v_cvt_pk_bf16_f32 v108, v154, v155
    ds_write_b32 v5, v8 offset:5760
    ds_write_b32 v5, v108 offset:42624
    v_pk_mul_f32 v[56:57], v[38:39], v[26:27] op_sel:[0,0] op_sel_hi:[0,1]
    v_pk_mul_f32 v[156:157], v[138:139], v[126:127] op_sel:[0,0] op_sel_hi:[0,1]
    v_pk_fma_f32 v[56:57], v[38:39], v[26:27], v[56:57] op_sel:[1,1,0] op_sel_hi:[1,0,1] neg_lo:[1,0,0]
    v_pk_fma_f32 v[156:157], v[138:139], v[126:127], v[156:157] op_sel:[1,1,0] op_sel_hi:[1,0,1] neg_lo:[1,0,0]
    v_cvt_pk_bf16_f32 v9, v56, v57
    v_cvt_pk_bf16_f32 v109, v156, v157
    ds_write_b32 v5, v9 offset:6048
    ds_write_b32 v5, v109 offset:42912
    v_pk_mul_f32 v[54:55], v[38:39], v[28:29] op_sel:[0,0] op_sel_hi:[0,1]
    v_pk_mul_f32 v[154:155], v[138:139], v[128:129] op_sel:[0,0] op_sel_hi:[0,1]
    v_pk_fma_f32 v[54:55], v[38:39], v[28:29], v[54:55] op_sel:[1,1,0] op_sel_hi:[1,0,1] neg_lo:[1,0,0]
    v_pk_fma_f32 v[154:155], v[138:139], v[128:129], v[154:155] op_sel:[1,1,0] op_sel_hi:[1,0,1] neg_lo:[1,0,0]
    v_cvt_pk_bf16_f32 v8, v54, v55
    v_cvt_pk_bf16_f32 v108, v154, v155
    ds_write_b32 v5, v8 offset:6336
    ds_write_b32 v5, v108 offset:43200
    v_pk_mul_f32 v[56:57], v[38:39], v[30:31] op_sel:[0,0] op_sel_hi:[0,1]
    v_pk_mul_f32 v[156:157], v[138:139], v[130:131] op_sel:[0,0] op_sel_hi:[0,1]
    v_pk_fma_f32 v[56:57], v[38:39], v[30:31], v[56:57] op_sel:[1,1,0] op_sel_hi:[1,0,1] neg_lo:[1,0,0]
    v_pk_fma_f32 v[156:157], v[138:139], v[130:131], v[156:157] op_sel:[1,1,0] op_sel_hi:[1,0,1] neg_lo:[1,0,0]
    v_cvt_pk_bf16_f32 v9, v56, v57
    v_cvt_pk_bf16_f32 v109, v156, v157
    ds_write_b32 v5, v9 offset:6624
    ds_write_b32 v5, v109 offset:43488
    v_pk_mul_f32 v[40:41], v[38:39], v[36:37] op_sel:[0,0] op_sel_hi:[0,1]
    v_pk_mul_f32 v[140:141], v[138:139], v[136:137] op_sel:[0,0] op_sel_hi:[0,1]
    v_pk_fma_f32 v[40:41], v[38:39], v[36:37], v[40:41] op_sel:[1,1,0] op_sel_hi:[1,0,1] neg_lo:[1,0,0]
    v_pk_fma_f32 v[140:141], v[138:139], v[136:137], v[140:141] op_sel:[1,1,0] op_sel_hi:[1,0,1] neg_lo:[1,0,0]
    v_cvt_pk_bf16_f32 v8, v40, v41
    v_cvt_pk_bf16_f32 v108, v140, v141
    ds_write_b32 v5, v8 offset:6912
    ds_write_b32 v5, v108 offset:43776
PAD_A_9:
    s_cbranch_execz PAD_A_10
    v_pk_mul_f32 v[56:57], v[40:41], v[18:19] op_sel:[0,0] op_sel_hi:[0,1]
    v_pk_mul_f32 v[156:157], v[140:141], v[118:119] op_sel:[0,0] op_sel_hi:[0,1]
    v_pk_fma_f32 v[56:57], v[40:41], v[18:19], v[56:57] op_sel:[1,1,0] op_sel_hi:[1,0,1] neg_lo:[1,0,0]
    v_pk_fma_f32 v[156:157], v[140:141], v[118:119], v[156:157] op_sel:[1,1,0] op_sel_hi:[1,0,1] neg_lo:[1,0,0]
    v_cvt_pk_bf16_f32 v9, v56, v57
    v_cvt_pk_bf16_f32 v109, v156, v157
    ds_write_b32 v5, v9 offset:7200
    ds_write_b32 v5, v109 offset:44064
    s_waitcnt vmcnt(10)
    s_barrier
    s_cmp_lg_u32 s6, 0
    s_cbranch_scc1 SKIP_3
    s_add_u32 s92, s88, 1
    v_mov_b32 v253, s92
    v_lshlrev_b32 v252, 10, v2
    buffer_store_dword v253, v252, s[20:23], s89 offen sc1
    v_mov_b32 v251, s101
    s_add_u32 s3, s89, 131072
    buffer_store_dword v251, v252, s[20:23], s3 offen sc1
    s_mov_b64 exec, -1
SKIP_3:
    v_pk_mul_f32 v[54:55], v[40:41], v[20:21] op_sel:[0,0] op_sel_hi:[0,1]
    v_pk_mul_f32 v[154:155], v[140:141], v[120:121] op_sel:[0,0] op_sel_hi:[0,1]
    v_pk_fma_f32 v[54:55], v[40:41], v[20:21], v[54:55] op_sel:[1,1,0] op_sel_hi:[1,0,1] neg_lo:[1,0,0]
    v_pk_fma_f32 v[154:155], v[140:141], v[120:121], v[154:155] op_sel:[1,1,0] op_sel_hi:[1,0,1] neg_lo:[1,0,0]
    v_cvt_pk_bf16_f32 v8, v54, v55
    v_cvt_pk_bf16_f32 v108, v154, v155
    ds_write_b32 v5, v8 offset:7488
    ds_write_b32 v5, v108 offset:44352
    v_pk_mul_f32 v[56:57], v[40:41], v[22:23] op_sel:[0,0] op_sel_hi:[0,1]
    v_pk_mul_f32 v[156:157], v[140:141], v[122:123] op_sel:[0,0] op_sel_hi:[0,1]
    s_lshl_b32 s25, s96, 2
    s_add_u32 s25, s25, s6
    s_mul_i32 s25, s25, 114688
    s_mul_i32 s24, s97, 7168
    s_add_u32 s25, s25, s24
    s_add_u32 s25, s25, 16777216
    v_mov_b32 v216, -1
    v_mov_b32 v217, -1
    v_mov_b32 v218, -1
    v_mov_b32 v219, -1
    v_pk_fma_f32 v[56:57], v[40:41], v[22:23], v[56:57] op_sel:[1,1,0] op_sel_hi:[1,0,1] neg_lo:[1,0,0]
    v_pk_fma_f32 v[156:157], v[140:141], v[122:123], v[156:157] op_sel:[1,1,0] op_sel_hi:[1,0,1] neg_lo:[1,0,0]
    v_cvt_pk_bf16_f32 v9, v56, v57
    v_cvt_pk_bf16_f32 v109, v156, v157
    ds_write_b32 v5, v9 offset:7776
    ds_write_b32 v5, v109 offset:44640
    v_pk_mul_f32 v[54:55], v[40:41], v[24:25] op_sel:[0,0] op_sel_hi:[0,1]
    v_pk_mul_f32 v[154:155], v[140:141], v[124:125] op_sel:[0,0] op_sel_hi:[0,1]
PAD_A_10:
    s_cbranch_execz PRET_A
    v_pk_fma_f32 v[54:55], v[40:41], v[24:25], v[54:55] op_sel:[1,1,0] op_sel_hi:[1,0,1] neg_lo:[1,0,0]
    v_pk_fma_f32 v[154:155], v[140:141], v[124:125], v[154:155] op_sel:[1,1,0] op_sel_hi:[1,0,1] neg_lo:[1,0,0]
    v_cvt_pk_bf16_f32 v8, v54, v55
    v_cvt_pk_bf16_f32 v108, v154, v155
    ds_write_b32 v5, v8 offset:8064
    ds_write_b32 v5, v108 offset:44928
    s_add_u32 s25, s25, 4096
    buffer_store_dwordx4 v[216:219], v254, s[20:23], s25 offen sc1
    v_pk_mul_f32 v[56:57], v[40:41], v[26:27] op_sel:[0,0] op_sel_hi:[0,1]
    v_pk_mul_f32 v[156:157], v[140:141], v[126:127] op_sel:[0,0] op_sel_hi:[0,1]
    v_pk_fma_f32 v[56:57], v[40:41], v[26:27], v[56:57] op_sel:[1,1,0] op_sel_hi:[1,0,1] neg_lo:[1,0,0]
    v_pk_fma_f32 v[156:157], v[140:141], v[126:127], v[156:157] op_sel:[1,1,0] op_sel_hi:[1,0,1] neg_lo:[1,0,0]
    v_cvt_pk_bf16_f32 v9, v56, v57
    v_cvt_pk_bf16_f32 v109, v156, v157
    ds_write_b32 v5, v9 offset:8352
    ds_write_b32 v5, v109 offset:45216
    v_pk_mul_f32 v[54:55], v[40:41], v[28:29] op_sel:[0,0] op_sel_hi:[0,1]
    v_pk_mul_f32 v[154:155], v[140:141], v[128:129] op_sel:[0,0] op_sel_hi:[0,1]
    v_pk_fma_f32 v[54:55], v[40:41], v[28:29], v[54:55] op_sel:[1,1,0] op_sel_hi:[1,0,1] neg_lo:[1,0,0]
    v_pk_fma_f32 v[154:155], v[140:141], v[128:129], v[154:155] op_sel:[1,1,0] op_sel_hi:[1,0,1] neg_lo:[1,0,0]
    v_cvt_pk_bf16_f32 v8, v54, v55
    v_cvt_pk_bf16_f32 v108, v154, v155
    buffer_store_dwordx4 v[216:219], v254, s[20:23], s25 offen offset:1024 sc1
    ds_write_b32 v5, v8 offset:8640
    ds_write_b32 v5, v108 offset:45504
    v_pk_mul_f32 v[56:57], v[40:41], v[30:31] op_sel:[0,0] op_sel_hi:[0,1]
    v_pk_mul_f32 v[156:157], v[140:141], v[130:131] op_sel:[0,0] op_sel_hi:[0,1]
    v_pk_fma_f32 v[56:57], v[40:41], v[30:31], v[56:57] op_sel:[1,1,0] op_sel_hi:[1,0,1] neg_lo:[1,0,0]
    v_pk_fma_f32 v[156:157], v[140:141], v[130:131], v[156:157] op_sel:[1,1,0] op_sel_hi:[1,0,1] neg_lo:[1,0,0]
    v_cvt_pk_bf16_f32 v9, v56, v57
    v_cvt_pk_bf16_f32 v109, v156, v157
    ds_write_b32 v5, v9 offset:8928
    ds_write_b32 v5, v109 offset:45792
    ds_read_b128 v[76:79], v6 offset:4608
    ds_read_b128 v[176:179], v6 offset:41472
    ds_read_b128 v[80:83], v6 offset:4672
    ds_read_b128 v[180:183], v6 offset:41536
    buffer_store_dwordx4 v[216:219], v254, s[20:23], s25 offen offset:2048 sc1
    ds_read_b128 v[84:87], v6 offset:4736
    ds_read_b128 v[184:187], v6 offset:41600
PAD_A_11:
    s_cbranch_execz PRET_A
    ds_read_b128 v[88:91], v6 offset:4800
    ds_read_b128 v[188:191], v6 offset:41664
    s_waitcnt lgkmcnt(7)
    v_mfma_f32_16x16x32_bf16 v[92:95], v[76:79], v[60:63], 0
    s_waitcnt lgkmcnt(6)
    v_mfma_f32_16x16x32_bf16 v[192:195], v[176:179], v[160:163], 0
    s_waitcnt lgkmcnt(5)
    v_mfma_f32_16x16x32_bf16 v[92:95], v[80:83], v[64:67], v[92:95]
    s_waitcnt lgkmcnt(4)
    v_mfma_f32_16x16x32_bf16 v[192:195], v[180:183], v[164:167], v[192:195]
    s_waitcnt lgkmcnt(3)
    v_mfma_f32_16x16x32_bf16 v[92:95], v[84:87], v[68:71], v[92:95]
    s_waitcnt lgkmcnt(2)
    v_mfma_f32_16x16x32_bf16 v[192:195], v[184:187], v[168:171], v[192:195]
    s_waitcnt lgkmcnt(1)
    v_mfma_f32_16x16x32_bf16 v[92:95], v[88:91], v[72:75], v[92:95]
    s_waitcnt lgkmcnt(0)
    v_mfma_f32_16x16x32_bf16 v[192:195], v[188:191], v[172:175], v[192:195]
    v_pk_mul_f32 v[42:43], v[40:41], v[36:37] op_sel:[0,0] op_sel_hi:[0,1]
    v_pk_mul_f32 v[142:143], v[140:141], v[136:137] op_sel:[0,0] op_sel_hi:[0,1]
    v_pk_fma_f32 v[42:43], v[40:41], v[36:37], v[42:43] op_sel:[1,1,0] op_sel_hi:[1,0,1] neg_lo:[1,0,0]
    v_pk_fma_f32 v[142:143], v[140:141], v[136:137], v[142:143] op_sel:[1,1,0] op_sel_hi:[1,0,1] neg_lo:[1,0,0]
    v_cvt_pk_bf16_f32 v8, v42, v43
    v_cvt_pk_bf16_f32 v108, v142, v143
    ds_write_b32 v5, v8 offset:4608
    ds_write_b32 v5, v108 offset:41472
    v_pk_mul_f32 v[56:57], v[42:43], v[20:21] op_sel:[0,0] op_sel_hi:[0,1]
    v_pk_mul_f32 v[156:157], v[142:143], v[120:121] op_sel:[0,0] op_sel_hi:[0,1]
    v_pk_fma_f32 v[56:57], v[42:43], v[20:21], v[56:57] op_sel:[1,1,0] op_sel_hi:[1,0,1] neg_lo:[1,0,0]
    v_pk_fma_f32 v[156:157], v[142:143], v[120:121], v[156:157] op_sel:[1,1,0] op_sel_hi:[1,0,1] neg_lo:[1,0,0]
    v_cvt_pk_bf16_f32 v9, v56, v57
    v_cvt_pk_bf16_f32 v109, v156, v157
    ds_write_b32 v5, v9 offset:4896
    ds_write_b32 v5, v109 offset:41760
    v_pk_mul_f32 v[54:55], v[42:43], v[24:25] op_sel:[0,0] op_sel_hi:[0,1]
    v_pk_mul_f32 v[154:155], v[142:143], v[124:125] op_sel:[0,0] op_sel_hi:[0,1]
    v_pk_fma_f32 v[54:55], v[42:43], v[24:25], v[54:55] op_sel:[1,1,0] op_sel_hi:[1,0,1] neg_lo:[1,0,0]
    v_pk_fma_f32 v[154:155], v[142:143], v[124:125], v[154:155] op_sel:[1,1,0] op_sel_hi:[1,0,1] neg_lo:[1,0,0]
    v_cvt_pk_bf16_f32 v8, v54, v55
    v_cvt_pk_bf16_f32 v108, v154, v155
    ds_write_b32 v5, v8 offset:5184
    ds_write_b32 v5, v108 offset:42048
    v_pk_mul_f32 v[56:57], v[42:43], v[28:29] op_sel:[0,0] op_sel_hi:[0,1]
    v_pk_mul_f32 v[156:157], v[142:143], v[128:129] op_sel:[0,0] op_sel_hi:[0,1]
PAD_A_12:
    s_cbranch_execz PRET_A
    v_pk_fma_f32 v[56:57], v[42:43], v[28:29], v[56:57] op_sel:[1,1,0] op_sel_hi:[1,0,1] neg_lo:[1,0,0]
    v_pk_fma_f32 v[156:157], v[142:143], v[128:129], v[156:157] op_sel:[1,1,0] op_sel_hi:[1,0,1] neg_lo:[1,0,0]
    v_cvt_pk_bf16_f32 v9, v56, v57
    v_cvt_pk_bf16_f32 v109, v156, v157
    ds_write_b32 v5, v9 offset:5472
    ds_write_b32 v5, v109 offset:42336
    v_pk_mul_f32 v[40:41], v[42:43], v[36:37] op_sel:[0,0] op_sel_hi:[0,1]
    v_pk_mul_f32 v[140:141], v[142:143], v[136:137] op_sel:[0,0] op_sel_hi:[0,1]
    v_pk_fma_f32 v[40:41], v[42:43], v[36:37], v[40:41] op_sel:[1,1,0] op_sel_hi:[1,0,1] neg_lo:[1,0,0]
    v_pk_fma_f32 v[140:141], v[142:143], v[136:137], v[140:141] op_sel:[1,1,0] op_sel_hi:[1,0,1] neg_lo:[1,0,0]
    v_cvt_pk_bf16_f32 v8, v40, v41
    v_cvt_pk_bf16_f32 v108, v140, v141
    ds_write_b32 v5, v8 offset:5760
    ds_write_b32 v5, v108 offset:42624
    v_pk_mul_f32 v[56:57], v[40:41], v[20:21] op_sel:[0,0] op_sel_hi:[0,1]
    v_pk_mul_f32 v[156:157], v[140:141], v[120:121] op_sel:[0,0] op_sel_hi:[0,1]
    v_pk_fma_f32 v[56:57], v[40:41], v[20:21], v[56:57] op_sel:[1,1,0] op_sel_hi:[1,0,1] neg_lo:[1,0,0]
    v_pk_fma_f32 v[156:157], v[140:141], v[120:121], v[156:157] op_sel:[1,1,0] op_sel_hi:[1,0,1] neg_lo:[1,0,0]
    v_cvt_pk_bf16_f32 v9, v56, v57
    v_cvt_pk_bf16_f32 v109, v156, v157
    ds_write_b32 v5, v9 offset:6048
    ds_write_b32 v5, v109 offset:42912
    v_pk_mul_f32 v[54:55], v[40:41], v[24:25] op_sel:[0,0] op_sel_hi:[0,1]
    v_pk_mul_f32 v[154:155], v[140:141], v[124:125] op_sel:[0,0] op_sel_hi:[0,1]
    v_pk_fma_f32 v[54:55], v[40:41], v[24:25], v[54:55] op_sel:[1,1,0] op_sel_hi:[1,0,1] neg_lo:[1,0,0]
    v_pk_fma_f32 v[154:155], v[140:141], v[124:125], v[154:155] op_sel:[1,1,0] op_sel_hi:[1,0,1] neg_lo:[1,0,0]
    v_cvt_pk_bf16_f32 v8, v54, v55
    v_cvt_pk_bf16_f32 v108, v154, v155
    ds_write_b32 v5, v8 offset:6336
    ds_write_b32 v5, v108 offset:43200
    v_pk_mul_f32 v[56:57], v[40:41], v[28:29] op_sel:[0,0] op_sel_hi:[0,1]
    v_pk_mul_f32 v[156:157], v[140:141], v[128:129] op_sel:[0,0] op_sel_hi:[0,1]
    v_pk_fma_f32 v[56:57], v[40:41], v[28:29], v[56:57] op_sel:[1,1,0] op_sel_hi:[1,0,1] neg_lo:[1,0,0]
    v_pk_fma_f32 v[156:157], v[140:141], v[128:129], v[156:157] op_sel:[1,1,0] op_sel_hi:[1,0,1] neg_lo:[1,0,0]
    v_cvt_pk_bf16_f32 v9, v56, v57
    v_cvt_pk_bf16_f32 v109, v156, v157
    ds_write_b32 v5, v9 offset:6624
    ds_write_b32 v5, v109 offset:43488
    v_pk_mul_f32 v[42:43], v[40:41], v[36:37] op_sel:[0,0] op_sel_hi:[0,1]
    v_pk_mul_f32 v[142:143], v[140:141], v[136:137] op_sel:[0,0] op_sel_hi:[0,1]
PAD_A_13:
    s_cbranch_execz PAD_A_14
    v_pk_fma_f32 v[42:43], v[40:41], v[36:37], v[42:43] op_sel:[1,1,0] op_sel_hi:[1,0,1] neg_lo:[1,0,0]
    v_pk_fma_f32 v[142:143], v[140:141], v[136:137], v[142:143] op_sel:[1,1,0] op_sel_hi:[1,0,1] neg_lo:[1,0,0]
    v_cvt_pk_bf16_f32 v8, v42, v43
    v_cvt_pk_bf16_f32 v108, v142, v143
    ds_write_b32 v5, v8 offset:6912
    ds_write_b32 v5, v108 offset:43776
    v_pk_mul_f32 v[56:57], v[42:43], v[24:25] op_sel:[0,0] op_sel_hi:[0,1]
    v_pk_mul_f32 v[156:157], v[142:143], v[124:125] op_sel:[0,0] op_sel_hi:[0,1]
    v_pk_fma_f32 v[56:57], v[42:43], v[24:25], v[56:57] op_sel:[1,1,0] op_sel_hi:[1,0,1] neg_lo:[1,0,0]
    v_pk_fma_f32 v[156:157], v[142:143], v[124:125], v[156:157] op_sel:[1,1,0] op_sel_hi:[1,0,1] neg_lo:[1,0,0]
    v_mov_b32 v243, 0x05040100
    v_mov_b32 v244, 0x07060302
    v_lshrrev_b32 v242, 4, v0
    v_mul_u32_u24 v242, 114688, v242
    s_waitcnt vmcnt(11)
    v_and_b32 v245, 15, v0
    v_lshl_add_u32 v242, v245, 5, v242
    s_lshl_b32 s7, s2, 9
    s_add_u32 s7, s7, 12582912
    s_waitcnt vmcnt(9)
    v_perm_b32 v234, v227, v226, v243
    v_perm_b32 v238, v227, v226, v244
    s_waitcnt vmcnt(7)
    v_perm_b32 v235, v229, v228, v243
    v_perm_b32 v239, v229, v228, v244
    s_waitcnt vmcnt(5)
    v_perm_b32 v236, v231, v230, v243
    v_perm_b32 v240, v231, v230, v244
    s_waitcnt vmcnt(3)
    v_perm_b32 v237, v233, v232, v243
    v_perm_b32 v241, v233, v232, v244
    v_cmp_gt_u32 vcc, 224, v0
    s_and_saveexec_b64 s[8:9], vcc
    buffer_store_dwordx4 v[234:237], v242, s[20:23], s7 offen sc1
    buffer_store_dwordx4 v[238:241], v242, s[20:23], s7 offen offset:16 sc1
    s_mov_b64 exec, -1
    v_cvt_pk_bf16_f32 v9, v56, v57
    v_cvt_pk_bf16_f32 v109, v156, v157
    ds_write_b32 v5, v9 offset:7200
    ds_write_b32 v5, v109 offset:44064
    v_pk_mul_f32 v[40:41], v[42:43], v[36:37] op_sel:[0,0] op_sel_hi:[0,1]
    v_pk_mul_f32 v[140:141], v[142:143], v[136:137] op_sel:[0,0] op_sel_hi:[0,1]
    v_pk_fma_f32 v[40:41], v[42:43], v[36:37], v[40:41] op_sel:[1,1,0] op_sel_hi:[1,0,1] neg_lo:[1,0,0]
    v_pk_fma_f32 v[140:141], v[142:143], v[136:137], v[140:141] op_sel:[1,1,0] op_sel_hi:[1,0,1] neg_lo:[1,0,0]
    v_cvt_pk_bf16_f32 v8, v40, v41
PAD_A_14:
    s_cbranch_execz PRET_A
    v_cvt_pk_bf16_f32 v108, v140, v141
    ds_write_b32 v5, v8 offset:7488
    ds_write_b32 v5, v108 offset:44352
    v_pk_mul_f32 v[56:57], v[40:41], v[24:25] op_sel:[0,0] op_sel_hi:[0,1]
    v_pk_mul_f32 v[156:157], v[140:141], v[124:125] op_sel:[0,0] op_sel_hi:[0,1]
    v_pk_fma_f32 v[56:57], v[40:41], v[24:25], v[56:57] op_sel:[1,1,0] op_sel_hi:[1,0,1] neg_lo:[1,0,0]
    v_pk_fma_f32 v[156:157], v[140:141], v[124:125], v[156:157] op_sel:[1,1,0] op_sel_hi:[1,0,1] neg_lo:[1,0,0]
    v_cvt_pk_bf16_f32 v9, v56, v57
    v_cvt_pk_bf16_f32 v109, v156, v157
    ds_write_b32 v5, v9 offset:7776
    ds_write_b32 v5, v109 offset:44640
    v_pk_mul_f32 v[42:43], v[40:41], v[36:37] op_sel:[0,0] op_sel_hi:[0,1]
    v_pk_mul_f32 v[142:143], v[140:141], v[136:137] op_sel:[0,0] op_sel_hi:[0,1]
    v_pk_fma_f32 v[42:43], v[40:41], v[36:37], v[42:43] op_sel:[1,1,0] op_sel_hi:[1,0,1] neg_lo:[1,0,0]
    v_pk_fma_f32 v[142:143], v[140:141], v[136:137], v[142:143] op_sel:[1,1,0] op_sel_hi:[1,0,1] neg_lo:[1,0,0]
    v_cvt_pk_bf16_f32 v8, v42, v43
    v_cvt_pk_bf16_f32 v108, v142, v143
    ds_write_b32 v5, v8 offset:8064
    ds_write_b32 v5, v108 offset:44928
    v_pk_mul_f32 v[56:57], v[42:43], v[24:25] op_sel:[0,0] op_sel_hi:[0,1]
    v_pk_mul_f32 v[156:157], v[142:143], v[124:125] op_sel:[0,0] op_sel_hi:[0,1]
    v_pk_fma_f32 v[56:57], v[42:43], v[24:25], v[56:57] op_sel:[1,1,0] op_sel_hi:[1,0,1] neg_lo:[1,0,0]
    v_pk_fma_f32 v[156:157], v[142:143], v[124:125], v[156:157] op_sel:[1,1,0] op_sel_hi:[1,0,1] neg_lo:[1,0,0]
    v_cvt_pk_bf16_f32 v9, v56, v57
    v_cvt_pk_bf16_f32 v109, v156, v157
    ds_write_b32 v5, v9 offset:8352
    ds_write_b32 v5, v109 offset:45216
    v_pk_mul_f32 v[40:41], v[42:43], v[36:37] op_sel:[0,0] op_sel_hi:[0,1]
    v_pk_mul_f32 v[140:141], v[142:143], v[136:137] op_sel:[0,0] op_sel_hi:[0,1]
    v_pk_fma_f32 v[40:41], v[42:43], v[36:37], v[40:41] op_sel:[1,1,0] op_sel_hi:[1,0,1] neg_lo:[1,0,0]
    v_pk_fma_f32 v[140:141], v[142:143], v[136:137], v[140:141] op_sel:[1,1,0] op_sel_hi:[1,0,1] neg_lo:[1,0,0]
    v_cvt_pk_bf16_f32 v8, v40, v41
    v_cvt_pk_bf16_f32 v108, v140, v141
    ds_write_b32 v5, v8 offset:8640
    ds_write_b32 v5, v108 offset:45504
    v_pk_mul_f32 v[56:57], v[40:41], v[24:25] op_sel:[0,0] op_sel_hi:[0,1]
    v_pk_mul_f32 v[156:157], v[140:141], v[124:125] op_sel:[0,0] op_sel_hi:[0,1]
    v_pk_fma_f32 v[56:57], v[40:41], v[24:25], v[56:57] op_sel:[1,1,0] op_sel_hi:[1,0,1] neg_lo:[1,0,0]
    v_pk_fma_f32 v[156:157], v[140:141], v[124:125], v[156:157] op_sel:[1,1,0] op_sel_hi:[1,0,1] neg_lo:[1,0,0]
    v_cvt_pk_bf16_f32 v9, v56, v57
PAD_A_15:
    s_cbranch_execz PRET_A
    v_cvt_pk_bf16_f32 v109, v156, v157
    ds_write_b32 v5, v9 offset:8928
    ds_write_b32 v5, v109 offset:45792
    ds_read_b128 v[76:79], v6 offset:4608
    ds_read_b128 v[176:179], v6 offset:41472
    ds_read_b128 v[80:83], v6 offset:4672
    ds_read_b128 v[180:183], v6 offset:41536
    ds_read_b128 v[84:87], v6 offset:4736
    ds_read_b128 v[184:187], v6 offset:41600
    ds_read_b128 v[88:91], v6 offset:4800
    ds_read_b128 v[188:191], v6 offset:41664
    s_waitcnt lgkmcnt(7)
    v_mfma_f32_16x16x32_bf16 v[96:99], v[76:79], v[60:63], 0
    s_waitcnt lgkmcnt(6)
    v_mfma_f32_16x16x32_bf16 v[196:199], v[176:179], v[160:163], 0
    s_waitcnt lgkmcnt(5)
    v_mfma_f32_16x16x32_bf16 v[96:99], v[80:83], v[64:67], v[96:99]
    s_waitcnt lgkmcnt(4)
    v_mfma_f32_16x16x32_bf16 v[196:199], v[180:183], v[164:167], v[196:199]
    s_waitcnt lgkmcnt(3)
    v_mfma_f32_16x16x32_bf16 v[96:99], v[84:87], v[68:71], v[96:99]
    s_waitcnt lgkmcnt(2)
    v_mfma_f32_16x16x32_bf16 v[196:199], v[184:187], v[168:171], v[196:199]
    s_waitcnt lgkmcnt(1)
    v_mfma_f32_16x16x32_bf16 v[96:99], v[88:91], v[72:75], v[96:99]
    s_waitcnt lgkmcnt(0)
    v_mfma_f32_16x16x32_bf16 v[196:199], v[188:191], v[172:175], v[196:199]
    v_pk_mul_f32 v[42:43], v[40:41], v[36:37] op_sel:[0,0] op_sel_hi:[0,1]
    v_pk_mul_f32 v[142:143], v[140:141], v[136:137] op_sel:[0,0] op_sel_hi:[0,1]
    v_pk_fma_f32 v[42:43], v[40:41], v[36:37], v[42:43] op_sel:[1,1,0] op_sel_hi:[1,0,1] neg_lo:[1,0,0]
    v_pk_fma_f32 v[142:143], v[140:141], v[136:137], v[142:143] op_sel:[1,1,0] op_sel_hi:[1,0,1] neg_lo:[1,0,0]
    v_cvt_pk_bf16_f32 v8, v42, v43
    v_cvt_pk_bf16_f32 v108, v142, v143
    ds_write_b32 v5, v8 offset:4608
    ds_write_b32 v5, v108 offset:41472
    v_pk_mul_f32 v[40:41], v[42:43], v[36:37] op_sel:[0,0] op_sel_hi:[0,1]
    v_pk_mul_f32 v[140:141], v[142:143], v[136:137] op_sel:[0,0] op_sel_hi:[0,1]
    v_pk_fma_f32 v[40:41], v[42:43], v[36:37], v[40:41] op_sel:[1,1,0] op_sel_hi:[1,0,1] neg_lo:[1,0,0]
    v_pk_fma_f32 v[140:141], v[142:143], v[136:137], v[140:141] op_sel:[1,1,0] op_sel_hi:[1,0,1] neg_lo:[1,0,0]
    v_cvt_pk_bf16_f32 v9, v40, v41
    v_cvt_pk_bf16_f32 v109, v140, v141
    ds_write_b32 v5, v9 offset:4896
    ds_write_b32 v5, v109 offset:41760
    v_pk_mul_f32 v[42:43], v[40:41], v[36:37] op_sel:[0,0] op_sel_hi:[0,1]
PAD_A_16:
    s_cbranch_execz PRET_A
    v_pk_mul_f32 v[142:143], v[140:141], v[136:137] op_sel:[0,0] op_sel_hi:[0,1]
    v_pk_fma_f32 v[42:43], v[40:41], v[36:37], v[42:43] op_sel:[1,1,0] op_sel_hi:[1,0,1] neg_lo:[1,0,0]
    v_pk_fma_f32 v[142:143], v[140:141], v[136:137], v[142:143] op_sel:[1,1,0] op_sel_hi:[1,0,1] neg_lo:[1,0,0]
    v_cvt_pk_bf16_f32 v8, v42, v43
    v_cvt_pk_bf16_f32 v108, v142, v143
    ds_write_b32 v5, v8 offset:5184
    ds_write_b32 v5, v108 offset:42048
    v_pk_mul_f32 v[40:41], v[42:43], v[36:37] op_sel:[0,0] op_sel_hi:[0,1]
    v_pk_mul_f32 v[140:141], v[142:143], v[136:137] op_sel:[0,0] op_sel_hi:[0,1]
    v_pk_fma_f32 v[40:41], v[42:43], v[36:37], v[40:41] op_sel:[1,1,0] op_sel_hi:[1,0,1] neg_lo:[1,0,0]
    v_pk_fma_f32 v[140:141], v[142:143], v[136:137], v[140:141] op_sel:[1,1,0] op_sel_hi:[1,0,1] neg_lo:[1,0,0]
    v_cvt_pk_bf16_f32 v9, v40, v41
    v_cvt_pk_bf16_f32 v109, v140, v141
    ds_write_b32 v5, v9 offset:5472
    ds_write_b32 v5, v109 offset:42336
    v_pk_mul_f32 v[42:43], v[40:41], v[36:37] op_sel:[0,0] op_sel_hi:[0,1]
    v_pk_mul_f32 v[142:143], v[140:141], v[136:137] op_sel:[0,0] op_sel_hi:[0,1]
    v_pk_fma_f32 v[42:43], v[40:41], v[36:37], v[42:43] op_sel:[1,1,0] op_sel_hi:[1,0,1] neg_lo:[1,0,0]
    v_pk_fma_f32 v[142:143], v[140:141], v[136:137], v[142:143] op_sel:[1,1,0] op_sel_hi:[1,0,1] neg_lo:[1,0,0]
    v_cvt_pk_bf16_f32 v8, v42, v43
    v_cvt_pk_bf16_f32 v108, v142, v143
    ds_write_b32 v5, v8 offset:5760
    ds_write_b32 v5, v108 offset:42624
    v_pk_mul_f32 v[40:41], v[42:43], v[36:37] op_sel:[0,0] op_sel_hi:[0,1]
    v_pk_mul_f32 v[140:141], v[142:143], v[136:137] op_sel:[0,0] op_sel_hi:[0,1]
    v_pk_fma_f32 v[40:41], v[42:43], v[36:37], v[40:41] op_sel:[1,1,0] op_sel_hi:[1,0,1] neg_lo:[1,0,0]
    v_pk_fma_f32 v[140:141], v[142:143], v[136:137], v[140:141] op_sel:[1,1,0] op_sel_hi:[1,0,1] neg_lo:[1,0,0]
    v_cvt_pk_bf16_f32 v9, v40, v41
    v_cvt_pk_bf16_f32 v109, v140, v141
    ds_write_b32 v5, v9 offset:6048
    ds_write_b32 v5, v109 offset:42912
    v_pk_mul_f32 v[42:43], v[40:41], v[36:37] op_sel:[0,0] op_sel_hi:[0,1]
    v_pk_mul_f32 v[142:143], v[140:141], v[136:137] op_sel:[0,0] op_sel_hi:[0,1]
    v_pk_fma_f32 v[42:43], v[40:41], v[36:37], v[42:43] op_sel:[1,1,0] op_sel_hi:[1,0,1] neg_lo:[1,0,0]
    v_pk_fma_f32 v[142:143], v[140:141], v[136:137], v[142:143] op_sel:[1,1,0] op_sel_hi:[1,0,1] neg_lo:[1,0,0]
    v_cvt_pk_bf16_f32 v8, v42, v43
    v_cvt_pk_bf16_f32 v108, v142, v143
    ds_write_b32 v5, v8 offset:6336
    ds_write_b32 v5, v108 offset:43200
    v_pk_mul_f32 v[40:41], v[42:43], v[36:37] op_sel:[0,0] op_sel_hi:[0,1]
PAD_A_17:
    s_cbranch_execz PAD_A_18
    v_pk_mul_f32 v[140:141], v[142:143], v[136:137] op_sel:[0,0] op_sel_hi:[0,1]
    v_pk_fma_f32 v[40:41], v[42:43], v[36:37], v[40:41] op_sel:[1,1,0] op_sel_hi:[1,0,1] neg_lo:[1,0,0]
    v_pk_fma_f32 v[140:141], v[142:143], v[136:137], v[140:141] op_sel:[1,1,0] op_sel_hi:[1,0,1] neg_lo:[1,0,0]
    v_cvt_pk_bf16_f32 v9, v40, v41
    v_cvt_pk_bf16_f32 v109, v140, v141
    ds_write_b32 v5, v9 offset:6624
    ds_write_b32 v5, v109 offset:43488
    v_pk_mul_f32 v[42:43], v[40:41], v[36:37] op_sel:[0,0] op_sel_hi:[0,1]
    v_pk_mul_f32 v[142:143], v[140:141], v[136:137] op_sel:[0,0] op_sel_hi:[0,1]
    v_pk_fma_f32 v[42:43], v[40:41], v[36:37], v[42:43] op_sel:[1,1,0] op_sel_hi:[1,0,1] neg_lo:[1,0,0]
    v_pk_fma_f32 v[142:143], v[140:141], v[136:137], v[142:143] op_sel:[1,1,0] op_sel_hi:[1,0,1] neg_lo:[1,0,0]
    v_cvt_pk_bf16_f32 v8, v42, v43
    v_cvt_pk_bf16_f32 v108, v142, v143
    ds_write_b32 v5, v8 offset:6912
    ds_write_b32 v5, v108 offset:43776
    ds_read_b128 v[76:79], v6 offset:4608
    ds_read_b128 v[176:179], v6 offset:41472
    ds_read_b128 v[80:83], v6 offset:4672
    ds_read_b128 v[180:183], v6 offset:41536
    ds_read_b128 v[84:87], v6 offset:4736
    ds_read_b128 v[184:187], v6 offset:41600
    ds_read_b128 v[88:91], v6 offset:4800
    ds_read_b128 v[188:191], v6 offset:41664
    s_waitcnt lgkmcnt(7)
    v_mfma_f32_16x16x32_bf16 v[100:103], v[76:79], v[60:63], 0
    s_waitcnt lgkmcnt(6)
    v_mfma_f32_16x16x32_bf16 v[200:203], v[176:179], v[160:163], 0
    s_waitcnt lgkmcnt(5)
    v_mfma_f32_16x16x32_bf16 v[100:103], v[80:83], v[64:67], v[100:103]
    s_waitcnt lgkmcnt(4)
    v_mfma_f32_16x16x32_bf16 v[200:203], v[180:183], v[164:167], v[200:203]
    s_waitcnt lgkmcnt(3)
    v_mfma_f32_16x16x32_bf16 v[100:103], v[84:87], v[68:71], v[100:103]
    s_waitcnt lgkmcnt(2)
    v_mfma_f32_16x16x32_bf16 v[200:203], v[184:187], v[168:171], v[200:203]
    s_waitcnt lgkmcnt(1)
    v_mfma_f32_16x16x32_bf16 v[100:103], v[88:91], v[72:75], v[100:103]
    s_waitcnt lgkmcnt(0)
PAD_A_18:
    s_cbranch_execz PRET_A
    v_mfma_f32_16x16x32_bf16 v[200:203], v[188:191], v[172:175], v[200:203]
    ds_write_b128 v7, v[92:95] offset:0
    ds_write_b128 v7, v[192:195] offset:12288
    ds_write_b128 v7, v[96:99] offset:1024
    ds_write_b128 v7, v[196:199] offset:13312
    s_cmp_lg_u32 s6, 0
    s_cbranch_scc1 SKIP_5
    s_mov_b32 s7, s90
    s_add_u32 s8, s7, 131072
    buffer_load_dwordx4 v[248:251], v254, s[20:23], s7 offen sc1
    buffer_load_dwordx4 v[244:247], v254, s[20:23], s8 offen sc1
SKIP_5:
    ds_write_b128 v7, v[100:103] offset:2048
    s_nop 0
    ds_write_b128 v7, v[200:203] offset:14336
    v_lshlrev_b32 v3, 4, v0
    v_lshlrev_b32 v5, 7, v0
    s_waitcnt lgkmcnt(0)
    s_cmp_lg_u32 s6, 0
    s_cbranch_scc1 SKIP_7
    s_add_u32 s3, s88, 1
    s_mov_b32 s92, 30000
    s_mov_b32 s7, s90
    s_add_u32 s8, s7, 131072
    s_waitcnt vmcnt(0)
    s_branch PCHK_11
POLL_9:
    buffer_load_dwordx4 v[248:251], v254, s[20:23], s7 offen sc1
    buffer_load_dwordx4 v[244:247], v254, s[20:23], s8 offen sc1
    s_waitcnt vmcnt(0)
PCHK_11:
    v_subrev_u32 v248, s3, v248
    v_subrev_u32 v249, s3, v249
    v_subrev_u32 v250, s3, v250
    v_subrev_u32 v251, s3, v251
    v_max3_u32 v248, v248, v249, v250
    v_xor_b32 v244, s101, v244
    v_xor_b32 v245, s101, v245
    v_xor_b32 v246, s101, v246
    v_xor_b32 v247, s101, v247
    v_or3_b32 v244, v244, v245, v246
    v_or_b32 v244, v244, v247
    v_cmp_ne_u32 vcc, 0, v244
    s_nop 1
    v_cndmask_b32 v244, 0, -1, vcc
    v_max_u32 v248, v248, v244
    v_max_u32 v248, v248, v251
    v_cmp_lt_u32 vcc, 7, v248
    s_and_b64 exec, vcc, exec
    s_cbranch_scc0 PDONE_10
    s_sub_u32 s92, s92, 1
    s_cmp_lg_u32 s92, 0
    s_cbranch_scc1 POLL_9
PDONE_10:
    s_mov_b64 exec, -1
SKIP_7:
    s_barrier
    s_lshl_b32 s11, s93, 13
    s_mov_b32 s13, 327680
    buffer_load_dwordx4 v[224:227], v5, s[20:23], s13 offen
    buffer_load_dwordx4 v[232:235], v5, s[20:23], s13 offen offset:32
    buffer_load_dwordx4 v[228:231], v5, s[20:23], s13 offen offset:16
    buffer_load_dwordx4 v[236:239], v5, s[20:23], s13 offen offset:48
PAD_A_19:
    s_cbranch_execz PRET_A
    s_add_u32 s14, s11, 14680064
    s_add_u32 s15, s11, 14684160
    buffer_load_dwordx4 v[240:243], v3, s[20:23], s14 offen sc1
    buffer_load_dwordx4 v[244:247], v3, s[20:23], s15 offen sc1
    v_lshlrev_b32 v7, 2, v0
    v_add_u32 v7, 91136, v7
    ds_read_b32 v40, v7 offset:0
    ds_read_b32 v41, v7 offset:3072
    ds_read_b32 v42, v7 offset:6144
    ds_read_b32 v43, v7 offset:9216
    ds_read_b32 v44, v7 offset:1024
    ds_read_b32 v45, v7 offset:4096
    ds_read_b32 v46, v7 offset:7168
    ds_read_b32 v47, v7 offset:10240
    ds_read_b32 v48, v7 offset:2048
    ds_read_b32 v49, v7 offset:5120
    ds_read_b32 v50, v7 offset:8192
    ds_read_b32 v51, v7 offset:11264
    ds_read_b32 v140, v7 offset:12288
    ds_read_b32 v141, v7 offset:15360
    ds_read_b32 v142, v7 offset:18432
    ds_read_b32 v143, v7 offset:21504
    ds_read_b32 v144, v7 offset:13312
    ds_read_b32 v145, v7 offset:16384
    ds_read_b32 v146, v7 offset:19456
    ds_read_b32 v147, v7 offset:22528
    ds_read_b32 v148, v7 offset:14336
    ds_read_b32 v149, v7 offset:17408
    ds_read_b32 v150, v7 offset:20480
    ds_read_b32 v151, v7 offset:23552
    v_and_b32 v8, 3, v0
    v_bfe_u32 v9, v0, 2, 4
    s_lshr_b32 s19, s6, 1
    s_lshl_b32 s19, s19, 7
    s_and_b32 s18, s6, 1
    s_lshl_b32 s18, s18, 2
    s_add_u32 s19, s19, s18
    v_lshl_add_u32 v10, v9, 3, v8
    v_add_u32 v10, s19, v10
    v_lshl_add_u32 v11, v9, 2, v8
    s_lshl_b32 s19, s6, 6
    s_add_u32 s19, s19, 256
    v_add_u32 v11, s19, v11
    v_and_b32 v12, 1, v8
    v_lshrrev_b32 v13, 1, v8
    v_lshl_add_u32 v12, v13, 5, v12
PAD_A_20:
    s_cbranch_execz PAD_A_21
    v_lshl_add_u32 v12, v9, 1, v12
    v_add_u32 v12, s19, v12
    s_cmp_lt_u32 s6, 2
    s_cselect_b64 vcc, -1, 0
    v_cndmask_b32 v11, v12, v11, vcc
    v_lshl_add_u32 v12, v8, 4, v9
    s_lshl_b32 s19, s6, 6
    s_add_u32 s19, s19, 512
    v_add_u32 v12, s19, v12
    v_lshlrev_b32 v10, 2, v10
    v_lshlrev_b32 v11, 2, v11
    v_lshlrev_b32 v12, 2, v12
    s_waitcnt lgkmcnt(15)
    v_add_f32 v40, v40, v41
    v_add_f32 v42, v42, v43
    v_add_f32 v40, v40, v42
    v_add_f32 v44, v44, v45
    v_add_f32 v46, v46, v47
    v_add_f32 v44, v44, v46
    s_waitcnt lgkmcnt(14)
    v_add_f32 v48, v48, v49
    s_waitcnt lgkmcnt(12)
    v_add_f32 v50, v50, v51
    v_add_f32 v48, v48, v50
    s_waitcnt lgkmcnt(10)
    v_add_f32 v140, v140, v141
    s_waitcnt lgkmcnt(8)
    v_add_f32 v142, v142, v143
    v_add_f32 v140, v140, v142
    s_waitcnt lgkmcnt(6)
    v_add_f32 v144, v144, v145
    s_waitcnt lgkmcnt(4)
    v_add_f32 v146, v146, v147
    v_add_f32 v144, v144, v146
    s_waitcnt lgkmcnt(2)
    v_add_f32 v148, v148, v149
    s_waitcnt lgkmcnt(0)
    v_add_f32 v150, v150, v151
    v_add_f32 v148, v148, v150
    ds_write_b32 v10, v40 offset:17408
    ds_write_b32 v11, v44 offset:17408
    ds_write_b32 v12, v48 offset:17408
    ds_write_b32 v10, v140 offset:21504
    ds_write_b32 v11, v144 offset:21504
    ds_write_b32 v12, v148 offset:21504
    v_mov_b32 v13, 0
    v_mov_b32 v14, 3072
    ds_write_b32 v14, v13 offset:17408
    ds_write_b32 v14, v13 offset:21504
    v_lshlrev_b32 v15, 3, v0
    v_sub_u32 v15, 2047, v15
    v_cvt_f32_u32 v16, v15
    v_mov_b32 v17, 0x43000000
    v_cmp_le_u32 vcc, 240, v0
    s_nop 1
    v_cndmask_b32 v18, 0, v17, vcc
    v_add_f32 v16, v16, v18
    v_mov_b32 v19, 0xfffef600
    v_mov_b32 v20, 0xfffef400
    v_cndmask_b32 v19, v19, v20, vcc
    v_mov_b32 v22, v16
    v_add_f32 v23, 0xbf800000, v16
    v_add_f32 v24, 0xc0000000, v16
PAD_A_21:
    s_cbranch_execz PRET_A
    v_add_f32 v25, 0xc0400000, v16
    v_add_f32 v26, 0xc0800000, v16
    v_add_f32 v27, 0xc0a00000, v16
    v_add_f32 v28, 0xc0c00000, v16
    v_add_f32 v29, 0xc0e00000, v16
    v_cvt_f32_u32 v30, v15
    v_add_f32 v30, 0xc1000000, v30
    v_cmp_le_u32 vcc, 239, v0
    s_nop 1
    v_cndmask_b32 v18, 0, v17, vcc
    v_add_f32 v30, v30, v18
    v_mov_b32 v21, 0xfffef600
    v_cndmask_b32 v21, v21, v20, vcc
    v_cvt_pk_bf16_f32 v32, v22, v23
    v_cvt_pk_bf16_f32 v33, v24, v25
    v_cvt_pk_bf16_f32 v34, v26, v27
    v_cvt_pk_bf16_f32 v35, v28, v29
    v_cvt_pk_bf16_f32 v36, v30, v30
    v_mad_u32_u16 v22, v32, 4, v19 op_sel:[0,0,0,0]
    v_mad_u32_u16 v23, v32, 4, v19 op_sel:[1,0,0,0]
    v_mad_u32_u16 v24, v33, 4, v19 op_sel:[0,0,0,0]
    v_mad_u32_u16 v25, v33, 4, v19 op_sel:[1,0,0,0]
    v_mad_u32_u16 v26, v34, 4, v19 op_sel:[0,0,0,0]
    v_mad_u32_u16 v27, v34, 4, v19 op_sel:[1,0,0,0]
    v_mad_u32_u16 v28, v35, 4, v19 op_sel:[0,0,0,0]
    v_mad_u32_u16 v29, v35, 4, v19 op_sel:[1,0,0,0]
    v_mad_u32_u16 v30, v36, 4, v21 op_sel:[0,0,0,0]
    v_cmp_eq_u32 vcc, 255, v0
    s_nop 1
    v_cndmask_b32 v30, v30, v14, vcc
    s_waitcnt vmcnt(6)
    s_waitcnt lgkmcnt(0)
    s_barrier
    s_cmp_lg_u32 s6, 0
    s_cbranch_scc1 SKIP_12
    s_add_u32 s92, s88, 2
    v_mov_b32 v253, s92
    v_lshlrev_b32 v252, 10, v2
    buffer_store_dword v253, v252, s[20:23], s89 offen sc1
    s_mov_b64 exec, -1
SKIP_12:
    ds_read_b32 v40, v22 offset:17408
    ds_read_b32 v41, v23 offset:17408
    ds_read_b32 v42, v24 offset:17408
    ds_read_b32 v43, v25 offset:17408
    ds_read_b32 v44, v26 offset:17408
    ds_read_b32 v45, v27 offset:17408
    ds_read_b32 v46, v28 offset:17408
    ds_read_b32 v47, v29 offset:17408
PAD_A_22:
    s_cbranch_execz PRET_A
    ds_read_b32 v48, v30 offset:17408
    ds_read_b32 v140, v22 offset:21504
    ds_read_b32 v141, v23 offset:21504
    ds_read_b32 v142, v24 offset:21504
    ds_read_b32 v143, v25 offset:21504
    ds_read_b32 v144, v26 offset:21504
    ds_read_b32 v145, v27 offset:21504
    ds_read_b32 v146, v28 offset:21504
    ds_read_b32 v147, v29 offset:21504
    ds_read_b32 v148, v30 offset:21504
    v_lshlrev_b32 v7, 4, v0
    s_waitcnt lgkmcnt(15)
    v_cvt_pk_bf16_f32 v52, v40, v41
    s_waitcnt lgkmcnt(14)
    v_cvt_pk_bf16_f32 v53, v42, v43
    s_waitcnt lgkmcnt(12)
    v_cvt_pk_bf16_f32 v54, v44, v45
    s_waitcnt lgkmcnt(10)
    v_cvt_pk_bf16_f32 v55, v46, v47
    v_cvt_pk_bf16_f32 v56, v41, v42
    v_cvt_pk_bf16_f32 v57, v43, v44
    v_cvt_pk_bf16_f32 v58, v45, v46
    s_waitcnt lgkmcnt(9)
    v_cvt_pk_bf16_f32 v59, v47, v48
    ds_write_b128 v7, v[52:55] offset:0
    ds_write_b128 v7, v[56:59] offset:4160
    s_waitcnt lgkmcnt(9)
    v_cvt_pk_bf16_f32 v152, v140, v141
    s_waitcnt lgkmcnt(7)
    v_cvt_pk_bf16_f32 v153, v142, v143
    s_waitcnt lgkmcnt(5)
    v_cvt_pk_bf16_f32 v154, v144, v145
    s_waitcnt lgkmcnt(3)
    v_cvt_pk_bf16_f32 v155, v146, v147
    v_cvt_pk_bf16_f32 v156, v141, v142
    v_cvt_pk_bf16_f32 v157, v143, v144
    v_cvt_pk_bf16_f32 v158, v145, v146
    s_waitcnt lgkmcnt(2)
    v_cvt_pk_bf16_f32 v159, v147, v148
    ds_write_b128 v7, v[152:155] offset:8320
    ds_write_b128 v7, v[156:159] offset:12480
    v_mov_b32 v60, 0
    v_mov_b32 v61, 0
    v_mov_b32 v62, 0
    v_mov_b32 v63, 0
    v_add_u32 v8, 4096, v7
    v_add_u32 v9, 8192, v7
    v_cmp_le_u32 vcc, 4, v0
PAD_A_23:
    s_cbranch_execz PRET_A
    s_nop 1
    v_cndmask_b32 v8, v8, v9, vcc
    s_cmp_lg_u32 s6, 0
    s_cbranch_scc1 SKIP_14
    s_mov_b64 exec, 0xff
    ds_write_b128 v8, v[60:63] offset:0
    ds_write_b128 v8, v[60:63] offset:8320
    s_mov_b64 exec, -1
SKIP_14:
    s_waitcnt lgkmcnt(0)
    s_barrier
    v_lshlrev_b32 v3, 4, v0
    v_lshlrev_b32 v4, 4, v2
    v_lshlrev_b32 v5, 7, v0
    v_and_b32 v6, 15, v2
    v_lshrrev_b32 v7, 4, v2
    s_and_b32 s17, s6, 1
    s_lshr_b32 s18, s6, 1
    v_lshlrev_b32 v32, 1, v6
    v_sub_u32 v33, 30, v32
    v_sub_u32 v34, 4188, v32
    v_and_b32 v35, 1, v6
    v_cmp_eq_u32 vcc, 1, v35
    s_nop 1
    v_cndmask_b32 v33, v34, v33, vcc
    v_lshl_add_u32 v33, v7, 4, v33
    s_mul_i32 s19, s17, 8320
    s_lshl_b32 s24, s18, 8
    s_sub_u32 s19, s19, s24
    s_add_u32 s19, s19, 256
    v_add_u32 v36, s19, v33
    v_add_u32 v37, 1024, v36
    v_add_u32 v38, 2048, v36
    v_add_u32 v39, 3072, v36
    v_lshlrev_b32 v32, 5, v6
    v_lshl_add_u32 v32, v7, 4, v32
    s_mul_i32 s19, s17, 4608
    s_sub_u32 s19, s19, s24
    s_add_u32 s19, s19, 17696
    v_add_u32 v40, s19, v32
    s_lshl_b32 s26, s95, 1
    s_lshr_b32 s27, s6, 1
    s_add_u32 s26, s26, s27
    s_xor_b32 s27, s26, 1
    s_mul_i32 s26, s26, 114688
    s_mul_i32 s27, s27, 114688
    s_mul_i32 s28, s6, 28672
    s_add_u32 s28, s28, 12582912
    s_add_u32 s48, s26, s28
    s_add_u32 s52, s27, s28
    s_add_u32 s49, s48, 7168
    s_add_u32 s53, s52, 7168
    s_add_u32 s50, s48, 14336
    s_add_u32 s54, s52, 14336
    s_add_u32 s51, s48, 21504
    s_add_u32 s55, s52, 21504
    s_lshl_b32 s11, s93, 13
    v_mov_b32 v32, 0
PAD_A_24:
    s_cbranch_execz PAD_A_25
    v_mov_b32 v33, 0
    v_mov_b32 v34, 0
    v_mov_b32 v35, 0
    v_and_b32 v6, 31, v0
    v_lshlrev_b32 v6, 4, v6
    ds_write_b128 v6, v[32:35] offset:17408
    ds_write_b128 v6, v[32:35] offset:22016
    s_add_u32 s11, s11, 2097152
    s_add_u32 s12, s11, 4096
    s_lshl_b32 s37, s86, 16
    s_and_b32 s38, s86, 0xffff0000
    v_lshrrev_b32 v41, 5, v2
    v_lshlrev_b32 v41, 7, v41
    v_add_u32 v41, v41, v4
    s_mul_i32 s19, s6, 9216
    v_add_u32 v41, s19, v41
    v_lshrrev_b32 v42, 5, v0
    v_mul_u32_u24 v42, 1152, v42
    v_bfe_u32 v32, v0, 1, 4
    v_lshl_add_u32 v42, v32, 4, v42
    v_and_b32 v32, 1, v0
    v_mul_u32_u24 v32, 640, v32
    v_add_u32 v42, v42, v32
    s_waitcnt vmcnt(5)
    v_mul_f32 v224, 0x3b124925, v224
    s_waitcnt vmcnt(4)
    v_mul_f32 v232, 0x3b124925, v232
    v_mul_f32 v225, 0x3b124925, v225
    v_mul_f32 v233, 0x3b124925, v233
    v_mul_f32 v226, 0x3b124925, v226
    v_mul_f32 v234, 0x3b124925, v234
    v_mul_f32 v227, 0x3b124925, v227
    v_mul_f32 v235, 0x3b124925, v235
    s_waitcnt vmcnt(3)
    v_mul_f32 v228, 0x3b124925, v228
    s_waitcnt vmcnt(2)
    v_mul_f32 v236, 0x3b124925, v236
    v_mul_f32 v229, 0x3b124925, v229
    v_mul_f32 v237, 0x3b124925, v237
    v_mul_f32 v230, 0x3b124925, v230
    v_mul_f32 v238, 0x3b124925, v238
    v_mul_f32 v231, 0x3b124925, v231
    v_mul_f32 v239, 0x3b124925, v239
    v_fma_f32 v232, -v224, v224, v232
    v_max_f32 v232, 0, v232
    v_fma_f32 v233, -v225, v225, v233
    v_max_f32 v233, 0, v233
    v_fma_f32 v234, -v226, v226, v234
    v_max_f32 v234, 0, v234
    v_fma_f32 v235, -v227, v227, v235
PAD_A_25:
    s_cbranch_execz PRET_A
    v_max_f32 v235, 0, v235
    v_fma_f32 v236, -v228, v228, v236
    v_max_f32 v236, 0, v236
    v_fma_f32 v237, -v229, v229, v237
    v_max_f32 v237, 0, v237
    v_fma_f32 v238, -v230, v230, v238
    v_max_f32 v238, 0, v238
    v_fma_f32 v239, -v231, v231, v239
    v_max_f32 v239, 0, v239
    v_cvt_pk_bf16_f32 v32, v224, v225
    v_lshlrev_b32 v224, 16, v32
    v_and_b32 v225, 0xffff0000, v32
    v_cvt_pk_bf16_f32 v33, v232, v233
    v_lshlrev_b32 v232, 16, v33
    v_and_b32 v233, 0xffff0000, v33
    v_cvt_pk_bf16_f32 v32, v226, v227
    v_lshlrev_b32 v226, 16, v32
    v_and_b32 v227, 0xffff0000, v32
    v_cvt_pk_bf16_f32 v33, v234, v235
    v_lshlrev_b32 v234, 16, v33
    v_and_b32 v235, 0xffff0000, v33
    v_cvt_pk_bf16_f32 v32, v228, v229
    v_lshlrev_b32 v228, 16, v32
    v_and_b32 v229, 0xffff0000, v32
    v_cvt_pk_bf16_f32 v33, v236, v237
    v_lshlrev_b32 v236, 16, v33
    v_and_b32 v237, 0xffff0000, v33
    v_cvt_pk_bf16_f32 v32, v230, v231
    v_lshlrev_b32 v230, 16, v32
    v_and_b32 v231, 0xffff0000, v32
    v_cvt_pk_bf16_f32 v33, v238, v239
    v_lshlrev_b32 v238, 16, v33
    v_and_b32 v239, 0xffff0000, v33
    v_add_f32 v232, 0x3727c5ac, v232
    v_add_f32 v233, 0x3727c5ac, v233
    v_add_f32 v234, 0x3727c5ac, v234
    v_add_f32 v235, 0x3727c5ac, v235
    v_add_f32 v236, 0x3727c5ac, v236
    v_add_f32 v237, 0x3727c5ac, v237
    v_add_f32 v238, 0x3727c5ac, v238
    v_add_f32 v239, 0x3727c5ac, v239
    v_cvt_pk_bf16_f32 v32, v232, v233
    v_lshlrev_b32 v232, 16, v32
    v_and_b32 v233, 0xffff0000, v32
    v_cvt_pk_bf16_f32 v33, v234, v235
    v_lshlrev_b32 v234, 16, v33
    v_and_b32 v235, 0xffff0000, v33
PAD_A_26:
    s_cbranch_execz PRET_A
    v_cvt_pk_bf16_f32 v32, v236, v237
    v_lshlrev_b32 v236, 16, v32
    v_and_b32 v237, 0xffff0000, v32
    v_cvt_pk_bf16_f32 v33, v238, v239
    v_lshlrev_b32 v238, 16, v33
    v_and_b32 v239, 0xffff0000, v33
    v_sqrt_f32 v232, v232
    v_sqrt_f32 v233, v233
    v_sqrt_f32 v234, v234
    v_sqrt_f32 v235, v235
    v_sqrt_f32 v236, v236
    v_sqrt_f32 v237, v237
    v_sqrt_f32 v238, v238
    v_sqrt_f32 v239, v239
    v_cvt_pk_bf16_f32 v32, v232, v233
    v_lshlrev_b32 v232, 16, v32
    v_and_b32 v233, 0xffff0000, v32
    v_cvt_pk_bf16_f32 v33, v234, v235
    v_lshlrev_b32 v234, 16, v33
    v_and_b32 v235, 0xffff0000, v33
    v_cvt_pk_bf16_f32 v32, v236, v237
    v_lshlrev_b32 v236, 16, v32
    v_and_b32 v237, 0xffff0000, v32
    v_cvt_pk_bf16_f32 v33, v238, v239
    v_lshlrev_b32 v238, 16, v33
    v_and_b32 v239, 0xffff0000, v33
    v_rcp_f32 v232, v232
    v_rcp_f32 v233, v233
    v_rcp_f32 v234, v234
    v_rcp_f32 v235, v235
    v_rcp_f32 v236, v236
    v_rcp_f32 v237, v237
    v_rcp_f32 v238, v238
    v_rcp_f32 v239, v239
    v_mul_f32 v224, -v224, v232
    v_mul_f32 v225, -v225, v233
    v_mul_f32 v226, -v226, v234
    v_mul_f32 v227, -v227, v235
    v_mul_f32 v228, -v228, v236
    v_mul_f32 v229, -v229, v237
    v_mul_f32 v230, -v230, v238
    v_mul_f32 v231, -v231, v239
    s_waitcnt vmcnt(1)
    v_lshlrev_b32 v52, 16, v240
    v_and_b32 v53, 0xffff0000, v240
    v_fma_f32 v52, v52, v232, v224
    v_fma_f32 v53, v53, v233, v225
    v_cvt_pk_bf16_f32 v44, v52, v53
    v_lshlrev_b32 v54, 16, v241
    v_and_b32 v55, 0xffff0000, v241
    v_fma_f32 v54, v54, v234, v226
    v_fma_f32 v55, v55, v235, v227
PAD_A_27:
    s_cbranch_execz PRET_A
    v_cvt_pk_bf16_f32 v45, v54, v55
    v_lshlrev_b32 v52, 16, v242
    v_and_b32 v53, 0xffff0000, v242
    v_fma_f32 v52, v52, v236, v228
    v_fma_f32 v53, v53, v237, v229
    v_cvt_pk_bf16_f32 v46, v52, v53
    v_lshlrev_b32 v54, 16, v243
    v_and_b32 v55, 0xffff0000, v243
    v_fma_f32 v54, v54, v238, v230
    v_fma_f32 v55, v55, v239, v231
    v_cvt_pk_bf16_f32 v47, v54, v55
    ds_write_b128 v3, v[44:47] offset:17920
    s_waitcnt vmcnt(0)
    v_lshlrev_b32 v56, 16, v244
    v_and_b32 v57, 0xffff0000, v244
    v_fma_f32 v56, v56, v232, v224
    v_fma_f32 v57, v57, v233, v225
    v_cvt_pk_bf16_f32 v48, v56, v57
    v_lshlrev_b32 v58, 16, v245
    v_and_b32 v59, 0xffff0000, v245
    v_fma_f32 v58, v58, v234, v226
    v_fma_f32 v59, v59, v235, v227
    v_cvt_pk_bf16_f32 v49, v58, v59
    v_lshlrev_b32 v56, 16, v246
    v_and_b32 v57, 0xffff0000, v246
    v_fma_f32 v56, v56, v236, v228
    v_fma_f32 v57, v57, v237, v229
    v_cvt_pk_bf16_f32 v50, v56, v57
    v_lshlrev_b32 v58, 16, v247
    v_and_b32 v59, 0xffff0000, v247
    v_fma_f32 v58, v58, v238, v230
    v_fma_f32 v59, v59, v239, v231
    v_cvt_pk_bf16_f32 v51, v58, v59
    ds_write_b128 v3, v[48:51] offset:22528
    s_waitcnt lgkmcnt(0)
    s_barrier
    ds_read2_b32 v[96:97], v39 offset0:176 offset1:177
    ds_read2_b32 v[98:99], v39 offset0:178 offset1:179
    ds_read_b128 v[160:163], v40 offset:192
    ds_read_b128 v[164:167], v40 offset:704
    ds_read_b128 v[168:171], v40 offset:1216
    ds_read_b128 v[172:175], v40 offset:1728
    ds_read_b128 v[176:179], v40 offset:2240
    ds_read_b128 v[180:183], v40 offset:2752
PAD_A_28:
    s_cbranch_execz PAD_A_29
    ds_read_b128 v[184:187], v40 offset:3264
    ds_read_b128 v[188:191], v40 offset:3776
    ds_read2_b32 v[100:101], v39 offset0:48 offset1:49
    ds_read2_b32 v[102:103], v39 offset0:50 offset1:51
    ds_read2_b32 v[104:105], v38 offset0:176 offset1:177
    ds_read2_b32 v[106:107], v38 offset0:178 offset1:179
    ds_read2_b32 v[108:109], v38 offset0:48 offset1:49
    ds_read2_b32 v[110:111], v38 offset0:50 offset1:51
    ds_read2_b32 v[112:113], v37 offset0:176 offset1:177
    ds_read2_b32 v[114:115], v37 offset0:178 offset1:179
    ds_read2_b32 v[116:117], v37 offset0:48 offset1:49
    ds_read2_b32 v[118:119], v37 offset0:50 offset1:51
    ds_read2_b32 v[120:121], v36 offset0:176 offset1:177
    ds_read2_b32 v[122:123], v36 offset0:178 offset1:179
    ds_read2_b32 v[124:125], v36 offset0:48 offset1:49
    ds_read2_b32 v[126:127], v36 offset0:50 offset1:51
    s_waitcnt lgkmcnt(15)
    v_mfma_f32_16x16x32_bf16 v[64:67], v[96:99], v[160:163], 0
    ds_read2_b32 v[128:129], v39 offset0:160 offset1:161
    v_mfma_f32_16x16x32_bf16 v[68:71], v[96:99], v[164:167], 0
    ds_read2_b32 v[130:131], v39 offset0:162 offset1:163
    v_mfma_f32_16x16x32_bf16 v[72:75], v[96:99], v[168:171], 0
    ds_read_b128 v[192:195], v40 offset:128
    v_mfma_f32_16x16x32_bf16 v[76:79], v[96:99], v[172:175], 0
    ds_read_b128 v[196:199], v40 offset:640
    v_mfma_f32_16x16x32_bf16 v[80:83], v[96:99], v[176:179], 0
    ds_read_b128 v[200:203], v40 offset:1152
    v_mfma_f32_16x16x32_bf16 v[84:87], v[96:99], v[180:183], 0
    ds_read_b128 v[204:207], v40 offset:1664
    v_mfma_f32_16x16x32_bf16 v[88:91], v[96:99], v[184:187], 0
    ds_read_b128 v[208:211], v40 offset:2176
    s_waitcnt lgkmcnt(15)
    v_mfma_f32_16x16x32_bf16 v[92:95], v[96:99], v[188:191], 0
    ds_read_b128 v[212:215], v40 offset:2688
    v_mfma_f32_16x16x32_bf16 v[68:71], v[100:103], v[160:163], v[68:71]
    ds_read_b128 v[216:219], v40 offset:3200
    v_mfma_f32_16x16x32_bf16 v[72:75], v[100:103], v[164:167], v[72:75]
    ds_read_b128 v[220:223], v40 offset:3712
    v_mfma_f32_16x16x32_bf16 v[76:79], v[100:103], v[168:171], v[76:79]
    ds_read2_b32 v[132:133], v39 offset0:32 offset1:33
    v_mfma_f32_16x16x32_bf16 v[80:83], v[100:103], v[172:175], v[80:83]
PAD_A_29:
    s_cbranch_execz PRET_A
    ds_read2_b32 v[134:135], v39 offset0:34 offset1:35
    v_mfma_f32_16x16x32_bf16 v[84:87], v[100:103], v[176:179], v[84:87]
    ds_read2_b32 v[136:137], v38 offset0:160 offset1:161
    v_mfma_f32_16x16x32_bf16 v[88:91], v[100:103], v[180:183], v[88:91]
    ds_read2_b32 v[138:139], v38 offset0:162 offset1:163
    v_mfma_f32_16x16x32_bf16 v[92:95], v[100:103], v[184:187], v[92:95]
    ds_read2_b32 v[140:141], v38 offset0:32 offset1:33
    v_mfma_f32_16x16x32_bf16 v[72:75], v[104:107], v[160:163], v[72:75]
    ds_read2_b32 v[142:143], v38 offset0:34 offset1:35
    v_mfma_f32_16x16x32_bf16 v[76:79], v[104:107], v[164:167], v[76:79]
    ds_read2_b32 v[144:145], v37 offset0:160 offset1:161
    v_mfma_f32_16x16x32_bf16 v[80:83], v[104:107], v[168:171], v[80:83]
    ds_read2_b32 v[146:147], v37 offset0:162 offset1:163
    v_mfma_f32_16x16x32_bf16 v[84:87], v[104:107], v[172:175], v[84:87]
    ds_read2_b32 v[148:149], v37 offset0:32 offset1:33
    v_mfma_f32_16x16x32_bf16 v[88:91], v[104:107], v[176:179], v[88:91]
    ds_read2_b32 v[150:151], v37 offset0:34 offset1:35
    v_mfma_f32_16x16x32_bf16 v[92:95], v[104:107], v[180:183], v[92:95]
    ds_read2_b32 v[152:153], v36 offset0:160 offset1:161
    v_mfma_f32_16x16x32_bf16 v[76:79], v[108:111], v[160:163], v[76:79]
    ds_read2_b32 v[154:155], v36 offset0:162 offset1:163
    v_mfma_f32_16x16x32_bf16 v[80:83], v[108:111], v[164:167], v[80:83]
    ds_read2_b32 v[156:157], v36 offset0:32 offset1:33
    v_mfma_f32_16x16x32_bf16 v[84:87], v[108:111], v[168:171], v[84:87]
    ds_read2_b32 v[158:159], v36 offset0:34 offset1:35
    v_mfma_f32_16x16x32_bf16 v[88:91], v[108:111], v[172:175], v[88:91]
    v_lshlrev_b32 v52, 16, v44
    v_and_b32 v53, 0xffff0000, v44
    v_mfma_f32_16x16x32_bf16 v[92:95], v[108:111], v[176:179], v[92:95]
    v_lshlrev_b32 v224, 16, v240
    v_and_b32 v225, 0xffff0000, v240
    s_waitcnt lgkmcnt(15)
    v_mfma_f32_16x16x32_bf16 v[80:83], v[112:115], v[160:163], v[80:83]
    v_fma_f32 v224, v52, s37, v224
    v_fma_f32 v225, v53, s37, v225
    v_mfma_f32_16x16x32_bf16 v[84:87], v[112:115], v[164:167], v[84:87]
    v_lshlrev_b32 v54, 16, v45
    v_and_b32 v55, 0xffff0000, v45
    v_mfma_f32_16x16x32_bf16 v[88:91], v[112:115], v[168:171], v[88:91]
    v_lshlrev_b32 v226, 16, v241
    v_and_b32 v227, 0xffff0000, v241
    v_mfma_f32_16x16x32_bf16 v[92:95], v[112:115], v[172:175], v[92:95]
PAD_A_30:
    s_cbranch_execz PRET_A
    v_fma_f32 v226, v54, s37, v226
    v_fma_f32 v227, v55, s37, v227
    v_mfma_f32_16x16x32_bf16 v[84:87], v[116:119], v[160:163], v[84:87]
    v_lshlrev_b32 v56, 16, v46
    v_and_b32 v57, 0xffff0000, v46
    v_mfma_f32_16x16x32_bf16 v[88:91], v[116:119], v[164:167], v[88:91]
    v_lshlrev_b32 v228, 16, v242
    v_and_b32 v229, 0xffff0000, v242
    v_mfma_f32_16x16x32_bf16 v[92:95], v[116:119], v[168:171], v[92:95]
    v_fma_f32 v228, v56, s37, v228
    v_fma_f32 v229, v57, s37, v229
    v_mfma_f32_16x16x32_bf16 v[88:91], v[120:123], v[160:163], v[88:91]
    v_lshlrev_b32 v58, 16, v47
    v_and_b32 v59, 0xffff0000, v47
    v_mfma_f32_16x16x32_bf16 v[92:95], v[120:123], v[164:167], v[92:95]
    v_lshlrev_b32 v230, 16, v243
    v_and_b32 v231, 0xffff0000, v243
    v_mfma_f32_16x16x32_bf16 v[92:95], v[124:127], v[160:163], v[92:95]
    v_fma_f32 v230, v58, s37, v230
    v_fma_f32 v231, v59, s37, v231
    v_mfma_f32_16x16x32_bf16 v[64:67], v[128:131], v[192:195], v[64:67]
    ds_read2_b32 v[96:97], v39 offset0:144 offset1:145
    v_mfma_f32_16x16x32_bf16 v[68:71], v[128:131], v[196:199], v[68:71]
    ds_read2_b32 v[98:99], v39 offset0:146 offset1:147
    v_mfma_f32_16x16x32_bf16 v[72:75], v[128:131], v[200:203], v[72:75]
    ds_read_b128 v[160:163], v40 offset:64
    v_mfma_f32_16x16x32_bf16 v[76:79], v[128:131], v[204:207], v[76:79]
    ds_read_b128 v[164:167], v40 offset:576
    v_mfma_f32_16x16x32_bf16 v[80:83], v[128:131], v[208:211], v[80:83]
    ds_read_b128 v[168:171], v40 offset:1088
    v_mfma_f32_16x16x32_bf16 v[84:87], v[128:131], v[212:215], v[84:87]
    ds_read_b128 v[172:175], v40 offset:1600
    v_mfma_f32_16x16x32_bf16 v[88:91], v[128:131], v[216:219], v[88:91]
    ds_read_b128 v[176:179], v40 offset:2112
    s_waitcnt lgkmcnt(15)
    v_mfma_f32_16x16x32_bf16 v[92:95], v[128:131], v[220:223], v[92:95]
    ds_read_b128 v[180:183], v40 offset:2624
    v_mfma_f32_16x16x32_bf16 v[68:71], v[132:135], v[192:195], v[68:71]
    ds_read_b128 v[184:187], v40 offset:3136
    v_mfma_f32_16x16x32_bf16 v[72:75], v[132:135], v[196:199], v[72:75]
    ds_read_b128 v[188:191], v40 offset:3648
    v_mfma_f32_16x16x32_bf16 v[76:79], v[132:135], v[200:203], v[76:79]
PAD_A_31:
    s_cbranch_execz PRET_A
    ds_read2_b32 v[100:101], v39 offset0:16 offset1:17
    v_mfma_f32_16x16x32_bf16 v[80:83], v[132:135], v[204:207], v[80:83]
    ds_read2_b32 v[102:103], v39 offset0:18 offset1:19
    buffer_load_dwordx4 v[248:251], v254, s[20:23], s90 offen sc1
    v_mfma_f32_16x16x32_bf16 v[84:87], v[132:135], v[208:211], v[84:87]
    ds_read2_b32 v[104:105], v38 offset0:144 offset1:145
    v_mfma_f32_16x16x32_bf16 v[88:91], v[132:135], v[212:215], v[88:91]
    ds_read2_b32 v[106:107], v38 offset0:146 offset1:147
    v_mfma_f32_16x16x32_bf16 v[92:95], v[132:135], v[216:219], v[92:95]
    ds_read2_b32 v[108:109], v38 offset0:16 offset1:17
    v_mfma_f32_16x16x32_bf16 v[72:75], v[136:139], v[192:195], v[72:75]
    ds_read2_b32 v[110:111], v38 offset0:18 offset1:19
    v_mfma_f32_16x16x32_bf16 v[76:79], v[136:139], v[196:199], v[76:79]
    ds_read2_b32 v[112:113], v37 offset0:144 offset1:145
    v_mfma_f32_16x16x32_bf16 v[80:83], v[136:139], v[200:203], v[80:83]
    ds_read2_b32 v[114:115], v37 offset0:146 offset1:147
    v_mfma_f32_16x16x32_bf16 v[84:87], v[136:139], v[204:207], v[84:87]
    ds_read2_b32 v[116:117], v37 offset0:16 offset1:17
    v_mfma_f32_16x16x32_bf16 v[88:91], v[136:139], v[208:211], v[88:91]
    ds_read2_b32 v[118:119], v37 offset0:18 offset1:19
    v_mfma_f32_16x16x32_bf16 v[92:95], v[136:139], v[212:215], v[92:95]
    ds_read2_b32 v[120:121], v36 offset0:144 offset1:145
    v_mfma_f32_16x16x32_bf16 v[76:79], v[140:143], v[192:195], v[76:79]
    ds_read2_b32 v[122:123], v36 offset0:146 offset1:147
    v_mfma_f32_16x16x32_bf16 v[80:83], v[140:143], v[196:199], v[80:83]
    ds_read2_b32 v[124:125], v36 offset0:16 offset1:17
    v_mfma_f32_16x16x32_bf16 v[84:87], v[140:143], v[200:203], v[84:87]
    ds_read2_b32 v[126:127], v36 offset0:18 offset1:19
    v_mfma_f32_16x16x32_bf16 v[88:91], v[140:143], v[204:207], v[88:91]
    v_lshlrev_b32 v52, 16, v48
    v_and_b32 v53, 0xffff0000, v48
    v_mfma_f32_16x16x32_bf16 v[92:95], v[140:143], v[208:211], v[92:95]
    v_lshlrev_b32 v232, 16, v244
    v_and_b32 v233, 0xffff0000, v244
    s_waitcnt lgkmcnt(15)
    v_mfma_f32_16x16x32_bf16 v[80:83], v[144:147], v[192:195], v[80:83]
    v_fma_f32 v232, v52, s38, v232
    v_fma_f32 v233, v53, s38, v233
    v_mfma_f32_16x16x32_bf16 v[84:87], v[144:147], v[196:199], v[84:87]
    v_lshlrev_b32 v54, 16, v49
    v_and_b32 v55, 0xffff0000, v49
    v_mfma_f32_16x16x32_bf16 v[88:91], v[144:147], v[200:203], v[88:91]
PAD_A_32:
    s_cbranch_execz PAD_A_33
    v_lshlrev_b32 v234, 16, v245
    v_and_b32 v235, 0xffff0000, v245
    v_mfma_f32_16x16x32_bf16 v[92:95], v[144:147], v[204:207], v[92:95]
    v_fma_f32 v234, v54, s38, v234
    v_fma_f32 v235, v55, s38, v235
    v_mfma_f32_16x16x32_bf16 v[84:87], v[148:151], v[192:195], v[84:87]
    v_lshlrev_b32 v56, 16, v50
    v_and_b32 v57, 0xffff0000, v50
    v_mfma_f32_16x16x32_bf16 v[88:91], v[148:151], v[196:199], v[88:91]
    v_lshlrev_b32 v236, 16, v246
    v_and_b32 v237, 0xffff0000, v246
    v_mfma_f32_16x16x32_bf16 v[92:95], v[148:151], v[200:203], v[92:95]
    v_fma_f32 v236, v56, s38, v236
    v_fma_f32 v237, v57, s38, v237
    v_mfma_f32_16x16x32_bf16 v[88:91], v[152:155], v[192:195], v[88:91]
    v_lshlrev_b32 v58, 16, v51
    v_and_b32 v59, 0xffff0000, v51
    v_mfma_f32_16x16x32_bf16 v[92:95], v[152:155], v[196:199], v[92:95]
    v_lshlrev_b32 v238, 16, v247
    v_and_b32 v239, 0xffff0000, v247
    v_mfma_f32_16x16x32_bf16 v[92:95], v[156:159], v[192:195], v[92:95]
    v_fma_f32 v238, v58, s38, v238
    v_fma_f32 v239, v59, s38, v239
    v_mfma_f32_16x16x32_bf16 v[64:67], v[96:99], v[160:163], v[64:67]
    ds_read2_b32 v[128:129], v39 offset0:128 offset1:129
    v_mfma_f32_16x16x32_bf16 v[68:71], v[96:99], v[164:167], v[68:71]
    ds_read2_b32 v[130:131], v39 offset0:130 offset1:131
    v_mfma_f32_16x16x32_bf16 v[72:75], v[96:99], v[168:171], v[72:75]
    ds_read_b128 v[192:195], v40 offset:0
    v_mfma_f32_16x16x32_bf16 v[76:79], v[96:99], v[172:175], v[76:79]
    ds_read_b128 v[196:199], v40 offset:512
    v_mfma_f32_16x16x32_bf16 v[80:83], v[96:99], v[176:179], v[80:83]
    ds_read_b128 v[200:203], v40 offset:1024
    v_mfma_f32_16x16x32_bf16 v[84:87], v[96:99], v[180:183], v[84:87]
    ds_read_b128 v[204:207], v40 offset:1536
    v_mfma_f32_16x16x32_bf16 v[88:91], v[96:99], v[184:187], v[88:91]
    ds_read_b128 v[208:211], v40 offset:2048
    s_waitcnt lgkmcnt(15)
    v_mfma_f32_16x16x32_bf16 v[92:95], v[96:99], v[188:191], v[92:95]
    ds_read_b128 v[212:215], v40 offset:2560
    v_mfma_f32_16x16x32_bf16 v[68:71], v[100:103], v[160:163], v[68:71]
    ds_read_b128 v[216:219], v40 offset:3072
    v_mfma_f32_16x16x32_bf16 v[72:75], v[100:103], v[164:167], v[72:75]
PAD_A_33:
    s_cbranch_execz PRET_A
    ds_read_b128 v[220:223], v40 offset:3584
    v_mfma_f32_16x16x32_bf16 v[76:79], v[100:103], v[168:171], v[76:79]
    ds_read2_b32 v[132:133], v39 offset0:0 offset1:1
    v_mfma_f32_16x16x32_bf16 v[80:83], v[100:103], v[172:175], v[80:83]
    ds_read2_b32 v[134:135], v39 offset0:2 offset1:3
    v_mfma_f32_16x16x32_bf16 v[84:87], v[100:103], v[176:179], v[84:87]
    ds_read2_b32 v[136:137], v38 offset0:128 offset1:129
    v_mfma_f32_16x16x32_bf16 v[88:91], v[100:103], v[180:183], v[88:91]
    ds_read2_b32 v[138:139], v38 offset0:130 offset1:131
    v_mfma_f32_16x16x32_bf16 v[92:95], v[100:103], v[184:187], v[92:95]
    ds_read2_b32 v[140:141], v38 offset0:0 offset1:1
    v_mfma_f32_16x16x32_bf16 v[72:75], v[104:107], v[160:163], v[72:75]
    ds_read2_b32 v[142:143], v38 offset0:2 offset1:3
    v_mfma_f32_16x16x32_bf16 v[76:79], v[104:107], v[164:167], v[76:79]
    ds_read2_b32 v[144:145], v37 offset0:128 offset1:129
    v_mfma_f32_16x16x32_bf16 v[80:83], v[104:107], v[168:171], v[80:83]
    ds_read2_b32 v[146:147], v37 offset0:130 offset1:131
    v_mfma_f32_16x16x32_bf16 v[84:87], v[104:107], v[172:175], v[84:87]
    ds_read2_b32 v[148:149], v37 offset0:0 offset1:1
    v_mfma_f32_16x16x32_bf16 v[88:91], v[104:107], v[176:179], v[88:91]
    ds_read2_b32 v[150:151], v37 offset0:2 offset1:3
    v_mfma_f32_16x16x32_bf16 v[92:95], v[104:107], v[180:183], v[92:95]
    ds_read2_b32 v[152:153], v36 offset0:128 offset1:129
    v_mfma_f32_16x16x32_bf16 v[76:79], v[108:111], v[160:163], v[76:79]
    ds_read2_b32 v[154:155], v36 offset0:130 offset1:131
    v_mfma_f32_16x16x32_bf16 v[80:83], v[108:111], v[164:167], v[80:83]
    ds_read2_b32 v[156:157], v36 offset0:0 offset1:1
PAD_A_34:
    s_cbranch_execz PRET_A
    v_mfma_f32_16x16x32_bf16 v[84:87], v[108:111], v[168:171], v[84:87]
    ds_read2_b32 v[158:159], v36 offset0:2 offset1:3
    s_add_u32 s3, s88, 2
    s_mov_b32 s92, 30000
    s_branch PCHK_18
POLL_16:
    s_waitcnt vmcnt(0)
    buffer_load_dwordx4 v[248:251], v254, s[20:23], s90 offen sc1
PCHK_18:
    s_waitcnt vmcnt(0)
    s_waitcnt vmcnt(0)
    v_subrev_u32 v248, s3, v248
    v_subrev_u32 v249, s3, v249
    v_subrev_u32 v250, s3, v250
    v_subrev_u32 v251, s3, v251
    v_max3_u32 v248, v248, v249, v250
    v_max_u32 v248, v248, v251
    v_cmp_lt_u32 vcc, 7, v248
    s_and_b64 exec, vcc, exec
    s_cbranch_scc0 PDONE_17
    s_sub_u32 s92, s92, 1
    s_cmp_lg_u32 s92, 0
    s_cbranch_scc1 POLL_16
PDONE_17:
    s_mov_b64 exec, -1
    v_mfma_f32_16x16x32_bf16 v[88:91], v[108:111], v[172:175], v[88:91]
    s_add_u32 m0, s100, 66560
    s_add_u32 s18, s99, 0
    buffer_load_dwordx4 v4, s[20:23], s18 offen lds
    v_mfma_f32_16x16x32_bf16 v[92:95], v[108:111], v[176:179], v[92:95]
    s_waitcnt lgkmcnt(15)
    v_mfma_f32_16x16x32_bf16 v[80:83], v[112:115], v[160:163], v[80:83]
    s_add_u32 m0, s100, 70656
    s_add_u32 s18, s99, 28672
    buffer_load_dwordx4 v4, s[20:23], s18 offen lds
    v_mfma_f32_16x16x32_bf16 v[84:87], v[112:115], v[164:167], v[84:87]
    v_mfma_f32_16x16x32_bf16 v[88:91], v[112:115], v[168:171], v[88:91]
    s_add_u32 m0, s100, 74752
    s_add_u32 s18, s99, 57344
    buffer_load_dwordx4 v4, s[20:23], s18 offen lds
    v_mfma_f32_16x16x32_bf16 v[92:95], v[112:115], v[172:175], v[92:95]
    v_mfma_f32_16x16x32_bf16 v[84:87], v[116:119], v[160:163], v[84:87]
    s_add_u32 m0, s100, 78848
    s_add_u32 s18, s99, 4096
    buffer_load_dwordx4 v4, s[20:23], s18 offen lds
    v_mfma_f32_16x16x32_bf16 v[88:91], v[116:119], v[164:167], v[88:91]
    v_mfma_f32_16x16x32_bf16 v[92:95], v[116:119], v[168:171], v[92:95]
    s_add_u32 m0, s100, 82944
    s_add_u32 s18, s99, 32768
    buffer_load_dwordx4 v4, s[20:23], s18 offen lds
    v_mfma_f32_16x16x32_bf16 v[88:91], v[120:123], v[160:163], v[88:91]
PAD_A_35:
    s_cbranch_execz PRET_A
    v_mfma_f32_16x16x32_bf16 v[92:95], v[120:123], v[164:167], v[92:95]
    s_add_u32 m0, s100, 87040
    s_add_u32 s18, s99, 61440
    buffer_load_dwordx4 v4, s[20:23], s18 offen lds
    v_mfma_f32_16x16x32_bf16 v[92:95], v[124:127], v[160:163], v[92:95]
    v_mfma_f32_16x16x32_bf16 v[64:67], v[128:131], v[192:195], v[64:67]
    s_add_u32 m0, s100, 91136
    s_add_u32 s18, s99, 8192
    buffer_load_dwordx4 v4, s[20:23], s18 offen lds
    v_mfma_f32_16x16x32_bf16 v[68:71], v[128:131], v[196:199], v[68:71]
    v_mfma_f32_16x16x32_bf16 v[72:75], v[128:131], v[200:203], v[72:75]
    s_add_u32 m0, s100, 95232
    s_add_u32 s18, s99, 36864
    buffer_load_dwordx4 v4, s[20:23], s18 offen lds
    v_mfma_f32_16x16x32_bf16 v[76:79], v[128:131], v[204:207], v[76:79]
    ds_write_b128 v41, v[64:67] offset:26624
    v_mfma_f32_16x16x32_bf16 v[80:83], v[128:131], v[208:211], v[80:83]
    s_add_u32 m0, s100, 99328
    s_add_u32 s18, s99, 65536
    buffer_load_dwordx4 v4, s[20:23], s18 offen lds
    v_mfma_f32_16x16x32_bf16 v[84:87], v[128:131], v[212:215], v[84:87]
    v_mfma_f32_16x16x32_bf16 v[88:91], v[128:131], v[216:219], v[88:91]
    s_add_u32 m0, s100, 103424
    s_add_u32 s18, s99, 12288
    buffer_load_dwordx4 v4, s[20:23], s18 offen lds
    s_waitcnt lgkmcnt(15)
    v_mfma_f32_16x16x32_bf16 v[92:95], v[128:131], v[220:223], v[92:95]
    s_waitcnt lgkmcnt(13)
    v_mfma_f32_16x16x32_bf16 v[68:71], v[132:135], v[192:195], v[68:71]
    s_add_u32 m0, s100, 107520
    s_add_u32 s18, s99, 40960
    buffer_load_dwordx4 v4, s[20:23], s18 offen lds
    v_mfma_f32_16x16x32_bf16 v[72:75], v[132:135], v[196:199], v[72:75]
PAD_A_36:
    s_cbranch_execz PAD_A_37
    v_mfma_f32_16x16x32_bf16 v[76:79], v[132:135], v[200:203], v[76:79]
    s_add_u32 m0, s100, 111616
    s_add_u32 s18, s99, 69632
    buffer_load_dwordx4 v4, s[20:23], s18 offen lds
    v_mfma_f32_16x16x32_bf16 v[80:83], v[132:135], v[204:207], v[80:83]
    ds_write_b128 v41, v[68:71] offset:27776
    v_mfma_f32_16x16x32_bf16 v[84:87], v[132:135], v[208:211], v[84:87]
    s_add_u32 m0, s100, 115712
    s_add_u32 s18, s99, 16384
    buffer_load_dwordx4 v4, s[20:23], s18 offen lds
    v_mfma_f32_16x16x32_bf16 v[88:91], v[132:135], v[212:215], v[88:91]
    v_mfma_f32_16x16x32_bf16 v[92:95], v[132:135], v[216:219], v[92:95]
    s_add_u32 m0, s100, 119808
    s_add_u32 s18, s99, 45056
    buffer_load_dwordx4 v4, s[20:23], s18 offen lds
    s_waitcnt lgkmcnt(12)
    v_mfma_f32_16x16x32_bf16 v[72:75], v[136:139], v[192:195], v[72:75]
    v_mfma_f32_16x16x32_bf16 v[76:79], v[136:139], v[196:199], v[76:79]
    s_add_u32 m0, s100, 123904
    s_add_u32 s18, s99, 73728
    buffer_load_dwordx4 v4, s[20:23], s18 offen lds
    v_mfma_f32_16x16x32_bf16 v[80:83], v[136:139], v[200:203], v[80:83]
    s_nop 2
    ds_write_b128 v41, v[72:75] offset:28928
    v_mfma_f32_16x16x32_bf16 v[84:87], v[136:139], v[204:207], v[84:87]
    s_add_u32 m0, s100, 128000
    s_add_u32 s18, s99, 20480
    buffer_load_dwordx4 v4, s[20:23], s18 offen lds
    v_mfma_f32_16x16x32_bf16 v[88:91], v[136:139], v[208:211], v[88:91]
    v_mfma_f32_16x16x32_bf16 v[92:95], v[136:139], v[212:215], v[92:95]
    s_add_u32 m0, s100, 132096
    s_add_u32 s18, s99, 49152
    buffer_load_dwordx4 v4, s[20:23], s18 offen lds
    s_waitcnt lgkmcnt(11)
    v_mfma_f32_16x16x32_bf16 v[76:79], v[140:143], v[192:195], v[76:79]
PAD_A_37:
    s_cbranch_execz PRET_A
    v_mfma_f32_16x16x32_bf16 v[80:83], v[140:143], v[196:199], v[80:83]
    s_add_u32 m0, s100, 136192
    s_add_u32 s18, s99, 77824
    buffer_load_dwordx4 v4, s[20:23], s18 offen lds
    v_mfma_f32_16x16x32_bf16 v[84:87], v[140:143], v[200:203], v[84:87]
    s_nop 2
    ds_write_b128 v41, v[76:79] offset:30080
    v_mfma_f32_16x16x32_bf16 v[88:91], v[140:143], v[204:207], v[88:91]
    s_add_u32 m0, s100, 140288
    s_add_u32 s18, s99, 24576
    buffer_load_dwordx4 v4, s[20:23], s18 offen lds
    v_mfma_f32_16x16x32_bf16 v[92:95], v[140:143], v[208:211], v[92:95]
    s_waitcnt lgkmcnt(10)
    v_mfma_f32_16x16x32_bf16 v[80:83], v[144:147], v[192:195], v[80:83]
    s_add_u32 m0, s100, 144384
    s_add_u32 s18, s99, 53248
    buffer_load_dwordx4 v4, s[20:23], s18 offen lds
    v_mfma_f32_16x16x32_bf16 v[84:87], v[144:147], v[196:199], v[84:87]
    v_mfma_f32_16x16x32_bf16 v[88:91], v[144:147], v[200:203], v[88:91]
    s_add_u32 m0, s100, 148480
    s_add_u32 s18, s99, 81920
    buffer_load_dwordx4 v4, s[20:23], s18 offen lds
    v_mfma_f32_16x16x32_bf16 v[92:95], v[144:147], v[204:207], v[92:95]
    ds_write_b128 v41, v[80:83] offset:31232
    s_waitcnt lgkmcnt(9)
    v_mfma_f32_16x16x32_bf16 v[84:87], v[148:151], v[192:195], v[84:87]
    s_add_u32 m0, s100, 152576
    s_add_u32 s18, s99, 86016
    buffer_load_dwordx4 v4, s[20:23], s18 offen lds
    v_mfma_f32_16x16x32_bf16 v[88:91], v[148:151], v[196:199], v[88:91]
    v_mfma_f32_16x16x32_bf16 v[92:95], v[148:151], v[200:203], v[92:95]
    s_add_u32 m0, s100, 156672
    s_add_u32 s18, s99, 90112
    buffer_load_dwordx4 v4, s[20:23], s18 offen lds
    s_waitcnt lgkmcnt(7)
    v_mfma_f32_16x16x32_bf16 v[88:91], v[152:155], v[192:195], v[88:91]
    ds_write_b128 v41, v[84:87] offset:32384
    v_mfma_f32_16x16x32_bf16 v[92:95], v[152:155], v[196:199], v[92:95]
    s_waitcnt lgkmcnt(6)
PAD_A_38:
    s_cbranch_execz PRET_A
    v_mfma_f32_16x16x32_bf16 v[92:95], v[156:159], v[192:195], v[92:95]
    s_nop 3
    ds_write_b128 v41, v[88:91] offset:33536
    v_add_u32 v246, 4096, v4
    s_nop 1
    ds_write_b128 v41, v[92:95] offset:34688
    s_waitcnt lgkmcnt(0)
    s_barrier
    ds_read_b128 v[96:99], v42 offset:26624
    ds_read_b128 v[100:103], v42 offset:26880
    ds_read_b128 v[104:107], v42 offset:45056
    ds_read_b128 v[108:111], v42 offset:45312
    ds_read_b128 v[112:115], v42 offset:35840
    ds_read_b128 v[116:119], v42 offset:36096
    ds_read_b128 v[120:123], v42 offset:54272
    ds_read_b128 v[124:127], v42 offset:54528
    s_waitcnt lgkmcnt(5)
    v_pk_add_f32 v[96:97], v[96:97], v[104:105]
    v_pk_add_f32 v[98:99], v[98:99], v[106:107]
    s_waitcnt lgkmcnt(4)
    v_pk_add_f32 v[100:101], v[100:101], v[108:109]
    v_pk_add_f32 v[102:103], v[102:103], v[110:111]
    v_pk_add_f32 v[96:97], v[96:97], v[224:225]
    v_pk_add_f32 v[98:99], v[98:99], v[226:227]
    v_pk_add_f32 v[100:101], v[100:101], v[228:229]
    v_pk_add_f32 v[102:103], v[102:103], v[230:231]
    v_cvt_pk_bf16_f32 v128, v96, v97
    v_cvt_pk_bf16_f32 v129, v98, v99
    v_cvt_pk_bf16_f32 v130, v100, v101
    v_cvt_pk_bf16_f32 v131, v102, v103
    buffer_store_dwordx4 v[128:131], v3, s[20:23], s11 offen sc1
    s_waitcnt lgkmcnt(1)
    v_pk_add_f32 v[112:113], v[112:113], v[120:121]
    v_pk_add_f32 v[114:115], v[114:115], v[122:123]
    s_waitcnt lgkmcnt(0)
    v_pk_add_f32 v[116:117], v[116:117], v[124:125]
    v_pk_add_f32 v[118:119], v[118:119], v[126:127]
    v_pk_add_f32 v[112:113], v[112:113], v[232:233]
    v_pk_add_f32 v[114:115], v[114:115], v[234:235]
    v_pk_add_f32 v[116:117], v[116:117], v[236:237]
    v_pk_add_f32 v[118:119], v[118:119], v[238:239]
    v_cvt_pk_bf16_f32 v132, v112, v113
    v_cvt_pk_bf16_f32 v133, v114, v115
    v_cvt_pk_bf16_f32 v134, v116, v117
PAD_A_39:
    s_cbranch_execz PRET_A
    v_cvt_pk_bf16_f32 v135, v118, v119
    buffer_store_dwordx4 v[132:135], v3, s[20:23], s12 offen sc1
    v_lshrrev_b32 v5, 2, v2
    v_lshlrev_b32 v5, 12, v5
    v_and_b32 v6, 3, v2
    v_lshl_add_u32 v3, v6, 4, v5
    v_lshlrev_b32 v4, 4, v2
    v_lshrrev_b32 v16, 5, v2
    v_lshlrev_b32 v16, 3, v16
    v_bfe_u32 v17, v2, 2, 2
    v_add_u32 v16, v16, v17
    v_lshlrev_b32 v16, 6, v16
    v_bfe_u32 v17, v2, 4, 1
    v_lshl_add_u32 v16, v17, 5, v16
    v_lshl_add_u32 v16, v6, 3, v16
    s_add_u32 s12, s100, 17408
    v_add_u32 v12, s12, v16
    v_add_u32 v8, 17408, v4
    v_add_u32 v9, 82944, v4
    v_add_u32 v10, 148480, v4
    s_mov_b32 s60, -1
    s_mov_b32 s61, 0
    v_mov_b32 v241, 0
    v_mov_b32 v242, 0
    v_mov_b32 v243, 0
    v_mov_b32 v16, 0x3f803f80
    v_mov_b32 v17, 0
    v_mov_b32 v13, 0
    v_mov_b32 v18, 0
    v_mov_b32 v14, 0
    s_lshl_b32 s13, s96, 8
    s_lshl_b32 s12, s6, 6
    s_add_u32 s13, s13, s12
    s_add_u32 s13, s13, 2097152
    s_mov_b32 vcc_lo, 0x10100101
    s_mov_b32 vcc_hi, 0x10100101
    v_cndmask_b32 v16, 0, v16, vcc
    v_accvgpr_write_b32 a240, v16
    v_accvgpr_write_b32 a241, v16
    v_accvgpr_write_b32 a242, v16
    v_accvgpr_write_b32 a243, v16
    s_lshl_b32 s19, s96, 2
    s_add_u32 s19, s19, s6
    s_mul_i32 s19, s19, 114688
    s_mul_i32 s24, s97, 7168
    s_add_u32 s19, s19, s24
    s_add_u32 s19, s19, 16777216
    s_and_b32 s11, s6, 1
    s_lshr_b32 s12, s6, 1
    s_lshl_b32 s40, s94, 1
    s_add_u32 s40, s40, s11
    s_lshl_b32 s41, s95, 1
    s_add_u32 s41, s41, s12
    s_lshl_b32 s42, s41, 17
    s_lshl_b32 s43, s40, 6
    s_add_u32 s42, s42, s43
    s_add_u32 s43, s42, 2097152
PAD_A_40:
    s_cbranch_execz PAD_A_41
    s_xor_b32 s45, s40, 1
    s_mul_i32 s44, s40, 114688
    s_mul_i32 s45, s45, 114688
    s_mul_i32 s46, s6, 28672
    s_add_u32 s46, s46, 16777216
    s_add_u32 s32, s44, s46
    s_add_u32 s56, s45, s46
    s_lshl_b32 s47, s6, 11
    s_add_u32 s47, s47, 152576
    v_add_u32 v22, 4096, v4
    s_add_u32 s33, s32, 7168
    s_add_u32 s57, s56, 7168
    s_add_u32 s34, s32, 14336
    s_add_u32 s58, s56, 14336
    s_add_u32 s35, s32, 21504
    s_add_u32 s59, s56, 21504
    s_waitcnt vmcnt(0)
    s_barrier
    s_cmp_lg_u32 s6, 0
    s_cbranch_scc1 SKIP_19
    s_add_u32 s92, s88, 3
    v_mov_b32 v253, s92
    v_lshlrev_b32 v252, 10, v2
    buffer_store_dword v253, v252, s[20:23], s89 offen sc1
    s_mov_b64 exec, -1
SKIP_19:
    s_cmp_eq_u32 s6, 0
    s_cbranch_scc1 SKIP_21
    buffer_load_dwordx4 a[0:3], v4, s[20:23], s48 offen
    buffer_load_dwordx4 a[4:7], v4, s[20:23], s52 offen
    buffer_load_dwordx4 a[56:59], v4, s[20:23], s49 offen
    buffer_load_dwordx4 a[60:63], v4, s[20:23], s53 offen
    buffer_load_dwordx4 a[112:115], v4, s[20:23], s50 offen
    buffer_load_dwordx4 a[116:119], v4, s[20:23], s54 offen
    buffer_load_dwordx4 a[168:171], v4, s[20:23], s51 offen
    buffer_load_dwordx4 a[172:175], v4, s[20:23], s55 offen
    buffer_load_dwordx4 a[8:11], v4, s[20:23], s48 offen offset:1024
    buffer_load_dwordx4 a[12:15], v4, s[20:23], s52 offen offset:1024
    buffer_load_dwordx4 a[64:67], v4, s[20:23], s49 offen offset:1024
    buffer_load_dwordx4 a[68:71], v4, s[20:23], s53 offen offset:1024
    buffer_load_dwordx4 a[120:123], v4, s[20:23], s50 offen offset:1024
    buffer_load_dwordx4 a[124:127], v4, s[20:23], s54 offen offset:1024
    buffer_load_dwordx4 a[176:179], v4, s[20:23], s51 offen offset:1024
    buffer_load_dwordx4 a[180:183], v4, s[20:23], s55 offen offset:1024
    buffer_load_dwordx4 a[16:19], v4, s[20:23], s48 offen offset:2048
    buffer_load_dwordx4 a[20:23], v4, s[20:23], s52 offen offset:2048
    buffer_load_dwordx4 a[72:75], v4, s[20:23], s49 offen offset:2048
    buffer_load_dwordx4 a[76:79], v4, s[20:23], s53 offen offset:2048
PAD_A_41:
    s_cbranch_execz PRET_A
    buffer_load_dwordx4 a[128:131], v4, s[20:23], s50 offen offset:2048
    buffer_load_dwordx4 a[132:135], v4, s[20:23], s54 offen offset:2048
    buffer_load_dwordx4 a[184:187], v4, s[20:23], s51 offen offset:2048
    buffer_load_dwordx4 a[188:191], v4, s[20:23], s55 offen offset:2048
    buffer_load_dwordx4 a[24:27], v4, s[20:23], s48 offen offset:3072
    buffer_load_dwordx4 a[28:31], v4, s[20:23], s52 offen offset:3072
    buffer_load_dwordx4 a[80:83], v4, s[20:23], s49 offen offset:3072
    buffer_load_dwordx4 a[84:87], v4, s[20:23], s53 offen offset:3072
    s_lshr_b32 s3, s2, 3
    s_and_b32 s3, s3, 7
    s_mul_i32 s3, s3, 3
    s_add_u32 s3, s3, s6
    s_sub_u32 s3, s3, 1
    s_sub_u32 s7, s6, 1
    s_mov_b64 exec, 0
    s_cmp_ge_u32 s3, 12
    s_cbranch_scc1 PCH_B_12_24
    s_cmp_ge_u32 s3, 6
    s_cbranch_scc1 PCH_B_6_12
    s_cmp_eq_u32 s3, 0
    s_cbranch_scc1 PAD_B_0
    s_cmp_eq_u32 s3, 1
    s_cbranch_scc1 PAD_B_2
    s_cmp_eq_u32 s3, 2
    s_cbranch_scc1 PAD_B_4
    s_cmp_eq_u32 s3, 3
    s_cbranch_scc1 PAD_B_5
    s_cmp_eq_u32 s3, 4
    s_cbranch_scc1 PAD_B_7
    s_cmp_eq_u32 s3, 5
    s_cbranch_scc1 PAD_B_9
    s_branch PNO_B
PCH_B_6_12:
    s_cmp_eq_u32 s3, 6
    s_cbranch_scc1 PAD_B_11
    s_cmp_eq_u32 s3, 7
    s_cbranch_scc1 PAD_B_13
    s_cmp_eq_u32 s3, 8
    s_cbranch_scc1 PAD_B_14
    s_cmp_eq_u32 s3, 9
    s_cbranch_scc1 PAD_B_16
    s_cmp_eq_u32 s3, 10
    s_cbranch_scc1 PAD_B_18
    s_cmp_eq_u32 s3, 11
    s_cbranch_scc1 PAD_B_20
    s_branch PNO_B
PCH_B_12_24:
    s_cmp_ge_u32 s3, 18
    s_cbranch_scc1 PCH_B_18_12
    s_cmp_eq_u32 s3, 12
    s_cbranch_scc1 PAD_B_22
    s_cmp_eq_u32 s3, 13
    s_cbranch_scc1 PAD_B_23
    s_cmp_eq_u32 s3, 14
    s_cbranch_scc1 PAD_B_25
    s_cmp_eq_u32 s3, 15
    s_cbranch_scc1 PAD_B_27
    s_cmp_eq_u32 s3, 16
    s_cbranch_scc1 PAD_B_29
    s_cmp_eq_u32 s3, 17
    s_cbranch_scc1 PAD_B_30
    s_branch PNO_B
PCH_B_18_12:
    s_cmp_eq_u32 s3, 18
    s_cbranch_scc1 PAD_B_32
    s_cmp_eq_u32 s3, 19
    s_cbranch_scc1 PAD_B_34
    s_cmp_eq_u32 s3, 20
    s_cbranch_scc1 PAD_B_36
    s_cmp_eq_u32 s3, 21
    s_cbranch_scc1 PAD_B_38
    s_cmp_eq_u32 s3, 22
    s_cbranch_scc1 PAD_B_39
    s_cmp_eq_u32 s3, 23
    s_cbranch_scc1 PAD_B_41
PNO_B:
PRET_B:
    s_mov_b64 exec, -1
SKIP_21:
PAD_A_42:
    s_cbranch_execz PRET_A
    s_cmp_lg_u32 s6, 0
    s_cbranch_scc1 SKIP_23
    s_add_u32 s3, s88, 3
    s_mov_b32 s92, 30000
POLL_25:
    buffer_load_dwordx4 v[248:251], v254, s[20:23], s90 offen sc1
    s_waitcnt vmcnt(0)
    v_subrev_u32 v248, s3, v248
    v_subrev_u32 v249, s3, v249
    v_subrev_u32 v250, s3, v250
    v_subrev_u32 v251, s3, v251
    v_max3_u32 v248, v248, v249, v250
    v_max_u32 v248, v248, v251
    v_cmp_lt_u32 vcc, 7, v248
    s_and_b64 exec, vcc, exec
    s_cbranch_scc0 PDONE_26
    s_sub_u32 s92, s92, 1
    s_cmp_lg_u32 s92, 0
    s_cbranch_scc1 POLL_25
PDONE_26:
    s_mov_b64 exec, -1
SKIP_23:
    s_barrier
    s_branch L_GLU1
L_SPARE0:
    s_mov_b32 s24, s36
    s_mov_b32 s25, s37
    s_mov_b32 s26, 1835008
    s_mov_b32 s27, 0x00020000
    v_lshrrev_b32 v225, 5, v0
    v_mul_u32_u24 v225, 896, v225
    v_and_b32 v224, 31, v0
    v_mul_u32_u24 v224, 28, v224
    v_add_u32 v225, v225, v224
    s_mul_i32 s7, s2, 7168
    buffer_load_dwordx4 v[216:219], v225, s[24:27], s7 offen
    buffer_load_dwordx3 v[220:222], v225, s[24:27], s7 offen offset:16
    s_mov_b32 s28, s52
    s_mov_b32 s29, s53
    s_mov_b32 s30, 1605632
    s_mov_b32 s31, 0x00020000
    s_mov_b32 s32, s54
    s_mov_b32 s33, s55
    s_mov_b32 s34, 1605632
    s_mov_b32 s35, 0x00020000
    s_sub_u32 s7, s2, 224
    s_min_u32 s7, s7, 27
    v_lshrrev_b32 v5, 3, v2
    v_and_b32 v6, 7, v2
    v_and_b32 v7, 3, v5
    v_lshlrev_b32 v7, 1, v7
    v_xor_b32 v6, v6, v7
    v_mul_u32_u24 v5, 3584, v5
    v_lshl_add_u32 v3, v6, 4, v5
    v_xor_b32 v6, 2, v6
    v_lshl_add_u32 v4, v6, 4, v5
    s_lshl_b32 s12, s7, 7
    s_mul_i32 s9, s6, 401408
    s_add_u32 s12, s12, s9
    s_mul_i32 s13, s6, 14336
    s_waitcnt lgkmcnt(0)
    s_mul_i32 s88, s87, 0x9E3779B1
    s_add_u32 s88, s88, 0x7F4A7C15
    s_mul_i32 s101, s87, 0x85EBCA6B
    s_add_u32 s101, s101, 0xC2B2AE35
    v_mov_b32 v223, 0
    v_mov_b32 v224, 0
    v_mov_b32 v225, 0x3f803f80
    s_waitcnt vmcnt(1)
    v_dot2c_f32_bf16 v223, v216, v225
    v_dot2c_f32_bf16 v224, v216, v216
    v_dot2c_f32_bf16 v223, v217, v225
    v_dot2c_f32_bf16 v224, v217, v217
    v_dot2c_f32_bf16 v223, v218, v225
    v_dot2c_f32_bf16 v224, v218, v218
    v_dot2c_f32_bf16 v223, v219, v225
    v_dot2c_f32_bf16 v224, v219, v219
    s_waitcnt vmcnt(0)
    v_dot2c_f32_bf16 v223, v220, v225
    v_dot2c_f32_bf16 v224, v220, v220
    v_dot2c_f32_bf16 v223, v221, v225
    v_dot2c_f32_bf16 v224, v221, v221
    v_dot2c_f32_bf16 v223, v222, v225
    v_dot2c_f32_bf16 v224, v222, v222
    s_nop 1
    v_add_f32_dpp v223, v223, v223 quad_perm:[1,0,3,2] row_mask:0xf bank_mask:0xf
    v_add_f32_dpp v224, v224, v224 quad_perm:[1,0,3,2] row_mask:0xf bank_mask:0xf
    s_nop 0
    v_add_f32_dpp v223, v223, v223 quad_perm:[2,3,0,1] row_mask:0xf bank_mask:0xf
    v_add_f32_dpp v224, v224, v224 quad_perm:[2,3,0,1] row_mask:0xf bank_mask:0xf
    s_nop 0
    v_add_f32_dpp v223, v223, v223 row_half_mirror row_mask:0xf bank_mask:0xf
    v_add_f32_dpp v224, v224, v224 row_half_mirror row_mask:0xf bank_mask:0xf
    s_nop 0
    v_add_f32_dpp v223, v223, v223 row_mirror row_mask:0xf bank_mask:0xf
    v_add_f32_dpp v224, v224, v224 row_mirror row_mask:0xf bank_mask:0xf
    s_nop 0
    v_add_f32_dpp v223, v223, v223 row_bcast:15 row_mask:0xa bank_mask:0xf
    v_add_f32_dpp v224, v224, v224 row_bcast:15 row_mask:0xa bank_mask:0xf
    v_lshrrev_b32 v225, 5, v0
    v_lshlrev_b32 v225, 2, v225
    s_lshl_b32 s7, s2, 7
    s_add_u32 s8, s7, 327680
    s_mov_b32 exec_lo, 0x80000000
    s_mov_b32 exec_hi, 0x80000000
    buffer_store_dword v223, v225, s[20:23], s8 offen sc1
    buffer_store_dword v224, v225, s[20:23], s8 offen offset:32 sc1
    s_mov_b64 exec, -1
    v_mov_b32 v216, 0
    v_and_b32 v217, 15, v2
    v_lshlrev_b32 v217, 2, v217
    v_lshrrev_b32 v218, 4, v2
    v_lshl_add_u32 v217, v218, 15, v217
    s_add_u32 s8, s7, 524288
    s_cmp_lg_u32 s6, 0
    s_cbranch_scc1 SKIP_27
    s_mov_b64 exec, 0xffff
    buffer_atomic_swap v216, v217, s[20:23], s8 offen sc1
    s_mov_b64 exec, -1
SKIP_27:
    s_add_u32 s10, s12, 0
    s_add_u32 m0, s13, 17408
    s_nop 0
    buffer_load_dwordx4 v3, s[28:31], s10 offen lds
    s_add_u32 m0, s13, 74752
    s_nop 0
    buffer_load_dwordx4 v4, s[32:35], s10 offen lds
    s_add_u32 s10, s12, 28672
    s_add_u32 m0, s13, 18432
    s_nop 0
    buffer_load_dwordx4 v3, s[28:31], s10 offen lds
    s_add_u32 m0, s13, 75776
    s_nop 0
    buffer_load_dwordx4 v4, s[32:35], s10 offen lds
    s_add_u32 s10, s12, 57344
    s_add_u32 m0, s13, 19456
    s_nop 0
    buffer_load_dwordx4 v3, s[28:31], s10 offen lds
    s_add_u32 m0, s13, 76800
    s_nop 0
    buffer_load_dwordx4 v4, s[32:35], s10 offen lds
    s_add_u32 s10, s12, 86016
    s_add_u32 m0, s13, 20480
    s_nop 0
    buffer_load_dwordx4 v3, s[28:31], s10 offen lds
    s_add_u32 m0, s13, 77824
    s_nop 0
    buffer_load_dwordx4 v4, s[32:35], s10 offen lds
    s_add_u32 s10, s12, 114688
    s_add_u32 m0, s13, 21504
    s_nop 0
    buffer_load_dwordx4 v3, s[28:31], s10 offen lds
    s_add_u32 m0, s13, 78848
    s_nop 0
    buffer_load_dwordx4 v4, s[32:35], s10 offen lds
    s_add_u32 s10, s12, 143360
    s_add_u32 m0, s13, 22528
    s_nop 0
    buffer_load_dwordx4 v3, s[28:31], s10 offen lds
    s_add_u32 m0, s13, 79872
    s_nop 0
    buffer_load_dwordx4 v4, s[32:35], s10 offen lds
    s_add_u32 s10, s12, 172032
    s_add_u32 m0, s13, 23552
    s_nop 0
    buffer_load_dwordx4 v3, s[28:31], s10 offen lds
    s_add_u32 m0, s13, 80896
    s_nop 0
    buffer_load_dwordx4 v4, s[32:35], s10 offen lds
    s_add_u32 s10, s12, 200704
    s_add_u32 m0, s13, 24576
    s_nop 0
    buffer_load_dwordx4 v3, s[28:31], s10 offen lds
    s_add_u32 m0, s13, 81920
    s_nop 0
    buffer_load_dwordx4 v4, s[32:35], s10 offen lds
    s_add_u32 s10, s12, 229376
    s_add_u32 m0, s13, 25600
    s_nop 0
    buffer_load_dwordx4 v3, s[28:31], s10 offen lds
    s_add_u32 m0, s13, 82944
    s_nop 0
    buffer_load_dwordx4 v4, s[32:35], s10 offen lds
    s_add_u32 s10, s12, 258048
    s_add_u32 m0, s13, 26624
    s_nop 0
    buffer_load_dwordx4 v3, s[28:31], s10 offen lds
    s_add_u32 m0, s13, 83968
    s_nop 0
    buffer_load_dwordx4 v4, s[32:35], s10 offen lds
    s_add_u32 s10, s12, 286720
    s_add_u32 m0, s13, 27648
    s_nop 0
    buffer_load_dwordx4 v3, s[28:31], s10 offen lds
    s_add_u32 m0, s13, 84992
    s_nop 0
    buffer_load_dwordx4 v4, s[32:35], s10 offen lds
    s_add_u32 s10, s12, 315392
    s_add_u32 m0, s13, 28672
    s_nop 0
    buffer_load_dwordx4 v3, s[28:31], s10 offen lds
    s_add_u32 m0, s13, 86016
    s_nop 0
    buffer_load_dwordx4 v4, s[32:35], s10 offen lds
    s_add_u32 s10, s12, 344064
    s_add_u32 m0, s13, 29696
    s_nop 0
    buffer_load_dwordx4 v3, s[28:31], s10 offen lds
    s_add_u32 m0, s13, 87040
    s_nop 0
    buffer_load_dwordx4 v4, s[32:35], s10 offen lds
    s_add_u32 s10, s12, 372736
    s_add_u32 m0, s13, 30720
    s_nop 0
    buffer_load_dwordx4 v3, s[28:31], s10 offen lds
    s_add_u32 m0, s13, 88064
    s_nop 0
    buffer_load_dwordx4 v4, s[32:35], s10 offen lds
    s_waitcnt vmcnt(0)
    s_barrier
    s_cmp_lg_u32 s6, 0
    s_cbranch_scc1 SKIP_29
    s_add_u32 s92, s88, 1
    v_mov_b32 v253, s92
    v_lshlrev_b32 v252, 10, v2
    buffer_store_dword v253, v252, s[20:23], s89 offen sc1
    v_mov_b32 v251, s101
    s_add_u32 s3, s89, 131072
    buffer_store_dword v251, v252, s[20:23], s3 offen sc1
    s_mov_b64 exec, -1
SKIP_29:
    s_sub_u32 s7, s2, 224
    s_min_u32 s7, s7, 27
    v_bfe_u32 v5, v2, 2, 2
    v_lshrrev_b32 v6, 5, v2
    v_lshl_add_u32 v6, v6, 3, v5
    v_lshlrev_b32 v6, 7, v6
    v_bfe_u32 v7, v2, 1, 1
    s_lshl_b32 s8, s6, 1
    v_add_u32 v7, s8, v7
    v_lshlrev_b32 v8, 1, v5
    v_xor_b32 v7, v7, v8
    v_bfe_u32 v8, v2, 4, 1
    v_lshlrev_b32 v9, 1, v8
    v_xor_b32 v7, v7, v9
    v_lshl_add_u32 v6, v7, 4, v6
    v_and_b32 v7, 1, v2
    v_lshl_add_u32 v6, v7, 3, v6
    v_mul_u32_u24 v8, 57344, v8
    v_add_u32 v6, v6, v8
    v_add_u32 v6, 17408, v6
    v_mov_b32 v10, 0x3f803f80
    v_mov_b32 v11, 0
    ds_read_b64_tr_b16 v[32:33], v6 offset:0
    ds_read_b64_tr_b16 v[34:35], v6 offset:512
    ds_read_b64_tr_b16 v[36:37], v6 offset:2048
    ds_read_b64_tr_b16 v[38:39], v6 offset:2560
    ds_read_b64_tr_b16 v[40:41], v6 offset:4096
    ds_read_b64_tr_b16 v[42:43], v6 offset:4608
    ds_read_b64_tr_b16 v[44:45], v6 offset:6144
    ds_read_b64_tr_b16 v[46:47], v6 offset:6656
    s_waitcnt lgkmcnt(7)
    v_dot2c_f32_bf16 v11, v32, v10
    v_dot2c_f32_bf16 v11, v33, v10
    s_waitcnt lgkmcnt(6)
    v_dot2c_f32_bf16 v11, v34, v10
    v_dot2c_f32_bf16 v11, v35, v10
    ds_read_b64_tr_b16 v[48:49], v6 offset:8192
    ds_read_b64_tr_b16 v[50:51], v6 offset:8704
    s_waitcnt lgkmcnt(7)
    v_dot2c_f32_bf16 v11, v36, v10
    v_dot2c_f32_bf16 v11, v37, v10
    s_waitcnt lgkmcnt(6)
    v_dot2c_f32_bf16 v11, v38, v10
    v_dot2c_f32_bf16 v11, v39, v10
    ds_read_b64_tr_b16 v[52:53], v6 offset:10240
    ds_read_b64_tr_b16 v[54:55], v6 offset:10752
    s_waitcnt lgkmcnt(7)
    v_dot2c_f32_bf16 v11, v40, v10
    v_dot2c_f32_bf16 v11, v41, v10
    s_waitcnt lgkmcnt(6)
    v_dot2c_f32_bf16 v11, v42, v10
    v_dot2c_f32_bf16 v11, v43, v10
    ds_read_b64_tr_b16 v[56:57], v6 offset:12288
    ds_read_b64_tr_b16 v[58:59], v6 offset:12800
    s_waitcnt lgkmcnt(7)
    v_dot2c_f32_bf16 v11, v44, v10
    v_dot2c_f32_bf16 v11, v45, v10
    s_waitcnt lgkmcnt(6)
    v_dot2c_f32_bf16 v11, v46, v10
    v_dot2c_f32_bf16 v11, v47, v10
    ds_read_b64_tr_b16 v[60:61], v6 offset:14336
    ds_read_b64_tr_b16 v[62:63], v6 offset:14848
    s_waitcnt lgkmcnt(7)
    v_dot2c_f32_bf16 v11, v48, v10
    v_dot2c_f32_bf16 v11, v49, v10
    s_waitcnt lgkmcnt(6)
    v_dot2c_f32_bf16 v11, v50, v10
    v_dot2c_f32_bf16 v11, v51, v10
    ds_read_b64_tr_b16 v[64:65], v6 offset:16384
    ds_read_b64_tr_b16 v[66:67], v6 offset:16896
    s_waitcnt lgkmcnt(7)
    v_dot2c_f32_bf16 v11, v52, v10
    v_dot2c_f32_bf16 v11, v53, v10
    s_waitcnt lgkmcnt(6)
    v_dot2c_f32_bf16 v11, v54, v10
    v_dot2c_f32_bf16 v11, v55, v10
    ds_read_b64_tr_b16 v[68:69], v6 offset:18432
    ds_read_b64_tr_b16 v[70:71], v6 offset:18944
    s_waitcnt lgkmcnt(7)
    v_dot2c_f32_bf16 v11, v56, v10
    v_dot2c_f32_bf16 v11, v57, v10
    s_waitcnt lgkmcnt(6)
    v_dot2c_f32_bf16 v11, v58, v10
    v_dot2c_f32_bf16 v11, v59, v10
    ds_read_b64_tr_b16 v[72:73], v6 offset:20480
    ds_read_b64_tr_b16 v[74:75], v6 offset:20992
    s_waitcnt lgkmcnt(7)
    v_dot2c_f32_bf16 v11, v60, v10
    v_dot2c_f32_bf16 v11, v61, v10
    s_waitcnt lgkmcnt(6)
    v_dot2c_f32_bf16 v11, v62, v10
    v_dot2c_f32_bf16 v11, v63, v10
    ds_read_b64_tr_b16 v[76:77], v6 offset:22528
    ds_read_b64_tr_b16 v[78:79], v6 offset:23040
    s_waitcnt lgkmcnt(7)
    v_dot2c_f32_bf16 v11, v64, v10
    v_dot2c_f32_bf16 v11, v65, v10
    s_waitcnt lgkmcnt(6)
    v_dot2c_f32_bf16 v11, v66, v10
    v_dot2c_f32_bf16 v11, v67, v10
    ds_read_b64_tr_b16 v[80:81], v6 offset:24576
    ds_read_b64_tr_b16 v[82:83], v6 offset:25088
    s_waitcnt lgkmcnt(7)
    v_dot2c_f32_bf16 v11, v68, v10
    v_dot2c_f32_bf16 v11, v69, v10
    s_waitcnt lgkmcnt(6)
    v_dot2c_f32_bf16 v11, v70, v10
    v_dot2c_f32_bf16 v11, v71, v10
    ds_read_b64_tr_b16 v[84:85], v6 offset:26624
    ds_read_b64_tr_b16 v[86:87], v6 offset:27136
    s_waitcnt lgkmcnt(7)
    v_dot2c_f32_bf16 v11, v72, v10
    v_dot2c_f32_bf16 v11, v73, v10
    s_waitcnt lgkmcnt(6)
    v_dot2c_f32_bf16 v11, v74, v10
    v_dot2c_f32_bf16 v11, v75, v10
    ds_read_b64_tr_b16 v[88:89], v6 offset:28672
    ds_read_b64_tr_b16 v[90:91], v6 offset:29184
    s_waitcnt lgkmcnt(7)
    v_dot2c_f32_bf16 v11, v76, v10
    v_dot2c_f32_bf16 v11, v77, v10
    s_waitcnt lgkmcnt(6)
    v_dot2c_f32_bf16 v11, v78, v10
    v_dot2c_f32_bf16 v11, v79, v10
    ds_read_b64_tr_b16 v[92:93], v6 offset:30720
    ds_read_b64_tr_b16 v[94:95], v6 offset:31232
    s_waitcnt lgkmcnt(7)
    v_dot2c_f32_bf16 v11, v80, v10
    v_dot2c_f32_bf16 v11, v81, v10
    s_waitcnt lgkmcnt(6)
    v_dot2c_f32_bf16 v11, v82, v10
    v_dot2c_f32_bf16 v11, v83, v10
    ds_read_b64_tr_b16 v[96:97], v6 offset:32768
    ds_read_b64_tr_b16 v[98:99], v6 offset:33280
    s_waitcnt lgkmcnt(7)
    v_dot2c_f32_bf16 v11, v84, v10
    v_dot2c_f32_bf16 v11, v85, v10
    s_waitcnt lgkmcnt(6)
    v_dot2c_f32_bf16 v11, v86, v10
    v_dot2c_f32_bf16 v11, v87, v10
    ds_read_b64_tr_b16 v[100:101], v6 offset:34816
    ds_read_b64_tr_b16 v[102:103], v6 offset:35328
    s_waitcnt lgkmcnt(7)
    v_dot2c_f32_bf16 v11, v88, v10
    v_dot2c_f32_bf16 v11, v89, v10
    s_waitcnt lgkmcnt(6)
    v_dot2c_f32_bf16 v11, v90, v10
    v_dot2c_f32_bf16 v11, v91, v10
    ds_read_b64_tr_b16 v[104:105], v6 offset:36864
    ds_read_b64_tr_b16 v[106:107], v6 offset:37376
    s_waitcnt lgkmcnt(7)
    v_dot2c_f32_bf16 v11, v92, v10
    v_dot2c_f32_bf16 v11, v93, v10
    s_waitcnt lgkmcnt(6)
    v_dot2c_f32_bf16 v11, v94, v10
    v_dot2c_f32_bf16 v11, v95, v10
    ds_read_b64_tr_b16 v[108:109], v6 offset:38912
    ds_read_b64_tr_b16 v[110:111], v6 offset:39424
    s_waitcnt lgkmcnt(7)
    v_dot2c_f32_bf16 v11, v96, v10
    v_dot2c_f32_bf16 v11, v97, v10
    s_waitcnt lgkmcnt(6)
    v_dot2c_f32_bf16 v11, v98, v10
    v_dot2c_f32_bf16 v11, v99, v10
    ds_read_b64_tr_b16 v[112:113], v6 offset:40960
    ds_read_b64_tr_b16 v[114:115], v6 offset:41472
    s_waitcnt lgkmcnt(7)
    v_dot2c_f32_bf16 v11, v100, v10
    v_dot2c_f32_bf16 v11, v101, v10
    s_waitcnt lgkmcnt(6)
    v_dot2c_f32_bf16 v11, v102, v10
    v_dot2c_f32_bf16 v11, v103, v10
    ds_read_b64_tr_b16 v[116:117], v6 offset:43008
    ds_read_b64_tr_b16 v[118:119], v6 offset:43520
    s_waitcnt lgkmcnt(7)
    v_dot2c_f32_bf16 v11, v104, v10
    v_dot2c_f32_bf16 v11, v105, v10
    s_waitcnt lgkmcnt(6)
    v_dot2c_f32_bf16 v11, v106, v10
    v_dot2c_f32_bf16 v11, v107, v10
    ds_read_b64_tr_b16 v[120:121], v6 offset:45056
    ds_read_b64_tr_b16 v[122:123], v6 offset:45568
    s_waitcnt lgkmcnt(7)
    v_dot2c_f32_bf16 v11, v108, v10
    v_dot2c_f32_bf16 v11, v109, v10
    s_waitcnt lgkmcnt(6)
    v_dot2c_f32_bf16 v11, v110, v10
    v_dot2c_f32_bf16 v11, v111, v10
    ds_read_b64_tr_b16 v[124:125], v6 offset:47104
    ds_read_b64_tr_b16 v[126:127], v6 offset:47616
    s_waitcnt lgkmcnt(7)
    v_dot2c_f32_bf16 v11, v112, v10
    v_dot2c_f32_bf16 v11, v113, v10
    s_waitcnt lgkmcnt(6)
    v_dot2c_f32_bf16 v11, v114, v10
    v_dot2c_f32_bf16 v11, v115, v10
    ds_read_b64_tr_b16 v[128:129], v6 offset:49152
    ds_read_b64_tr_b16 v[130:131], v6 offset:49664
    s_waitcnt lgkmcnt(7)
    v_dot2c_f32_bf16 v11, v116, v10
    v_dot2c_f32_bf16 v11, v117, v10
    s_waitcnt lgkmcnt(6)
    v_dot2c_f32_bf16 v11, v118, v10
    v_dot2c_f32_bf16 v11, v119, v10
    ds_read_b64_tr_b16 v[132:133], v6 offset:51200
    ds_read_b64_tr_b16 v[134:135], v6 offset:51712
    s_waitcnt lgkmcnt(7)
    v_dot2c_f32_bf16 v11, v120, v10
    v_dot2c_f32_bf16 v11, v121, v10
    s_waitcnt lgkmcnt(6)
    v_dot2c_f32_bf16 v11, v122, v10
    v_dot2c_f32_bf16 v11, v123, v10
    ds_read_b64_tr_b16 v[136:137], v6 offset:53248
    ds_read_b64_tr_b16 v[138:139], v6 offset:53760
    s_waitcnt lgkmcnt(7)
    v_dot2c_f32_bf16 v11, v124, v10
    v_dot2c_f32_bf16 v11, v125, v10
    s_waitcnt lgkmcnt(6)
    v_dot2c_f32_bf16 v11, v126, v10
    v_dot2c_f32_bf16 v11, v127, v10
    ds_read_b64_tr_b16 v[140:141], v6 offset:55296
    ds_read_b64_tr_b16 v[142:143], v6 offset:55808
    s_waitcnt lgkmcnt(7)
    v_dot2c_f32_bf16 v11, v128, v10
    v_dot2c_f32_bf16 v11, v129, v10
    s_waitcnt lgkmcnt(6)
    v_dot2c_f32_bf16 v11, v130, v10
    v_dot2c_f32_bf16 v11, v131, v10
    s_waitcnt lgkmcnt(5)
    v_dot2c_f32_bf16 v11, v132, v10
    v_dot2c_f32_bf16 v11, v133, v10
    s_waitcnt lgkmcnt(4)
    v_dot2c_f32_bf16 v11, v134, v10
    v_dot2c_f32_bf16 v11, v135, v10
    s_waitcnt lgkmcnt(3)
    v_dot2c_f32_bf16 v11, v136, v10
    v_dot2c_f32_bf16 v11, v137, v10
    s_waitcnt lgkmcnt(2)
    v_dot2c_f32_bf16 v11, v138, v10
    v_dot2c_f32_bf16 v11, v139, v10
    s_waitcnt lgkmcnt(1)
    v_dot2c_f32_bf16 v11, v140, v10
    v_dot2c_f32_bf16 v11, v141, v10
    s_waitcnt lgkmcnt(0)
    v_dot2c_f32_bf16 v11, v142, v10
    v_dot2c_f32_bf16 v11, v143, v10
    s_nop 2
    v_mov_b32 v14, v11
    s_nop 1
    v_permlane32_swap_b32 v11, v14
    v_add_f32 v11, v11, v14
    v_mul_f32 v11, 0xbb124925, v11
    v_mov_b32 v12, 0x3f80
    v_mov_b32 v13, 0x3f800000
    v_lshlrev_b32 v15, 4, v2
    s_lshl_b32 s8, s7, 2
    s_add_u32 s8, s8, s6
    s_mul_i32 s8, s8, 28672
    s_add_u32 s8, s8, 8388608
    s_cmp_ge_u32 s2, 252
    s_cbranch_scc1 SKIP_31
    v_dot2_f32_bf16 v16, v32, v12, v11
    v_dot2_f32_bf16 v17, v32, v13, v11
    v_dot2_f32_bf16 v18, v33, v12, v11
    v_dot2_f32_bf16 v19, v33, v13, v11
    v_dot2_f32_bf16 v20, v34, v12, v11
    v_dot2_f32_bf16 v21, v34, v13, v11
    v_dot2_f32_bf16 v22, v35, v12, v11
    v_dot2_f32_bf16 v23, v35, v13, v11
    v_cvt_pk_bf16_f32 v32, v16, v17
    v_cvt_pk_bf16_f32 v33, v18, v19
    v_cvt_pk_bf16_f32 v34, v20, v21
    v_cvt_pk_bf16_f32 v35, v22, v23
    buffer_store_dwordx4 v[32:35], v15, s[20:23], s8 offen sc1
    v_dot2_f32_bf16 v16, v36, v12, v11
    v_dot2_f32_bf16 v17, v36, v13, v11
    v_dot2_f32_bf16 v18, v37, v12, v11
    v_dot2_f32_bf16 v19, v37, v13, v11
    v_dot2_f32_bf16 v20, v38, v12, v11
    v_dot2_f32_bf16 v21, v38, v13, v11
    v_dot2_f32_bf16 v22, v39, v12, v11
    v_dot2_f32_bf16 v23, v39, v13, v11
    v_cvt_pk_bf16_f32 v36, v16, v17
    v_cvt_pk_bf16_f32 v37, v18, v19
    v_cvt_pk_bf16_f32 v38, v20, v21
    v_cvt_pk_bf16_f32 v39, v22, v23
    buffer_store_dwordx4 v[36:39], v15, s[20:23], s8 offen offset:1024 sc1
    v_dot2_f32_bf16 v16, v40, v12, v11
    v_dot2_f32_bf16 v17, v40, v13, v11
    v_dot2_f32_bf16 v18, v41, v12, v11
    v_dot2_f32_bf16 v19, v41, v13, v11
    v_dot2_f32_bf16 v20, v42, v12, v11
    v_dot2_f32_bf16 v21, v42, v13, v11
    v_dot2_f32_bf16 v22, v43, v12, v11
    v_dot2_f32_bf16 v23, v43, v13, v11
    v_cvt_pk_bf16_f32 v40, v16, v17
    v_cvt_pk_bf16_f32 v41, v18, v19
    v_cvt_pk_bf16_f32 v42, v20, v21
    v_cvt_pk_bf16_f32 v43, v22, v23
    buffer_store_dwordx4 v[40:43], v15, s[20:23], s8 offen offset:2048 sc1
    v_dot2_f32_bf16 v16, v44, v12, v11
    v_dot2_f32_bf16 v17, v44, v13, v11
    v_dot2_f32_bf16 v18, v45, v12, v11
    v_dot2_f32_bf16 v19, v45, v13, v11
    v_dot2_f32_bf16 v20, v46, v12, v11
    v_dot2_f32_bf16 v21, v46, v13, v11
    v_dot2_f32_bf16 v22, v47, v12, v11
    v_dot2_f32_bf16 v23, v47, v13, v11
    v_cvt_pk_bf16_f32 v44, v16, v17
    v_cvt_pk_bf16_f32 v45, v18, v19
    v_cvt_pk_bf16_f32 v46, v20, v21
    v_cvt_pk_bf16_f32 v47, v22, v23
    buffer_store_dwordx4 v[44:47], v15, s[20:23], s8 offen offset:3072 sc1
    v_dot2_f32_bf16 v16, v48, v12, v11
    v_dot2_f32_bf16 v17, v48, v13, v11
    v_dot2_f32_bf16 v18, v49, v12, v11
    v_dot2_f32_bf16 v19, v49, v13, v11
    v_dot2_f32_bf16 v20, v50, v12, v11
    v_dot2_f32_bf16 v21, v50, v13, v11
    v_dot2_f32_bf16 v22, v51, v12, v11
    v_dot2_f32_bf16 v23, v51, v13, v11
    s_add_u32 s8, s8, 4096
    v_cvt_pk_bf16_f32 v48, v16, v17
    v_cvt_pk_bf16_f32 v49, v18, v19
    v_cvt_pk_bf16_f32 v50, v20, v21
    v_cvt_pk_bf16_f32 v51, v22, v23
    buffer_store_dwordx4 v[48:51], v15, s[20:23], s8 offen sc1
    v_dot2_f32_bf16 v16, v52, v12, v11
    v_dot2_f32_bf16 v17, v52, v13, v11
    v_dot2_f32_bf16 v18, v53, v12, v11
    v_dot2_f32_bf16 v19, v53, v13, v11
    v_dot2_f32_bf16 v20, v54, v12, v11
    v_dot2_f32_bf16 v21, v54, v13, v11
    v_dot2_f32_bf16 v22, v55, v12, v11
    v_dot2_f32_bf16 v23, v55, v13, v11
    v_cvt_pk_bf16_f32 v52, v16, v17
    v_cvt_pk_bf16_f32 v53, v18, v19
    v_cvt_pk_bf16_f32 v54, v20, v21
    v_cvt_pk_bf16_f32 v55, v22, v23
    buffer_store_dwordx4 v[52:55], v15, s[20:23], s8 offen offset:1024 sc1
    v_dot2_f32_bf16 v16, v56, v12, v11
    v_dot2_f32_bf16 v17, v56, v13, v11
    v_dot2_f32_bf16 v18, v57, v12, v11
    v_dot2_f32_bf16 v19, v57, v13, v11
    v_dot2_f32_bf16 v20, v58, v12, v11
    v_dot2_f32_bf16 v21, v58, v13, v11
    v_dot2_f32_bf16 v22, v59, v12, v11
    v_dot2_f32_bf16 v23, v59, v13, v11
    v_cvt_pk_bf16_f32 v56, v16, v17
    v_cvt_pk_bf16_f32 v57, v18, v19
    v_cvt_pk_bf16_f32 v58, v20, v21
    v_cvt_pk_bf16_f32 v59, v22, v23
    buffer_store_dwordx4 v[56:59], v15, s[20:23], s8 offen offset:2048 sc1
    v_dot2_f32_bf16 v16, v60, v12, v11
    v_dot2_f32_bf16 v17, v60, v13, v11
    v_dot2_f32_bf16 v18, v61, v12, v11
    v_dot2_f32_bf16 v19, v61, v13, v11
    v_dot2_f32_bf16 v20, v62, v12, v11
    v_dot2_f32_bf16 v21, v62, v13, v11
    v_dot2_f32_bf16 v22, v63, v12, v11
    v_dot2_f32_bf16 v23, v63, v13, v11
    v_cvt_pk_bf16_f32 v60, v16, v17
    v_cvt_pk_bf16_f32 v61, v18, v19
    v_cvt_pk_bf16_f32 v62, v20, v21
    v_cvt_pk_bf16_f32 v63, v22, v23
    buffer_store_dwordx4 v[60:63], v15, s[20:23], s8 offen offset:3072 sc1
    v_dot2_f32_bf16 v16, v64, v12, v11
    v_dot2_f32_bf16 v17, v64, v13, v11
    v_dot2_f32_bf16 v18, v65, v12, v11
    v_dot2_f32_bf16 v19, v65, v13, v11
    v_dot2_f32_bf16 v20, v66, v12, v11
    v_dot2_f32_bf16 v21, v66, v13, v11
    v_dot2_f32_bf16 v22, v67, v12, v11
    v_dot2_f32_bf16 v23, v67, v13, v11
    s_add_u32 s8, s8, 4096
    v_cvt_pk_bf16_f32 v64, v16, v17
    v_cvt_pk_bf16_f32 v65, v18, v19
    v_cvt_pk_bf16_f32 v66, v20, v21
    v_cvt_pk_bf16_f32 v67, v22, v23
    buffer_store_dwordx4 v[64:67], v15, s[20:23], s8 offen sc1
    v_dot2_f32_bf16 v16, v68, v12, v11
    v_dot2_f32_bf16 v17, v68, v13, v11
    v_dot2_f32_bf16 v18, v69, v12, v11
    v_dot2_f32_bf16 v19, v69, v13, v11
    v_dot2_f32_bf16 v20, v70, v12, v11
    v_dot2_f32_bf16 v21, v70, v13, v11
    v_dot2_f32_bf16 v22, v71, v12, v11
    v_dot2_f32_bf16 v23, v71, v13, v11
    v_cvt_pk_bf16_f32 v68, v16, v17
    v_cvt_pk_bf16_f32 v69, v18, v19
    v_cvt_pk_bf16_f32 v70, v20, v21
    v_cvt_pk_bf16_f32 v71, v22, v23
    buffer_store_dwordx4 v[68:71], v15, s[20:23], s8 offen offset:1024 sc1
    v_dot2_f32_bf16 v16, v72, v12, v11
    v_dot2_f32_bf16 v17, v72, v13, v11
    v_dot2_f32_bf16 v18, v73, v12, v11
    v_dot2_f32_bf16 v19, v73, v13, v11
    v_dot2_f32_bf16 v20, v74, v12, v11
    v_dot2_f32_bf16 v21, v74, v13, v11
    v_dot2_f32_bf16 v22, v75, v12, v11
    v_dot2_f32_bf16 v23, v75, v13, v11
    v_cvt_pk_bf16_f32 v72, v16, v17
    v_cvt_pk_bf16_f32 v73, v18, v19
    v_cvt_pk_bf16_f32 v74, v20, v21
    v_cvt_pk_bf16_f32 v75, v22, v23
    buffer_store_dwordx4 v[72:75], v15, s[20:23], s8 offen offset:2048 sc1
    v_dot2_f32_bf16 v16, v76, v12, v11
    v_dot2_f32_bf16 v17, v76, v13, v11
    v_dot2_f32_bf16 v18, v77, v12, v11
    v_dot2_f32_bf16 v19, v77, v13, v11
    v_dot2_f32_bf16 v20, v78, v12, v11
    v_dot2_f32_bf16 v21, v78, v13, v11
    v_dot2_f32_bf16 v22, v79, v12, v11
    v_dot2_f32_bf16 v23, v79, v13, v11
    v_cvt_pk_bf16_f32 v76, v16, v17
    v_cvt_pk_bf16_f32 v77, v18, v19
    v_cvt_pk_bf16_f32 v78, v20, v21
    v_cvt_pk_bf16_f32 v79, v22, v23
    buffer_store_dwordx4 v[76:79], v15, s[20:23], s8 offen offset:3072 sc1
    v_dot2_f32_bf16 v16, v80, v12, v11
    v_dot2_f32_bf16 v17, v80, v13, v11
    v_dot2_f32_bf16 v18, v81, v12, v11
    v_dot2_f32_bf16 v19, v81, v13, v11
    v_dot2_f32_bf16 v20, v82, v12, v11
    v_dot2_f32_bf16 v21, v82, v13, v11
    v_dot2_f32_bf16 v22, v83, v12, v11
    v_dot2_f32_bf16 v23, v83, v13, v11
    s_add_u32 s8, s8, 4096
    v_cvt_pk_bf16_f32 v80, v16, v17
    v_cvt_pk_bf16_f32 v81, v18, v19
    v_cvt_pk_bf16_f32 v82, v20, v21
    v_cvt_pk_bf16_f32 v83, v22, v23
    buffer_store_dwordx4 v[80:83], v15, s[20:23], s8 offen sc1
    v_dot2_f32_bf16 v16, v84, v12, v11
    v_dot2_f32_bf16 v17, v84, v13, v11
    v_dot2_f32_bf16 v18, v85, v12, v11
    v_dot2_f32_bf16 v19, v85, v13, v11
    v_dot2_f32_bf16 v20, v86, v12, v11
    v_dot2_f32_bf16 v21, v86, v13, v11
    v_dot2_f32_bf16 v22, v87, v12, v11
    v_dot2_f32_bf16 v23, v87, v13, v11
    v_cvt_pk_bf16_f32 v84, v16, v17
    v_cvt_pk_bf16_f32 v85, v18, v19
    v_cvt_pk_bf16_f32 v86, v20, v21
    v_cvt_pk_bf16_f32 v87, v22, v23
    buffer_store_dwordx4 v[84:87], v15, s[20:23], s8 offen offset:1024 sc1
    v_dot2_f32_bf16 v16, v88, v12, v11
    v_dot2_f32_bf16 v17, v88, v13, v11
    v_dot2_f32_bf16 v18, v89, v12, v11
    v_dot2_f32_bf16 v19, v89, v13, v11
    v_dot2_f32_bf16 v20, v90, v12, v11
    v_dot2_f32_bf16 v21, v90, v13, v11
    v_dot2_f32_bf16 v22, v91, v12, v11
    v_dot2_f32_bf16 v23, v91, v13, v11
    v_cvt_pk_bf16_f32 v88, v16, v17
    v_cvt_pk_bf16_f32 v89, v18, v19
    v_cvt_pk_bf16_f32 v90, v20, v21
    v_cvt_pk_bf16_f32 v91, v22, v23
    buffer_store_dwordx4 v[88:91], v15, s[20:23], s8 offen offset:2048 sc1
    v_dot2_f32_bf16 v16, v92, v12, v11
    v_dot2_f32_bf16 v17, v92, v13, v11
    v_dot2_f32_bf16 v18, v93, v12, v11
    v_dot2_f32_bf16 v19, v93, v13, v11
    v_dot2_f32_bf16 v20, v94, v12, v11
    v_dot2_f32_bf16 v21, v94, v13, v11
    v_dot2_f32_bf16 v22, v95, v12, v11
    v_dot2_f32_bf16 v23, v95, v13, v11
    v_cvt_pk_bf16_f32 v92, v16, v17
    v_cvt_pk_bf16_f32 v93, v18, v19
    v_cvt_pk_bf16_f32 v94, v20, v21
    v_cvt_pk_bf16_f32 v95, v22, v23
    buffer_store_dwordx4 v[92:95], v15, s[20:23], s8 offen offset:3072 sc1
    v_dot2_f32_bf16 v16, v96, v12, v11
    v_dot2_f32_bf16 v17, v96, v13, v11
    v_dot2_f32_bf16 v18, v97, v12, v11
    v_dot2_f32_bf16 v19, v97, v13, v11
    v_dot2_f32_bf16 v20, v98, v12, v11
    v_dot2_f32_bf16 v21, v98, v13, v11
    v_dot2_f32_bf16 v22, v99, v12, v11
    v_dot2_f32_bf16 v23, v99, v13, v11
    s_add_u32 s8, s8, 4096
    v_cvt_pk_bf16_f32 v96, v16, v17
    v_cvt_pk_bf16_f32 v97, v18, v19
    v_cvt_pk_bf16_f32 v98, v20, v21
    v_cvt_pk_bf16_f32 v99, v22, v23
    buffer_store_dwordx4 v[96:99], v15, s[20:23], s8 offen sc1
    v_dot2_f32_bf16 v16, v100, v12, v11
    v_dot2_f32_bf16 v17, v100, v13, v11
    v_dot2_f32_bf16 v18, v101, v12, v11
    v_dot2_f32_bf16 v19, v101, v13, v11
    v_dot2_f32_bf16 v20, v102, v12, v11
    v_dot2_f32_bf16 v21, v102, v13, v11
    v_dot2_f32_bf16 v22, v103, v12, v11
    v_dot2_f32_bf16 v23, v103, v13, v11
    v_cvt_pk_bf16_f32 v100, v16, v17
    v_cvt_pk_bf16_f32 v101, v18, v19
    v_cvt_pk_bf16_f32 v102, v20, v21
    v_cvt_pk_bf16_f32 v103, v22, v23
    buffer_store_dwordx4 v[100:103], v15, s[20:23], s8 offen offset:1024 sc1
    v_dot2_f32_bf16 v16, v104, v12, v11
    v_dot2_f32_bf16 v17, v104, v13, v11
    v_dot2_f32_bf16 v18, v105, v12, v11
    v_dot2_f32_bf16 v19, v105, v13, v11
    v_dot2_f32_bf16 v20, v106, v12, v11
    v_dot2_f32_bf16 v21, v106, v13, v11
    v_dot2_f32_bf16 v22, v107, v12, v11
    v_dot2_f32_bf16 v23, v107, v13, v11
    v_cvt_pk_bf16_f32 v104, v16, v17
    v_cvt_pk_bf16_f32 v105, v18, v19
    v_cvt_pk_bf16_f32 v106, v20, v21
    v_cvt_pk_bf16_f32 v107, v22, v23
    buffer_store_dwordx4 v[104:107], v15, s[20:23], s8 offen offset:2048 sc1
    v_dot2_f32_bf16 v16, v108, v12, v11
    v_dot2_f32_bf16 v17, v108, v13, v11
    v_dot2_f32_bf16 v18, v109, v12, v11
    v_dot2_f32_bf16 v19, v109, v13, v11
    v_dot2_f32_bf16 v20, v110, v12, v11
    v_dot2_f32_bf16 v21, v110, v13, v11
    v_dot2_f32_bf16 v22, v111, v12, v11
    v_dot2_f32_bf16 v23, v111, v13, v11
    v_cvt_pk_bf16_f32 v108, v16, v17
    v_cvt_pk_bf16_f32 v109, v18, v19
    v_cvt_pk_bf16_f32 v110, v20, v21
    v_cvt_pk_bf16_f32 v111, v22, v23
    buffer_store_dwordx4 v[108:111], v15, s[20:23], s8 offen offset:3072 sc1
    v_dot2_f32_bf16 v16, v112, v12, v11
    v_dot2_f32_bf16 v17, v112, v13, v11
    v_dot2_f32_bf16 v18, v113, v12, v11
    v_dot2_f32_bf16 v19, v113, v13, v11
    v_dot2_f32_bf16 v20, v114, v12, v11
    v_dot2_f32_bf16 v21, v114, v13, v11
    v_dot2_f32_bf16 v22, v115, v12, v11
    v_dot2_f32_bf16 v23, v115, v13, v11
    s_add_u32 s8, s8, 4096
    v_cvt_pk_bf16_f32 v112, v16, v17
    v_cvt_pk_bf16_f32 v113, v18, v19
    v_cvt_pk_bf16_f32 v114, v20, v21
    v_cvt_pk_bf16_f32 v115, v22, v23
    buffer_store_dwordx4 v[112:115], v15, s[20:23], s8 offen sc1
    v_dot2_f32_bf16 v16, v116, v12, v11
    v_dot2_f32_bf16 v17, v116, v13, v11
    v_dot2_f32_bf16 v18, v117, v12, v11
    v_dot2_f32_bf16 v19, v117, v13, v11
    v_dot2_f32_bf16 v20, v118, v12, v11
    v_dot2_f32_bf16 v21, v118, v13, v11
    v_dot2_f32_bf16 v22, v119, v12, v11
    v_dot2_f32_bf16 v23, v119, v13, v11
    v_cvt_pk_bf16_f32 v116, v16, v17
    v_cvt_pk_bf16_f32 v117, v18, v19
    v_cvt_pk_bf16_f32 v118, v20, v21
    v_cvt_pk_bf16_f32 v119, v22, v23
    buffer_store_dwordx4 v[116:119], v15, s[20:23], s8 offen offset:1024 sc1
    v_dot2_f32_bf16 v16, v120, v12, v11
    v_dot2_f32_bf16 v17, v120, v13, v11
    v_dot2_f32_bf16 v18, v121, v12, v11
    v_dot2_f32_bf16 v19, v121, v13, v11
    v_dot2_f32_bf16 v20, v122, v12, v11
    v_dot2_f32_bf16 v21, v122, v13, v11
    v_dot2_f32_bf16 v22, v123, v12, v11
    v_dot2_f32_bf16 v23, v123, v13, v11
    v_cvt_pk_bf16_f32 v120, v16, v17
    v_cvt_pk_bf16_f32 v121, v18, v19
    v_cvt_pk_bf16_f32 v122, v20, v21
    v_cvt_pk_bf16_f32 v123, v22, v23
    buffer_store_dwordx4 v[120:123], v15, s[20:23], s8 offen offset:2048 sc1
    v_dot2_f32_bf16 v16, v124, v12, v11
    v_dot2_f32_bf16 v17, v124, v13, v11
    v_dot2_f32_bf16 v18, v125, v12, v11
    v_dot2_f32_bf16 v19, v125, v13, v11
    v_dot2_f32_bf16 v20, v126, v12, v11
    v_dot2_f32_bf16 v21, v126, v13, v11
    v_dot2_f32_bf16 v22, v127, v12, v11
    v_dot2_f32_bf16 v23, v127, v13, v11
    v_cvt_pk_bf16_f32 v124, v16, v17
    v_cvt_pk_bf16_f32 v125, v18, v19
    v_cvt_pk_bf16_f32 v126, v20, v21
    v_cvt_pk_bf16_f32 v127, v22, v23
    buffer_store_dwordx4 v[124:127], v15, s[20:23], s8 offen offset:3072 sc1
    v_dot2_f32_bf16 v16, v128, v12, v11
    v_dot2_f32_bf16 v17, v128, v13, v11
    v_dot2_f32_bf16 v18, v129, v12, v11
    v_dot2_f32_bf16 v19, v129, v13, v11
    v_dot2_f32_bf16 v20, v130, v12, v11
    v_dot2_f32_bf16 v21, v130, v13, v11
    v_dot2_f32_bf16 v22, v131, v12, v11
    v_dot2_f32_bf16 v23, v131, v13, v11
    s_add_u32 s8, s8, 4096
    v_cvt_pk_bf16_f32 v128, v16, v17
    v_cvt_pk_bf16_f32 v129, v18, v19
    v_cvt_pk_bf16_f32 v130, v20, v21
    v_cvt_pk_bf16_f32 v131, v22, v23
    buffer_store_dwordx4 v[128:131], v15, s[20:23], s8 offen sc1
    v_dot2_f32_bf16 v16, v132, v12, v11
    v_dot2_f32_bf16 v17, v132, v13, v11
    v_dot2_f32_bf16 v18, v133, v12, v11
    v_dot2_f32_bf16 v19, v133, v13, v11
    v_dot2_f32_bf16 v20, v134, v12, v11
    v_dot2_f32_bf16 v21, v134, v13, v11
    v_dot2_f32_bf16 v22, v135, v12, v11
    v_dot2_f32_bf16 v23, v135, v13, v11
    v_cvt_pk_bf16_f32 v132, v16, v17
    v_cvt_pk_bf16_f32 v133, v18, v19
    v_cvt_pk_bf16_f32 v134, v20, v21
    v_cvt_pk_bf16_f32 v135, v22, v23
    buffer_store_dwordx4 v[132:135], v15, s[20:23], s8 offen offset:1024 sc1
    v_dot2_f32_bf16 v16, v136, v12, v11
    v_dot2_f32_bf16 v17, v136, v13, v11
    v_dot2_f32_bf16 v18, v137, v12, v11
    v_dot2_f32_bf16 v19, v137, v13, v11
    v_dot2_f32_bf16 v20, v138, v12, v11
    v_dot2_f32_bf16 v21, v138, v13, v11
    v_dot2_f32_bf16 v22, v139, v12, v11
    v_dot2_f32_bf16 v23, v139, v13, v11
    v_cvt_pk_bf16_f32 v136, v16, v17
    v_cvt_pk_bf16_f32 v137, v18, v19
    v_cvt_pk_bf16_f32 v138, v20, v21
    v_cvt_pk_bf16_f32 v139, v22, v23
    buffer_store_dwordx4 v[136:139], v15, s[20:23], s8 offen offset:2048 sc1
    v_dot2_f32_bf16 v16, v140, v12, v11
    v_dot2_f32_bf16 v17, v140, v13, v11
    v_dot2_f32_bf16 v18, v141, v12, v11
    v_dot2_f32_bf16 v19, v141, v13, v11
    v_dot2_f32_bf16 v20, v142, v12, v11
    v_dot2_f32_bf16 v21, v142, v13, v11
    v_dot2_f32_bf16 v22, v143, v12, v11
    v_dot2_f32_bf16 v23, v143, v13, v11
    v_cvt_pk_bf16_f32 v140, v16, v17
    v_cvt_pk_bf16_f32 v141, v18, v19
    v_cvt_pk_bf16_f32 v142, v20, v21
    v_cvt_pk_bf16_f32 v143, v22, v23
    buffer_store_dwordx4 v[140:143], v15, s[20:23], s8 offen offset:3072 sc1
SKIP_31:
    s_waitcnt vmcnt(0)
    s_waitcnt vmcnt(0)
    s_barrier
    s_cmp_lg_u32 s6, 0
    s_cbranch_scc1 SKIP_33
    s_add_u32 s92, s88, 2
    v_mov_b32 v253, s92
    v_lshlrev_b32 v252, 10, v2
    buffer_store_dword v253, v252, s[20:23], s89 offen sc1
    s_mov_b64 exec, -1
SKIP_33:
    s_lshl_b32 s25, s96, 2
    s_add_u32 s25, s25, s6
    s_mul_i32 s25, s25, 114688
    s_mul_i32 s24, s97, 7168
    s_add_u32 s25, s25, s24
    s_add_u32 s25, s25, 16777216
    v_mov_b32 v232, -1
    v_mov_b32 v233, -1
    v_mov_b32 v234, -1
    v_mov_b32 v235, -1
    s_add_u32 s25, s25, 4096
    buffer_store_dwordx4 v[232:235], v15, s[20:23], s25 offen sc1
    buffer_store_dwordx4 v[232:235], v15, s[20:23], s25 offen offset:1024 sc1
    buffer_store_dwordx4 v[232:235], v15, s[20:23], s25 offen offset:2048 sc1
    s_and_b32 s3, s2, 7
    s_lshl_b32 s3, s3, 2
    s_sub_u32 s62, s2, 224
    s_lshr_b32 s62, s62, 3
    s_add_u32 s3, s3, s62
    s_lshl_b32 s3, s3, 2
    s_add_u32 s3, s3, s6
    s_mul_i32 s62, s3, 57344
    s_add_u32 s62, s62, 16777216
    v_lshlrev_b32 v15, 4, v2
    v_mov_b32 v228, -1
    v_mov_b32 v229, -1
    v_mov_b32 v230, -1
    v_mov_b32 v231, -1
    buffer_store_dwordx4 v[228:231], v15, s[20:23], s62 offen sc1
    buffer_store_dwordx4 v[228:231], v15, s[20:23], s62 offen offset:1024 sc1
    buffer_store_dwordx4 v[228:231], v15, s[20:23], s62 offen offset:2048 sc1
    buffer_store_dwordx4 v[228:231], v15, s[20:23], s62 offen offset:3072 sc1
    s_add_u32 s62, s62, 7168
    buffer_store_dwordx4 v[228:231], v15, s[20:23], s62 offen sc1
    buffer_store_dwordx4 v[228:231], v15, s[20:23], s62 offen offset:1024 sc1
    buffer_store_dwordx4 v[228:231], v15, s[20:23], s62 offen offset:2048 sc1
    buffer_store_dwordx4 v[228:231], v15, s[20:23], s62 offen offset:3072 sc1
    s_add_u32 s62, s62, 7168
    buffer_store_dwordx4 v[228:231], v15, s[20:23], s62 offen sc1
    buffer_store_dwordx4 v[228:231], v15, s[20:23], s62 offen offset:1024 sc1
    buffer_store_dwordx4 v[228:231], v15, s[20:23], s62 offen offset:2048 sc1
    buffer_store_dwordx4 v[228:231], v15, s[20:23], s62 offen offset:3072 sc1
    s_add_u32 s62, s62, 7168
    buffer_store_dwordx4 v[228:231], v15, s[20:23], s62 offen sc1
    buffer_store_dwordx4 v[228:231], v15, s[20:23], s62 offen offset:1024 sc1
    buffer_store_dwordx4 v[228:231], v15, s[20:23], s62 offen offset:2048 sc1
    buffer_store_dwordx4 v[228:231], v15, s[20:23], s62 offen offset:3072 sc1
    s_add_u32 s62, s62, 7168
    buffer_store_dwordx4 v[228:231], v15, s[20:23], s62 offen sc1
    buffer_store_dwordx4 v[228:231], v15, s[20:23], s62 offen offset:1024 sc1
    buffer_store_dwordx4 v[228:231], v15, s[20:23], s62 offen offset:2048 sc1
    buffer_store_dwordx4 v[228:231], v15, s[20:23], s62 offen offset:3072 sc1
    s_add_u32 s62, s62, 7168
    buffer_store_dwordx4 v[228:231], v15, s[20:23], s62 offen sc1
    buffer_store_dwordx4 v[228:231], v15, s[20:23], s62 offen offset:1024 sc1
    buffer_store_dwordx4 v[228:231], v15, s[20:23], s62 offen offset:2048 sc1
    buffer_store_dwordx4 v[228:231], v15, s[20:23], s62 offen offset:3072 sc1
    s_add_u32 s62, s62, 7168
    buffer_store_dwordx4 v[228:231], v15, s[20:23], s62 offen sc1
    buffer_store_dwordx4 v[228:231], v15, s[20:23], s62 offen offset:1024 sc1
    buffer_store_dwordx4 v[228:231], v15, s[20:23], s62 offen offset:2048 sc1
    buffer_store_dwordx4 v[228:231], v15, s[20:23], s62 offen offset:3072 sc1
    s_add_u32 s62, s62, 7168
    buffer_store_dwordx4 v[228:231], v15, s[20:23], s62 offen sc1
    buffer_store_dwordx4 v[228:231], v15, s[20:23], s62 offen offset:1024 sc1
    buffer_store_dwordx4 v[228:231], v15, s[20:23], s62 offen offset:2048 sc1
    buffer_store_dwordx4 v[228:231], v15, s[20:23], s62 offen offset:3072 sc1
    s_waitcnt vmcnt(0)
    s_barrier
    s_cmp_lg_u32 s6, 0
    s_cbranch_scc1 SKIP_35
    s_add_u32 s92, s88, 3
    v_mov_b32 v253, s92
    v_lshlrev_b32 v252, 10, v2
    buffer_store_dword v253, v252, s[20:23], s89 offen sc1
    s_mov_b64 exec, -1
    s_add_u32 s3, s88, 2
    s_mov_b32 s92, 30000
    s_mov_b32 s7, s90
    s_add_u32 s8, s7, 131072
POLL_37:
    buffer_load_dwordx4 v[248:251], v254, s[20:23], s7 offen sc1
    buffer_load_dwordx4 v[244:247], v254, s[20:23], s8 offen sc1
    s_waitcnt vmcnt(0)
    v_subrev_u32 v248, s3, v248
    v_subrev_u32 v249, s3, v249
    v_subrev_u32 v250, s3, v250
    v_subrev_u32 v251, s3, v251
    v_max3_u32 v248, v248, v249, v250
    v_xor_b32 v244, s101, v244
    v_xor_b32 v245, s101, v245
    v_xor_b32 v246, s101, v246
    v_xor_b32 v247, s101, v247
    v_or3_b32 v244, v244, v245, v246
    v_or_b32 v244, v244, v247
    v_cmp_ne_u32 vcc, 0, v244
    s_nop 1
    v_cndmask_b32 v244, 0, -1, vcc
    v_max_u32 v248, v248, v244
    v_max_u32 v248, v248, v251
    v_cmp_lt_u32 vcc, 7, v248
    s_and_b64 exec, vcc, exec
    s_cbranch_scc0 PDONE_38
    s_sub_u32 s92, s92, 1
    s_cmp_lg_u32 s92, 0
    s_cbranch_scc1 POLL_37
PDONE_38:
    s_mov_b64 exec, -1
SKIP_35:
    s_barrier
    v_lshlrev_b32 v4, 4, v2
    s_add_u32 m0, s100, 66560
    s_add_u32 s18, s99, 0
    buffer_load_dwordx4 v4, s[20:23], s18 offen lds
    s_add_u32 m0, s100, 70656
    s_add_u32 s18, s99, 28672
    buffer_load_dwordx4 v4, s[20:23], s18 offen lds
    s_add_u32 m0, s100, 74752
    s_add_u32 s18, s99, 57344
    buffer_load_dwordx4 v4, s[20:23], s18 offen lds
    s_add_u32 m0, s100, 78848
    s_add_u32 s18, s99, 4096
    buffer_load_dwordx4 v4, s[20:23], s18 offen lds
    s_add_u32 m0, s100, 82944
    s_add_u32 s18, s99, 32768
    buffer_load_dwordx4 v4, s[20:23], s18 offen lds
    s_add_u32 m0, s100, 87040
    s_add_u32 s18, s99, 61440
    buffer_load_dwordx4 v4, s[20:23], s18 offen lds
    s_add_u32 m0, s100, 91136
    s_add_u32 s18, s99, 8192
    buffer_load_dwordx4 v4, s[20:23], s18 offen lds
    s_add_u32 m0, s100, 95232
    s_add_u32 s18, s99, 36864
    buffer_load_dwordx4 v4, s[20:23], s18 offen lds
    s_add_u32 m0, s100, 99328
    s_add_u32 s18, s99, 65536
    buffer_load_dwordx4 v4, s[20:23], s18 offen lds
    s_add_u32 m0, s100, 103424
    s_add_u32 s18, s99, 12288
    buffer_load_dwordx4 v4, s[20:23], s18 offen lds
    s_add_u32 m0, s100, 107520
    s_add_u32 s18, s99, 40960
    buffer_load_dwordx4 v4, s[20:23], s18 offen lds
    s_add_u32 m0, s100, 111616
    s_add_u32 s18, s99, 69632
    buffer_load_dwordx4 v4, s[20:23], s18 offen lds
    s_add_u32 m0, s100, 115712
    s_add_u32 s18, s99, 16384
    buffer_load_dwordx4 v4, s[20:23], s18 offen lds
    s_add_u32 m0, s100, 119808
    s_add_u32 s18, s99, 45056
    buffer_load_dwordx4 v4, s[20:23], s18 offen lds
    s_add_u32 m0, s100, 123904
    s_add_u32 s18, s99, 73728
    buffer_load_dwordx4 v4, s[20:23], s18 offen lds
    s_add_u32 m0, s100, 128000
    s_add_u32 s18, s99, 20480
    buffer_load_dwordx4 v4, s[20:23], s18 offen lds
    s_add_u32 m0, s100, 132096
    s_add_u32 s18, s99, 49152
    buffer_load_dwordx4 v4, s[20:23], s18 offen lds
    s_add_u32 m0, s100, 136192
    s_add_u32 s18, s99, 77824
    buffer_load_dwordx4 v4, s[20:23], s18 offen lds
    s_add_u32 m0, s100, 140288
    s_add_u32 s18, s99, 24576
    buffer_load_dwordx4 v4, s[20:23], s18 offen lds
    s_add_u32 m0, s100, 144384
    s_add_u32 s18, s99, 53248
    buffer_load_dwordx4 v4, s[20:23], s18 offen lds
    s_add_u32 m0, s100, 148480
    s_add_u32 s18, s99, 81920
    buffer_load_dwordx4 v4, s[20:23], s18 offen lds
    s_add_u32 m0, s100, 152576
    s_add_u32 s18, s99, 86016
    buffer_load_dwordx4 v4, s[20:23], s18 offen lds
    s_add_u32 m0, s100, 156672
    s_add_u32 s18, s99, 90112
    buffer_load_dwordx4 v4, s[20:23], s18 offen lds
    v_lshrrev_b32 v5, 2, v2
    v_lshlrev_b32 v5, 12, v5
    v_and_b32 v6, 3, v2
    v_lshl_add_u32 v3, v6, 4, v5
    v_lshlrev_b32 v4, 4, v2
    v_lshrrev_b32 v16, 5, v2
    v_lshlrev_b32 v16, 3, v16
    v_bfe_u32 v17, v2, 2, 2
    v_add_u32 v16, v16, v17
    v_lshlrev_b32 v16, 6, v16
    v_bfe_u32 v17, v2, 4, 1
    v_lshl_add_u32 v16, v17, 5, v16
    v_lshl_add_u32 v16, v6, 3, v16
    s_add_u32 s12, s100, 17408
    v_add_u32 v12, s12, v16
    v_add_u32 v8, 17408, v4
    v_add_u32 v9, 82944, v4
    v_add_u32 v10, 148480, v4
    s_mov_b32 s60, -1
    s_mov_b32 s61, 0
    v_mov_b32 v241, 0
    v_mov_b32 v242, 0
    v_mov_b32 v243, 0
    v_mov_b32 v16, 0x3f803f80
    v_mov_b32 v17, 0
    v_mov_b32 v13, 0
    v_mov_b32 v18, 0
    v_mov_b32 v14, 0
    s_lshl_b32 s13, s96, 8
    s_lshl_b32 s12, s6, 6
    s_add_u32 s13, s13, s12
    s_add_u32 s13, s13, 2097152
    s_mov_b32 vcc_lo, 0x10100101
    s_mov_b32 vcc_hi, 0x10100101
    v_cndmask_b32 v16, 0, v16, vcc
    v_accvgpr_write_b32 a240, v16
    v_accvgpr_write_b32 a241, v16
    v_accvgpr_write_b32 a242, v16
    v_accvgpr_write_b32 a243, v16
    s_lshl_b32 s19, s96, 2
    s_add_u32 s19, s19, s6
    s_mul_i32 s19, s19, 114688
    s_mul_i32 s24, s97, 7168
    s_add_u32 s19, s19, s24
    s_add_u32 s19, s19, 16777216
    s_lshl_b32 s26, s95, 1
    s_lshr_b32 s27, s6, 1
    s_add_u32 s26, s26, s27
    s_xor_b32 s27, s26, 1
    s_mul_i32 s26, s26, 114688
    s_mul_i32 s27, s27, 114688
    s_mul_i32 s28, s6, 28672
    s_add_u32 s28, s28, 12582912
    s_add_u32 s48, s26, s28
    s_add_u32 s52, s27, s28
    s_add_u32 s49, s48, 7168
    s_add_u32 s53, s52, 7168
    s_add_u32 s50, s48, 14336
    s_add_u32 s54, s52, 14336
    s_add_u32 s51, s48, 21504
    s_add_u32 s55, s52, 21504
    v_add_u32 v246, 4096, v4
    s_and_b32 s11, s6, 1
    s_lshr_b32 s12, s6, 1
    s_lshl_b32 s40, s94, 1
    s_add_u32 s40, s40, s11
    s_lshl_b32 s41, s95, 1
    s_add_u32 s41, s41, s12
    s_lshl_b32 s42, s41, 17
    s_lshl_b32 s43, s40, 6
    s_add_u32 s42, s42, s43
    s_add_u32 s43, s42, 2097152
    s_xor_b32 s45, s40, 1
    s_mul_i32 s44, s40, 114688
    s_mul_i32 s45, s45, 114688
    s_mul_i32 s46, s6, 28672
    s_add_u32 s46, s46, 16777216
    s_add_u32 s32, s44, s46
    s_add_u32 s56, s45, s46
    s_lshl_b32 s47, s6, 11
    s_add_u32 s47, s47, 152576
    v_add_u32 v22, 4096, v4
    s_add_u32 s33, s32, 7168
    s_add_u32 s57, s56, 7168
    s_add_u32 s34, s32, 14336
    s_add_u32 s58, s56, 14336
    s_add_u32 s35, s32, 21504
    s_add_u32 s59, s56, 21504
    s_waitcnt vmcnt(0)
    s_cmp_lg_u32 s6, 0
    s_cbranch_scc1 SKIP_39
    s_add_u32 s3, s88, 3
    s_mov_b32 s92, 30000
POLL_41:
    buffer_load_dwordx4 v[248:251], v254, s[20:23], s90 offen sc1
    s_waitcnt vmcnt(0)
    v_subrev_u32 v248, s3, v248
    v_subrev_u32 v249, s3, v249
    v_subrev_u32 v250, s3, v250
    v_subrev_u32 v251, s3, v251
    v_max3_u32 v248, v248, v249, v250
    v_max_u32 v248, v248, v251
    v_cmp_lt_u32 vcc, 7, v248
    s_and_b64 exec, vcc, exec
    s_cbranch_scc0 PDONE_42
    s_sub_u32 s92, s92, 1
    s_cmp_lg_u32 s92, 0
    s_cbranch_scc1 POLL_41
PDONE_42:
    s_mov_b64 exec, -1
SKIP_39:
    s_barrier
L_GLU1:
    s_nop 7
PAD_B_0:
    s_cbranch_execz PAD_B_1
    s_add_u32 m0, s100, 17408
    s_nop 0
    buffer_load_dwordx4 v3, s[20:23], s13 offen lds
    s_add_u32 m0, s100, 21504
    s_add_u32 s18, s13, 65536
    buffer_load_dwordx4 v3, s[20:23], s18 offen lds
    s_add_u32 m0, s100, 25600
    s_add_u32 s18, s13, 131072
    buffer_load_dwordx4 v3, s[20:23], s18 offen lds
    s_add_u32 m0, s100, 29696
    s_add_u32 s18, s13, 196608
    buffer_load_dwordx4 v3, s[20:23], s18 offen lds
    s_add_u32 m0, s100, 33792
    s_add_u32 s18, s13, 262144
    buffer_load_dwordx4 v3, s[20:23], s18 offen lds
    s_add_u32 m0, s100, 37888
    s_add_u32 s18, s13, 327680
    buffer_load_dwordx4 v3, s[20:23], s18 offen lds
    s_add_u32 m0, s100, 41984
    s_add_u32 s18, s13, 393216
    buffer_load_dwordx4 v3, s[20:23], s18 offen lds
    s_add_u32 m0, s100, 46080
    s_add_u32 s18, s13, 458752
    buffer_load_dwordx4 v3, s[20:23], s18 offen lds
    s_add_u32 m0, s100, 50176
    s_add_u32 s18, s13, 524288
    buffer_load_dwordx4 v3, s[20:23], s18 offen lds
    s_add_u32 m0, s100, 54272
    s_add_u32 s18, s13, 589824
    buffer_load_dwordx4 v3, s[20:23], s18 offen lds
    s_add_u32 m0, s100, 58368
    s_add_u32 s18, s13, 655360
    buffer_load_dwordx4 v3, s[20:23], s18 offen lds
    s_add_u32 m0, s100, 62464
    s_add_u32 s18, s13, 720896
    buffer_load_dwordx4 v3, s[20:23], s18 offen lds
    s_cmp_lg_u32 s6, 0
    s_cbranch_scc1 SKIP_43
    buffer_load_dwordx4 a[0:3], v4, s[20:23], s48 offen
    buffer_load_dwordx4 a[4:7], v4, s[20:23], s52 offen
    buffer_load_dwordx4 a[56:59], v4, s[20:23], s49 offen
PAD_B_1:
    s_cbranch_execz PRET_B
    buffer_load_dwordx4 a[60:63], v4, s[20:23], s53 offen
    buffer_load_dwordx4 a[112:115], v4, s[20:23], s50 offen
    buffer_load_dwordx4 a[116:119], v4, s[20:23], s54 offen
    buffer_load_dwordx4 a[168:171], v4, s[20:23], s51 offen
    buffer_load_dwordx4 a[172:175], v4, s[20:23], s55 offen
    buffer_load_dwordx4 a[8:11], v4, s[20:23], s48 offen offset:1024
    buffer_load_dwordx4 a[12:15], v4, s[20:23], s52 offen offset:1024
    buffer_load_dwordx4 a[64:67], v4, s[20:23], s49 offen offset:1024
    buffer_load_dwordx4 a[68:71], v4, s[20:23], s53 offen offset:1024
    buffer_load_dwordx4 a[120:123], v4, s[20:23], s50 offen offset:1024
    buffer_load_dwordx4 a[124:127], v4, s[20:23], s54 offen offset:1024
    buffer_load_dwordx4 a[176:179], v4, s[20:23], s51 offen offset:1024
    buffer_load_dwordx4 a[180:183], v4, s[20:23], s55 offen offset:1024
    buffer_load_dwordx4 a[16:19], v4, s[20:23], s48 offen offset:2048
    buffer_load_dwordx4 a[20:23], v4, s[20:23], s52 offen offset:2048
    buffer_load_dwordx4 a[72:75], v4, s[20:23], s49 offen offset:2048
    buffer_load_dwordx4 a[76:79], v4, s[20:23], s53 offen offset:2048
    buffer_load_dwordx4 a[128:131], v4, s[20:23], s50 offen offset:2048
    buffer_load_dwordx4 a[132:135], v4, s[20:23], s54 offen offset:2048
    buffer_load_dwordx4 a[184:187], v4, s[20:23], s51 offen offset:2048
    buffer_load_dwordx4 a[188:191], v4, s[20:23], s55 offen offset:2048
    buffer_load_dwordx4 a[24:27], v4, s[20:23], s48 offen offset:3072
    buffer_load_dwordx4 a[28:31], v4, s[20:23], s52 offen offset:3072
    buffer_load_dwordx4 a[80:83], v4, s[20:23], s49 offen offset:3072
    buffer_load_dwordx4 a[84:87], v4, s[20:23], s53 offen offset:3072
SKIP_43:
    ds_read_b128 v[144:147], v8 offset:49152
    ds_read_b128 v[148:151], v8 offset:53248
    ds_read_b128 v[152:155], v8 offset:57344
    ds_read_b128 v[156:159], v8 offset:50176
    ds_read_b128 v[160:163], v8 offset:54272
    ds_read_b128 v[164:167], v8 offset:58368
    ds_read_b128 v[168:171], v8 offset:51200
    s_waitcnt vmcnt(11)
    ds_read_b64_tr_b16 v[32:33], v12 offset:0
    ds_read_b64_tr_b16 v[34:35], v12 offset:256
    s_waitcnt vmcnt(10)
    ds_read_b64_tr_b16 v[36:37], v12 offset:4096
    ds_read_b64_tr_b16 v[38:39], v12 offset:4352
    s_waitcnt lgkmcnt(2)
    v_mfma_f32_32x32x16_bf16 v[176:191], v[144:147], v[32:35], 0
    ds_read_b128 v[172:175], v8 offset:55296
    s_waitcnt vmcnt(9)
PAD_B_2:
    s_cbranch_execz PAD_B_3
    ds_read_b64_tr_b16 v[40:41], v12 offset:8192
    v_dot2c_f32_bf16 v18, v32, v32
    v_dot2c_f32_bf16 v14, v33, v33
    v_dot2c_f32_bf16 v18, v34, v34
    v_dot2c_f32_bf16 v14, v35, v35
    v_mfma_f32_32x32x16_bf16 v[192:207], v[148:151], v[32:35], 0
    ds_read_b128 v[144:147], v8 offset:59392
    ds_read_b64_tr_b16 v[42:43], v12 offset:8448
    v_mfma_f32_32x32x16_bf16 v[208:223], v[152:155], v[32:35], 0
    ds_read_b128 v[148:151], v8 offset:52224
    s_add_u32 m0, s100, 17408
    s_add_u32 s18, s13, 786432
    buffer_load_dwordx4 v3, s[20:23], s18 offen lds
    v_mfma_f32_16x16x32_bf16 a[244:247], a[240:243], v[32:35], 0
    s_waitcnt lgkmcnt(5)
    v_mfma_f32_32x32x16_bf16 v[176:191], v[156:159], v[36:39], v[176:191]
    ds_read_b128 v[152:155], v8 offset:56320
    s_waitcnt vmcnt(9)
    ds_read_b64_tr_b16 v[44:45], v12 offset:12288
    v_dot2c_f32_bf16 v18, v36, v36
    v_dot2c_f32_bf16 v14, v37, v37
    v_dot2c_f32_bf16 v18, v38, v38
    v_dot2c_f32_bf16 v14, v39, v39
    v_mfma_f32_32x32x16_bf16 v[192:207], v[160:163], v[36:39], v[192:207]
    ds_read_b128 v[156:159], v8 offset:60416
    ds_read_b64_tr_b16 v[46:47], v12 offset:12544
    v_mfma_f32_32x32x16_bf16 v[208:223], v[164:167], v[36:39], v[208:223]
    ds_read_b128 v[160:163], v8 offset:61440
    s_add_u32 m0, s100, 21504
    s_add_u32 s18, s13, 851968
    buffer_load_dwordx4 v3, s[20:23], s18 offen lds
    v_mfma_f32_16x16x32_bf16 a[244:247], a[240:243], v[36:39], a[244:247]
    s_waitcnt lgkmcnt(6)
PAD_B_3:
    s_cbranch_execz PRET_B
    v_mfma_f32_32x32x16_bf16 v[176:191], v[168:171], v[40:43], v[176:191]
    ds_read_b128 v[164:167], v9 offset:0
    s_waitcnt vmcnt(9)
    ds_read_b64_tr_b16 v[48:49], v12 offset:16384
    v_dot2c_f32_bf16 v18, v40, v40
    v_dot2c_f32_bf16 v14, v41, v41
    v_dot2c_f32_bf16 v18, v42, v42
    v_dot2c_f32_bf16 v14, v43, v43
    v_mfma_f32_32x32x16_bf16 v[192:207], v[172:175], v[40:43], v[192:207]
    ds_read_b128 v[168:171], v9 offset:4096
    ds_read_b64_tr_b16 v[50:51], v12 offset:16640
    v_mfma_f32_32x32x16_bf16 v[208:223], v[144:147], v[40:43], v[208:223]
    ds_read_b128 v[172:175], v8 offset:62464
    s_add_u32 m0, s100, 25600
    s_add_u32 s18, s13, 917504
    buffer_load_dwordx4 v3, s[20:23], s18 offen lds
    v_mfma_f32_16x16x32_bf16 a[244:247], a[240:243], v[40:43], a[244:247]
    s_waitcnt lgkmcnt(6)
    v_mfma_f32_32x32x16_bf16 v[176:191], v[148:151], v[44:47], v[176:191]
    ds_read_b128 v[144:147], v9 offset:1024
    s_waitcnt vmcnt(9)
    ds_read_b64_tr_b16 v[52:53], v12 offset:20480
    v_dot2c_f32_bf16 v18, v44, v44
    v_dot2c_f32_bf16 v14, v45, v45
    v_dot2c_f32_bf16 v18, v46, v46
    v_dot2c_f32_bf16 v14, v47, v47
    v_mfma_f32_32x32x16_bf16 v[192:207], v[152:155], v[44:47], v[192:207]
    ds_read_b128 v[148:151], v9 offset:5120
    ds_read_b64_tr_b16 v[54:55], v12 offset:20736
    v_mfma_f32_32x32x16_bf16 v[208:223], v[156:159], v[44:47], v[208:223]
    ds_read_b128 v[152:155], v8 offset:63488
    s_add_u32 m0, s100, 29696
    s_add_u32 s18, s13, 983040
    buffer_load_dwordx4 v3, s[20:23], s18 offen lds
    v_mfma_f32_16x16x32_bf16 a[244:247], a[240:243], v[44:47], a[244:247]
    s_waitcnt lgkmcnt(6)
PAD_B_4:
    s_cbranch_execz PRET_B
    v_mfma_f32_32x32x16_bf16 v[176:191], v[160:163], v[48:51], v[176:191]
    ds_read_b128 v[156:159], v9 offset:2048
    s_waitcnt vmcnt(9)
    ds_read_b64_tr_b16 v[56:57], v12 offset:24576
    v_dot2c_f32_bf16 v18, v48, v48
    v_dot2c_f32_bf16 v14, v49, v49
    v_dot2c_f32_bf16 v18, v50, v50
    v_dot2c_f32_bf16 v14, v51, v51
    v_mfma_f32_32x32x16_bf16 v[192:207], v[164:167], v[48:51], v[192:207]
    ds_read_b128 v[160:163], v9 offset:6144
    ds_read_b64_tr_b16 v[58:59], v12 offset:24832
    v_mfma_f32_32x32x16_bf16 v[208:223], v[168:171], v[48:51], v[208:223]
    ds_read_b128 v[164:167], v8 offset:64512
    s_add_u32 m0, s100, 33792
    s_add_u32 s18, s13, 1048576
    buffer_load_dwordx4 v3, s[20:23], s18 offen lds
    v_mfma_f32_16x16x32_bf16 a[244:247], a[240:243], v[48:51], a[244:247]
    s_waitcnt lgkmcnt(6)
    v_mfma_f32_32x32x16_bf16 v[176:191], v[172:175], v[52:55], v[176:191]
    ds_read_b128 v[168:171], v9 offset:3072
    s_waitcnt vmcnt(9)
    ds_read_b64_tr_b16 v[60:61], v12 offset:28672
    v_dot2c_f32_bf16 v18, v52, v52
    v_dot2c_f32_bf16 v14, v53, v53
    v_dot2c_f32_bf16 v18, v54, v54
    v_dot2c_f32_bf16 v14, v55, v55
    v_mfma_f32_32x32x16_bf16 v[192:207], v[144:147], v[52:55], v[192:207]
    ds_read_b128 v[172:175], v9 offset:7168
    ds_read_b64_tr_b16 v[62:63], v12 offset:28928
    v_mfma_f32_32x32x16_bf16 v[208:223], v[148:151], v[52:55], v[208:223]
    ds_read_b128 v[144:147], v9 offset:8192
    s_add_u32 m0, s100, 37888
    s_add_u32 s18, s13, 1114112
    buffer_load_dwordx4 v3, s[20:23], s18 offen lds
    v_mfma_f32_16x16x32_bf16 a[244:247], a[240:243], v[52:55], a[244:247]
    s_waitcnt lgkmcnt(6)
PAD_B_5:
    s_cbranch_execz PAD_B_6
    v_mfma_f32_32x32x16_bf16 v[176:191], v[152:155], v[56:59], v[176:191]
    ds_read_b128 v[148:151], v9 offset:12288
    s_waitcnt vmcnt(9)
    ds_read_b64_tr_b16 v[64:65], v12 offset:32768
    v_dot2c_f32_bf16 v18, v56, v56
    v_dot2c_f32_bf16 v14, v57, v57
    v_dot2c_f32_bf16 v18, v58, v58
    v_dot2c_f32_bf16 v14, v59, v59
    v_mfma_f32_32x32x16_bf16 v[192:207], v[156:159], v[56:59], v[192:207]
    ds_read_b128 v[152:155], v9 offset:16384
    ds_read_b64_tr_b16 v[66:67], v12 offset:33024
    v_mfma_f32_32x32x16_bf16 v[208:223], v[160:163], v[56:59], v[208:223]
    ds_read_b128 v[156:159], v9 offset:9216
    s_add_u32 m0, s100, 41984
    s_add_u32 s18, s13, 1179648
    buffer_load_dwordx4 v3, s[20:23], s18 offen lds
    v_mfma_f32_16x16x32_bf16 a[244:247], a[240:243], v[56:59], a[244:247]
    s_waitcnt lgkmcnt(6)
    v_mfma_f32_32x32x16_bf16 v[176:191], v[164:167], v[60:63], v[176:191]
    ds_read_b128 v[160:163], v9 offset:13312
    s_waitcnt vmcnt(9)
    ds_read_b64_tr_b16 v[68:69], v12 offset:36864
    v_dot2c_f32_bf16 v18, v60, v60
    v_dot2c_f32_bf16 v14, v61, v61
    v_dot2c_f32_bf16 v18, v62, v62
    v_dot2c_f32_bf16 v14, v63, v63
    v_mfma_f32_32x32x16_bf16 v[192:207], v[168:171], v[60:63], v[192:207]
    ds_read_b128 v[164:167], v9 offset:17408
    ds_read_b64_tr_b16 v[70:71], v12 offset:37120
    v_mfma_f32_32x32x16_bf16 v[208:223], v[172:175], v[60:63], v[208:223]
    ds_read_b128 v[168:171], v9 offset:10240
    s_add_u32 m0, s100, 46080
    s_add_u32 s18, s13, 1245184
    buffer_load_dwordx4 v3, s[20:23], s18 offen lds
    v_mfma_f32_16x16x32_bf16 a[244:247], a[240:243], v[60:63], a[244:247]
    s_waitcnt lgkmcnt(6)
PAD_B_6:
    s_cbranch_execz PRET_B
    v_mfma_f32_32x32x16_bf16 v[176:191], v[144:147], v[64:67], v[176:191]
    ds_read_b128 v[172:175], v9 offset:14336
    s_waitcnt vmcnt(9)
    ds_read_b64_tr_b16 v[72:73], v12 offset:40960
    v_dot2c_f32_bf16 v18, v64, v64
    v_dot2c_f32_bf16 v14, v65, v65
    v_dot2c_f32_bf16 v18, v66, v66
    v_dot2c_f32_bf16 v14, v67, v67
    v_mfma_f32_32x32x16_bf16 v[192:207], v[148:151], v[64:67], v[192:207]
    ds_read_b128 v[144:147], v9 offset:18432
    ds_read_b64_tr_b16 v[74:75], v12 offset:41216
    v_mfma_f32_32x32x16_bf16 v[208:223], v[152:155], v[64:67], v[208:223]
    ds_read_b128 v[148:151], v9 offset:11264
    s_add_u32 m0, s100, 50176
    s_add_u32 s18, s13, 1310720
    buffer_load_dwordx4 v3, s[20:23], s18 offen lds
    v_mfma_f32_16x16x32_bf16 a[244:247], a[240:243], v[64:67], a[244:247]
    s_waitcnt lgkmcnt(6)
    v_mfma_f32_32x32x16_bf16 v[176:191], v[156:159], v[68:71], v[176:191]
    ds_read_b128 v[152:155], v9 offset:15360
    s_waitcnt vmcnt(9)
    ds_read_b64_tr_b16 v[76:77], v12 offset:45056
    v_dot2c_f32_bf16 v18, v68, v68
    v_dot2c_f32_bf16 v14, v69, v69
    v_dot2c_f32_bf16 v18, v70, v70
    v_dot2c_f32_bf16 v14, v71, v71
    v_mfma_f32_32x32x16_bf16 v[192:207], v[160:163], v[68:71], v[192:207]
    ds_read_b128 v[156:159], v9 offset:19456
    ds_read_b64_tr_b16 v[78:79], v12 offset:45312
    v_mfma_f32_32x32x16_bf16 v[208:223], v[164:167], v[68:71], v[208:223]
    ds_read_b128 v[160:163], v9 offset:20480
    s_add_u32 m0, s100, 54272
    s_add_u32 s18, s13, 1376256
    buffer_load_dwordx4 v3, s[20:23], s18 offen lds
    v_mfma_f32_16x16x32_bf16 a[244:247], a[240:243], v[68:71], a[244:247]
    s_waitcnt lgkmcnt(6)
PAD_B_7:
    s_cbranch_execz PAD_B_8
    v_mfma_f32_32x32x16_bf16 v[176:191], v[168:171], v[72:75], v[176:191]
    ds_read_b128 v[164:167], v9 offset:24576
    s_waitcnt vmcnt(9)
    ds_read_b64_tr_b16 v[80:81], v12 offset:0
    v_dot2c_f32_bf16 v18, v72, v72
    v_dot2c_f32_bf16 v14, v73, v73
    v_dot2c_f32_bf16 v18, v74, v74
    v_dot2c_f32_bf16 v14, v75, v75
    v_mfma_f32_32x32x16_bf16 v[192:207], v[172:175], v[72:75], v[192:207]
    ds_read_b128 v[168:171], v9 offset:28672
    ds_read_b64_tr_b16 v[82:83], v12 offset:256
    v_mfma_f32_32x32x16_bf16 v[208:223], v[144:147], v[72:75], v[208:223]
    ds_read_b128 v[172:175], v9 offset:21504
    s_add_u32 m0, s100, 58368
    s_add_u32 s18, s13, 1441792
    buffer_load_dwordx4 v3, s[20:23], s18 offen lds
    v_mfma_f32_16x16x32_bf16 a[244:247], a[240:243], v[72:75], a[244:247]
    s_waitcnt lgkmcnt(6)
    v_mfma_f32_32x32x16_bf16 v[176:191], v[148:151], v[76:79], v[176:191]
    ds_read_b128 v[144:147], v9 offset:25600
    s_waitcnt vmcnt(9)
    ds_read_b64_tr_b16 v[84:85], v12 offset:4096
    v_dot2c_f32_bf16 v18, v76, v76
    v_dot2c_f32_bf16 v14, v77, v77
    v_dot2c_f32_bf16 v18, v78, v78
    v_dot2c_f32_bf16 v14, v79, v79
    v_mfma_f32_32x32x16_bf16 v[192:207], v[152:155], v[76:79], v[192:207]
    ds_read_b128 v[148:151], v9 offset:29696
    ds_read_b64_tr_b16 v[86:87], v12 offset:4352
    v_mfma_f32_32x32x16_bf16 v[208:223], v[156:159], v[76:79], v[208:223]
    ds_read_b128 v[152:155], v9 offset:22528
    s_add_u32 m0, s100, 62464
    s_add_u32 s18, s13, 1507328
    buffer_load_dwordx4 v3, s[20:23], s18 offen lds
    v_mfma_f32_16x16x32_bf16 a[244:247], a[240:243], v[76:79], a[244:247]
    s_waitcnt lgkmcnt(6)
PAD_B_8:
    s_cbranch_execz PRET_B
    v_mfma_f32_32x32x16_bf16 v[176:191], v[160:163], v[80:83], v[176:191]
    ds_read_b128 v[156:159], v9 offset:26624
    s_waitcnt vmcnt(9)
    ds_read_b64_tr_b16 v[88:89], v12 offset:8192
    v_dot2c_f32_bf16 v18, v80, v80
    v_dot2c_f32_bf16 v14, v81, v81
    v_dot2c_f32_bf16 v18, v82, v82
    v_dot2c_f32_bf16 v14, v83, v83
    v_mfma_f32_32x32x16_bf16 v[192:207], v[164:167], v[80:83], v[192:207]
    ds_read_b128 v[160:163], v9 offset:30720
    ds_read_b64_tr_b16 v[90:91], v12 offset:8448
    v_mfma_f32_32x32x16_bf16 v[208:223], v[168:171], v[80:83], v[208:223]
    ds_read_b128 v[164:167], v9 offset:23552
    s_add_u32 m0, s100, 17408
    s_add_u32 s18, s13, 1572864
    buffer_load_dwordx4 v3, s[20:23], s18 offen lds
    v_mfma_f32_16x16x32_bf16 a[244:247], a[240:243], v[80:83], a[244:247]
    s_waitcnt lgkmcnt(6)
    v_mfma_f32_32x32x16_bf16 v[176:191], v[172:175], v[84:87], v[176:191]
    ds_read_b128 v[168:171], v9 offset:27648
    s_waitcnt vmcnt(9)
    ds_read_b64_tr_b16 v[92:93], v12 offset:12288
    v_dot2c_f32_bf16 v18, v84, v84
    v_dot2c_f32_bf16 v14, v85, v85
    v_dot2c_f32_bf16 v18, v86, v86
    v_dot2c_f32_bf16 v14, v87, v87
    v_mfma_f32_32x32x16_bf16 v[192:207], v[144:147], v[84:87], v[192:207]
    ds_read_b128 v[172:175], v9 offset:31744
    ds_read_b64_tr_b16 v[94:95], v12 offset:12544
    v_mfma_f32_32x32x16_bf16 v[208:223], v[148:151], v[84:87], v[208:223]
    ds_read_b128 v[144:147], v9 offset:32768
    s_add_u32 m0, s100, 21504
    s_add_u32 s18, s13, 1638400
    buffer_load_dwordx4 v3, s[20:23], s18 offen lds
    v_mfma_f32_16x16x32_bf16 a[244:247], a[240:243], v[84:87], a[244:247]
    s_waitcnt lgkmcnt(6)
PAD_B_9:
    s_cbranch_execz PAD_B_10
    v_mfma_f32_32x32x16_bf16 v[176:191], v[152:155], v[88:91], v[176:191]
    ds_read_b128 v[148:151], v9 offset:36864
    s_waitcnt vmcnt(9)
    ds_read_b64_tr_b16 v[96:97], v12 offset:16384
    v_dot2c_f32_bf16 v18, v88, v88
    v_dot2c_f32_bf16 v14, v89, v89
    v_dot2c_f32_bf16 v18, v90, v90
    v_dot2c_f32_bf16 v14, v91, v91
    v_mfma_f32_32x32x16_bf16 v[192:207], v[156:159], v[88:91], v[192:207]
    ds_read_b128 v[152:155], v9 offset:40960
    ds_read_b64_tr_b16 v[98:99], v12 offset:16640
    v_mfma_f32_32x32x16_bf16 v[208:223], v[160:163], v[88:91], v[208:223]
    ds_read_b128 v[156:159], v9 offset:33792
    s_add_u32 m0, s100, 25600
    s_add_u32 s18, s13, 1703936
    buffer_load_dwordx4 v3, s[20:23], s18 offen lds
    v_mfma_f32_16x16x32_bf16 a[244:247], a[240:243], v[88:91], a[244:247]
    s_waitcnt lgkmcnt(6)
    v_mfma_f32_32x32x16_bf16 v[176:191], v[164:167], v[92:95], v[176:191]
    ds_read_b128 v[160:163], v9 offset:37888
    s_waitcnt vmcnt(9)
    ds_read_b64_tr_b16 v[100:101], v12 offset:20480
    v_dot2c_f32_bf16 v18, v92, v92
    v_dot2c_f32_bf16 v14, v93, v93
    v_dot2c_f32_bf16 v18, v94, v94
    v_dot2c_f32_bf16 v14, v95, v95
    v_mfma_f32_32x32x16_bf16 v[192:207], v[168:171], v[92:95], v[192:207]
    ds_read_b128 v[164:167], v9 offset:41984
    ds_read_b64_tr_b16 v[102:103], v12 offset:20736
    v_mfma_f32_32x32x16_bf16 v[208:223], v[172:175], v[92:95], v[208:223]
    ds_read_b128 v[168:171], v9 offset:34816
    s_add_u32 m0, s100, 29696
    s_add_u32 s18, s13, 1769472
    buffer_load_dwordx4 v3, s[20:23], s18 offen lds
    v_mfma_f32_16x16x32_bf16 a[244:247], a[240:243], v[92:95], a[244:247]
    s_barrier
    s_waitcnt lgkmcnt(6)
PAD_B_10:
    s_cbranch_execz PRET_B
    v_mfma_f32_32x32x16_bf16 v[176:191], v[144:147], v[96:99], v[176:191]
    ds_read_b128 v[172:175], v9 offset:38912
    s_waitcnt vmcnt(9)
    ds_read_b64_tr_b16 v[104:105], v12 offset:24576
    v_dot2c_f32_bf16 v18, v96, v96
    v_dot2c_f32_bf16 v14, v97, v97
    v_dot2c_f32_bf16 v18, v98, v98
    v_dot2c_f32_bf16 v14, v99, v99
    v_mfma_f32_32x32x16_bf16 v[192:207], v[148:151], v[96:99], v[192:207]
    ds_read_b128 v[144:147], v9 offset:43008
    ds_read_b64_tr_b16 v[106:107], v12 offset:24832
    buffer_load_dwordx4 a[136:139], v4, s[20:23], s50 offen offset:3072
    v_mfma_f32_32x32x16_bf16 v[208:223], v[152:155], v[96:99], v[208:223]
    ds_read_b128 v[148:151], v9 offset:35840
    s_add_u32 m0, s100, 66560
    s_add_u32 s18, s99, 94208
    buffer_load_dwordx4 v4, s[20:23], s18 offen lds
    v_mfma_f32_16x16x32_bf16 a[244:247], a[240:243], v[96:99], a[244:247]
    s_waitcnt lgkmcnt(6)
    v_mfma_f32_32x32x16_bf16 v[176:191], v[156:159], v[100:103], v[176:191]
    ds_read_b128 v[152:155], v9 offset:39936
    s_waitcnt vmcnt(10)
    ds_read_b64_tr_b16 v[108:109], v12 offset:28672
    v_dot2c_f32_bf16 v18, v100, v100
    v_dot2c_f32_bf16 v14, v101, v101
    v_dot2c_f32_bf16 v18, v102, v102
    v_dot2c_f32_bf16 v14, v103, v103
    v_mfma_f32_32x32x16_bf16 v[192:207], v[160:163], v[100:103], v[192:207]
    ds_read_b128 v[156:159], v9 offset:44032
    ds_read_b64_tr_b16 v[110:111], v12 offset:28928
    buffer_load_dwordx4 a[140:143], v4, s[20:23], s54 offen offset:3072
    v_mfma_f32_32x32x16_bf16 v[208:223], v[164:167], v[100:103], v[208:223]
    ds_read_b128 v[160:163], v9 offset:45056
    s_add_u32 m0, s100, 70656
    s_add_u32 s18, s99, 98304
    buffer_load_dwordx4 v4, s[20:23], s18 offen lds
    v_mfma_f32_16x16x32_bf16 a[244:247], a[240:243], v[100:103], a[244:247]
    s_waitcnt lgkmcnt(6)
PAD_B_11:
    s_cbranch_execz PAD_B_12
    v_mfma_f32_32x32x16_bf16 v[176:191], v[168:171], v[104:107], v[176:191]
    ds_read_b128 v[164:167], v9 offset:49152
    s_waitcnt vmcnt(11)
    ds_read_b64_tr_b16 v[112:113], v12 offset:32768
    v_dot2c_f32_bf16 v18, v104, v104
    v_dot2c_f32_bf16 v14, v105, v105
    v_dot2c_f32_bf16 v18, v106, v106
    v_dot2c_f32_bf16 v14, v107, v107
    v_mfma_f32_32x32x16_bf16 v[192:207], v[172:175], v[104:107], v[192:207]
    ds_read_b128 v[168:171], v9 offset:53248
    ds_read_b64_tr_b16 v[114:115], v12 offset:33024
    buffer_load_dwordx4 a[192:195], v4, s[20:23], s51 offen offset:3072
    v_mfma_f32_32x32x16_bf16 v[208:223], v[144:147], v[104:107], v[208:223]
    ds_read_b128 v[172:175], v9 offset:46080
    s_add_u32 m0, s100, 74752
    s_add_u32 s18, s99, 102400
    buffer_load_dwordx4 v4, s[20:23], s18 offen lds
    v_mfma_f32_16x16x32_bf16 a[244:247], a[240:243], v[104:107], a[244:247]
    s_waitcnt lgkmcnt(6)
    v_mfma_f32_32x32x16_bf16 v[176:191], v[148:151], v[108:111], v[176:191]
    ds_read_b128 v[144:147], v9 offset:50176
    s_waitcnt vmcnt(12)
    ds_read_b64_tr_b16 v[116:117], v12 offset:36864
    v_dot2c_f32_bf16 v18, v108, v108
    v_dot2c_f32_bf16 v14, v109, v109
    v_dot2c_f32_bf16 v18, v110, v110
    v_dot2c_f32_bf16 v14, v111, v111
    v_mfma_f32_32x32x16_bf16 v[192:207], v[152:155], v[108:111], v[192:207]
    ds_read_b128 v[148:151], v9 offset:54272
    ds_read_b64_tr_b16 v[118:119], v12 offset:37120
    buffer_load_dwordx4 a[196:199], v4, s[20:23], s55 offen offset:3072
    v_mfma_f32_32x32x16_bf16 v[208:223], v[156:159], v[108:111], v[208:223]
    ds_read_b128 v[152:155], v9 offset:47104
    s_add_u32 m0, s100, 78848
    s_add_u32 s18, s99, 106496
    buffer_load_dwordx4 v4, s[20:23], s18 offen lds
    v_mfma_f32_16x16x32_bf16 a[244:247], a[240:243], v[108:111], a[244:247]
    s_waitcnt lgkmcnt(6)
PAD_B_12:
    s_cbranch_execz PRET_B
    v_mfma_f32_32x32x16_bf16 v[176:191], v[160:163], v[112:115], v[176:191]
    ds_read_b128 v[156:159], v9 offset:51200
    s_waitcnt vmcnt(13)
    ds_read_b64_tr_b16 v[120:121], v12 offset:40960
    v_dot2c_f32_bf16 v18, v112, v112
    v_dot2c_f32_bf16 v14, v113, v113
    v_dot2c_f32_bf16 v18, v114, v114
    v_dot2c_f32_bf16 v14, v115, v115
    v_mfma_f32_32x32x16_bf16 v[192:207], v[164:167], v[112:115], v[192:207]
    ds_read_b128 v[160:163], v9 offset:55296
    ds_read_b64_tr_b16 v[122:123], v12 offset:41216
    buffer_load_dwordx4 a[32:35], v246, s[20:23], s48 offen
    v_mfma_f32_32x32x16_bf16 v[208:223], v[168:171], v[112:115], v[208:223]
    ds_read_b128 v[164:167], v9 offset:48128
    s_add_u32 m0, s100, 82944
    s_add_u32 s18, s99, 110592
    buffer_load_dwordx4 v4, s[20:23], s18 offen lds
    v_mfma_f32_16x16x32_bf16 a[244:247], a[240:243], v[112:115], a[244:247]
    s_waitcnt lgkmcnt(6)
    v_mfma_f32_32x32x16_bf16 v[176:191], v[172:175], v[116:119], v[176:191]
    ds_read_b128 v[168:171], v9 offset:52224
    s_waitcnt vmcnt(14)
    ds_read_b64_tr_b16 v[124:125], v12 offset:45056
    v_dot2c_f32_bf16 v18, v116, v116
    v_dot2c_f32_bf16 v14, v117, v117
    v_dot2c_f32_bf16 v18, v118, v118
    v_dot2c_f32_bf16 v14, v119, v119
    v_mfma_f32_32x32x16_bf16 v[192:207], v[144:147], v[116:119], v[192:207]
    ds_read_b128 v[172:175], v9 offset:56320
    ds_read_b64_tr_b16 v[126:127], v12 offset:45312
    buffer_load_dwordx4 a[36:39], v246, s[20:23], s52 offen
    v_mfma_f32_32x32x16_bf16 v[208:223], v[148:151], v[116:119], v[208:223]
    ds_read_b128 v[144:147], v9 offset:57344
    s_add_u32 m0, s100, 87040
    s_add_u32 s18, s99, 114688
    buffer_load_dwordx4 v4, s[20:23], s18 offen lds
    v_mfma_f32_16x16x32_bf16 a[244:247], a[240:243], v[116:119], a[244:247]
    s_waitcnt lgkmcnt(6)
PAD_B_13:
    s_cbranch_execz PRET_B
    v_mfma_f32_32x32x16_bf16 v[176:191], v[152:155], v[120:123], v[176:191]
    ds_read_b128 v[148:151], v9 offset:61440
    s_waitcnt vmcnt(15)
    ds_read_b64_tr_b16 v[128:129], v12 offset:0
    v_dot2c_f32_bf16 v18, v120, v120
    v_dot2c_f32_bf16 v14, v121, v121
    v_dot2c_f32_bf16 v18, v122, v122
    v_dot2c_f32_bf16 v14, v123, v123
    v_mfma_f32_32x32x16_bf16 v[192:207], v[156:159], v[120:123], v[192:207]
    ds_read_b128 v[152:155], v10 offset:0
    ds_read_b64_tr_b16 v[130:131], v12 offset:256
    buffer_load_dwordx4 a[88:91], v246, s[20:23], s49 offen
    v_mfma_f32_32x32x16_bf16 v[208:223], v[160:163], v[120:123], v[208:223]
    ds_read_b128 v[156:159], v9 offset:58368
    s_add_u32 m0, s100, 91136
    s_add_u32 s18, s99, 118784
    buffer_load_dwordx4 v4, s[20:23], s18 offen lds
    v_mfma_f32_16x16x32_bf16 a[244:247], a[240:243], v[120:123], a[244:247]
    s_waitcnt lgkmcnt(6)
    v_mfma_f32_32x32x16_bf16 v[176:191], v[164:167], v[124:127], v[176:191]
    ds_read_b128 v[160:163], v9 offset:62464
    s_waitcnt vmcnt(16)
    ds_read_b64_tr_b16 v[132:133], v12 offset:4096
    v_dot2c_f32_bf16 v18, v124, v124
    v_dot2c_f32_bf16 v14, v125, v125
    v_dot2c_f32_bf16 v18, v126, v126
    v_dot2c_f32_bf16 v14, v127, v127
    v_mfma_f32_32x32x16_bf16 v[192:207], v[168:171], v[124:127], v[192:207]
    ds_read_b128 v[164:167], v10 offset:1024
    ds_read_b64_tr_b16 v[134:135], v12 offset:4352
    buffer_load_dwordx4 a[92:95], v246, s[20:23], s53 offen
    v_mfma_f32_32x32x16_bf16 v[208:223], v[172:175], v[124:127], v[208:223]
    ds_read_b128 v[168:171], v9 offset:59392
    s_add_u32 m0, s100, 95232
    s_add_u32 s18, s99, 122880
    buffer_load_dwordx4 v4, s[20:23], s18 offen lds
    v_mfma_f32_16x16x32_bf16 a[244:247], a[240:243], v[124:127], a[244:247]
    s_waitcnt lgkmcnt(6)
PAD_B_14:
    s_cbranch_execz PAD_B_15
    v_mfma_f32_32x32x16_bf16 v[176:191], v[144:147], v[128:131], v[176:191]
    ds_read_b128 v[172:175], v9 offset:63488
    s_waitcnt vmcnt(17)
    ds_read_b64_tr_b16 v[136:137], v12 offset:8192
    v_dot2c_f32_bf16 v18, v128, v128
    v_dot2c_f32_bf16 v14, v129, v129
    v_dot2c_f32_bf16 v18, v130, v130
    v_dot2c_f32_bf16 v14, v131, v131
    v_mfma_f32_32x32x16_bf16 v[192:207], v[148:151], v[128:131], v[192:207]
    ds_read_b128 v[144:147], v10 offset:2048
    ds_read_b64_tr_b16 v[138:139], v12 offset:8448
    buffer_load_dwordx4 a[144:147], v246, s[20:23], s50 offen
    v_mfma_f32_32x32x16_bf16 v[208:223], v[152:155], v[128:131], v[208:223]
    ds_read_b128 v[148:151], v9 offset:60416
    s_add_u32 m0, s100, 99328
    s_add_u32 s18, s99, 126976
    buffer_load_dwordx4 v4, s[20:23], s18 offen lds
    v_mfma_f32_16x16x32_bf16 a[244:247], a[240:243], v[128:131], a[244:247]
    s_waitcnt lgkmcnt(6)
    v_mfma_f32_32x32x16_bf16 v[176:191], v[156:159], v[132:135], v[176:191]
    ds_read_b128 v[152:155], v9 offset:64512
    s_waitcnt vmcnt(18)
    ds_read_b64_tr_b16 v[140:141], v12 offset:12288
    v_dot2c_f32_bf16 v18, v132, v132
    v_dot2c_f32_bf16 v14, v133, v133
    v_dot2c_f32_bf16 v18, v134, v134
    v_dot2c_f32_bf16 v14, v135, v135
    v_mfma_f32_32x32x16_bf16 v[192:207], v[160:163], v[132:135], v[192:207]
    ds_read_b128 v[156:159], v10 offset:3072
    ds_read_b64_tr_b16 v[142:143], v12 offset:12544
    buffer_load_dwordx4 a[148:151], v246, s[20:23], s54 offen
    v_mfma_f32_32x32x16_bf16 v[208:223], v[164:167], v[132:135], v[208:223]
    ds_read_b128 v[160:163], v10 offset:4096
    s_add_u32 m0, s100, 103424
    s_add_u32 s18, s99, 131072
    buffer_load_dwordx4 v4, s[20:23], s18 offen lds
    v_mfma_f32_16x16x32_bf16 a[244:247], a[240:243], v[132:135], a[244:247]
    s_waitcnt lgkmcnt(6)
PAD_B_15:
    s_cbranch_execz PRET_B
    v_mfma_f32_32x32x16_bf16 v[176:191], v[168:171], v[136:139], v[176:191]
    ds_read_b128 v[164:167], v10 offset:5120
    v_dot2c_f32_bf16 v18, v136, v136
    v_dot2c_f32_bf16 v14, v137, v137
    v_dot2c_f32_bf16 v18, v138, v138
    v_dot2c_f32_bf16 v14, v139, v139
    v_mfma_f32_32x32x16_bf16 v[192:207], v[172:175], v[136:139], v[192:207]
    ds_read_b128 v[168:171], v10 offset:6144
    buffer_load_dwordx4 a[200:203], v246, s[20:23], s51 offen
    v_mfma_f32_32x32x16_bf16 v[208:223], v[144:147], v[136:139], v[208:223]
    ds_read_b128 v[172:175], v10 offset:7168
    s_add_u32 m0, s100, 107520
    s_add_u32 s18, s99, 135168
    buffer_load_dwordx4 v4, s[20:23], s18 offen lds
    v_mfma_f32_16x16x32_bf16 a[244:247], a[240:243], v[136:139], a[244:247]
    s_waitcnt lgkmcnt(4)
    v_mfma_f32_32x32x16_bf16 v[176:191], v[148:151], v[140:143], v[176:191]
    ds_read_b128 v[144:147], v10 offset:8192
    v_dot2c_f32_bf16 v18, v140, v140
    v_dot2c_f32_bf16 v14, v141, v141
    v_dot2c_f32_bf16 v18, v142, v142
    v_dot2c_f32_bf16 v14, v143, v143
    v_mfma_f32_32x32x16_bf16 v[192:207], v[152:155], v[140:143], v[192:207]
    ds_read_b128 v[148:151], v10 offset:9216
    buffer_load_dwordx4 a[204:207], v246, s[20:23], s55 offen
    v_mfma_f32_32x32x16_bf16 v[208:223], v[156:159], v[140:143], v[208:223]
    ds_read_b128 v[152:155], v10 offset:10240
    s_add_u32 m0, s100, 111616
    s_add_u32 s18, s99, 139264
    buffer_load_dwordx4 v4, s[20:23], s18 offen lds
    v_mfma_f32_16x16x32_bf16 a[244:247], a[240:243], v[140:143], a[244:247]
    s_waitcnt vmcnt(12)
    s_barrier
    s_waitcnt lgkmcnt(3)
PAD_B_16:
    s_cbranch_execz PAD_B_17
    v_mfma_f32_32x32x16_bf16 v[224:239], v[160:163], v[32:35], 0
    ds_read_b128 v[156:159], v10 offset:11264
    s_nop 2
    v_accvgpr_read_b32 v17, a244
    v_add_f32 v18, v18, v14
    v_mov_b32 v13, v18
    s_nop 1
    v_permlane32_swap_b32 v18, v13
    v_add_f32 v18, v18, v13
    v_mfma_f32_32x32x16_bf16 v[224:239], v[164:167], v[36:39], v[224:239]
    ds_read_b128 v[160:163], v8 offset:49152
    s_add_u32 m0, s100, 17408
    s_add_u32 s18, s99, 143360
    buffer_load_dwordx4 v4, s[20:23], s18 offen lds
    v_mul_f32 v17, 0x3b124925, v17
    v_mul_f32 v18, 0x3b124925, v18
    v_fma_f32 v18, -v17, v17, v18
    v_max_f32 v18, 0, v18
    v_cvt_pk_bf16_f32 v19, v18, v18
    v_lshlrev_b32 v18, 16, v19
    v_mfma_f32_32x32x16_bf16 v[224:239], v[168:171], v[40:43], v[224:239]
    ds_read_b128 v[164:167], v8 offset:50176
    v_add_f32 v18, 0x3727c5ac, v18
    v_cvt_pk_bf16_f32 v19, v18, v18
    v_lshlrev_b32 v18, 16, v19
    v_sqrt_f32 v18, v18
    s_nop 0
    v_cvt_pk_bf16_f32 v19, v18, v18
    v_lshlrev_b32 v21, 16, v19
    v_rcp_f32 v20, v21
    s_nop 0
    v_mul_f32 v20, 0xbfb8aa3b, v20
    v_mul_f32 v176, v176, v20
    v_mfma_f32_32x32x16_bf16 v[224:239], v[172:175], v[44:47], v[224:239]
    ds_read_b128 v[168:171], v8 offset:51200
    v_mul_f32 v177, v177, v20
    v_mul_f32 v178, v178, v20
    v_mul_f32 v179, v179, v20
    v_mul_f32 v180, v180, v20
    v_mul_f32 v181, v181, v20
    v_mul_f32 v182, v182, v20
    v_mul_f32 v183, v183, v20
    v_exp_f32 v176, v176
    v_exp_f32 v177, v177
    s_waitcnt lgkmcnt(3)
    v_mfma_f32_32x32x16_bf16 v[224:239], v[144:147], v[48:51], v[224:239]
    ds_read_b128 v[172:175], v8 offset:52224
    s_add_u32 m0, s100, 21504
    s_add_u32 s18, s99, 147456
    buffer_load_dwordx4 v4, s[20:23], s18 offen lds
    v_mfma_f32_32x32x16_bf16 v[224:239], v[148:151], v[52:55], v[224:239]
    ds_read_b128 v[144:147], v8 offset:53248
    v_exp_f32 v178, v178
PAD_B_17:
    s_cbranch_execz PRET_B
    v_exp_f32 v179, v179
    v_mfma_f32_32x32x16_bf16 v[224:239], v[152:155], v[56:59], v[224:239]
    ds_read_b128 v[148:151], v8 offset:54272
    v_exp_f32 v180, v180
    v_exp_f32 v181, v181
    v_mfma_f32_32x32x16_bf16 v[224:239], v[156:159], v[60:63], v[224:239]
    ds_read_b128 v[152:155], v8 offset:55296
    s_add_u32 m0, s100, 25600
    s_add_u32 s18, s99, 151552
    buffer_load_dwordx4 v4, s[20:23], s18 offen lds
    s_waitcnt lgkmcnt(3)
    v_mfma_f32_32x32x16_bf16 v[224:239], v[160:163], v[64:67], v[224:239]
    ds_read_b128 v[156:159], v8 offset:56320
    v_exp_f32 v182, v182
    v_exp_f32 v183, v183
    v_mfma_f32_32x32x16_bf16 v[224:239], v[164:167], v[68:71], v[224:239]
    ds_read_b128 v[160:163], v8 offset:57344
    v_fma_f32 v176, v176, v21, v21
    v_fma_f32 v177, v177, v21, v21
    v_fma_f32 v178, v178, v21, v21
    v_fma_f32 v179, v179, v21, v21
    v_fma_f32 v180, v180, v21, v21
    v_mfma_f32_32x32x16_bf16 v[224:239], v[168:171], v[72:75], v[224:239]
    ds_read_b128 v[164:167], v8 offset:58368
    s_add_u32 m0, s100, 29696
    s_add_u32 s18, s99, 155648
    buffer_load_dwordx4 v4, s[20:23], s18 offen lds
    v_mfma_f32_32x32x16_bf16 v[224:239], v[172:175], v[76:79], v[224:239]
    ds_read_b128 v[168:171], v8 offset:59392
    v_fma_f32 v181, v181, v21, v21
    v_fma_f32 v182, v182, v21, v21
    v_fma_f32 v183, v183, v21, v21
    v_rcp_f32 v176, v176
    s_waitcnt lgkmcnt(3)
    v_mfma_f32_32x32x16_bf16 v[224:239], v[144:147], v[80:83], v[224:239]
    ds_read_b128 v[172:175], v8 offset:60416
    v_rcp_f32 v177, v177
    v_rcp_f32 v178, v178
    v_mfma_f32_32x32x16_bf16 v[224:239], v[148:151], v[84:87], v[224:239]
    ds_read_b128 v[144:147], v8 offset:61440
    s_add_u32 m0, s100, 33792
    s_add_u32 s18, s99, 159744
    buffer_load_dwordx4 v4, s[20:23], s18 offen lds
    v_mfma_f32_32x32x16_bf16 v[224:239], v[152:155], v[88:91], v[224:239]
    ds_read_b128 v[148:151], v8 offset:62464
PAD_B_18:
    s_cbranch_execz PAD_B_19
    v_rcp_f32 v179, v179
    v_rcp_f32 v180, v180
    v_mfma_f32_32x32x16_bf16 v[224:239], v[156:159], v[92:95], v[224:239]
    ds_read_b128 v[152:155], v8 offset:63488
    v_rcp_f32 v181, v181
    v_rcp_f32 v182, v182
    s_waitcnt lgkmcnt(3)
    v_mfma_f32_32x32x16_bf16 v[224:239], v[160:163], v[96:99], v[224:239]
    ds_read_b128 v[156:159], v8 offset:64512
    s_add_u32 m0, s100, 37888
    s_add_u32 s18, s99, 163840
    buffer_load_dwordx4 v4, s[20:23], s18 offen lds
    v_mfma_f32_32x32x16_bf16 v[224:239], v[164:167], v[100:103], v[224:239]
    ds_read_b128 v[160:163], v9 offset:0
    v_rcp_f32 v183, v183
    v_mul_f32 v184, v184, v176
    v_mul_f32 v185, v185, v177
    v_mul_f32 v186, v186, v178
    v_mfma_f32_32x32x16_bf16 v[224:239], v[168:171], v[104:107], v[224:239]
    ds_read_b128 v[164:167], v9 offset:1024
    v_mul_f32 v187, v187, v179
    v_mul_f32 v188, v188, v180
    v_mul_f32 v189, v189, v181
    v_mul_f32 v190, v190, v182
    v_mul_f32 v191, v191, v183
    v_mfma_f32_32x32x16_bf16 v[224:239], v[172:175], v[108:111], v[224:239]
    ds_read_b128 v[168:171], v9 offset:2048
    s_add_u32 m0, s100, 41984
    s_add_u32 s18, s99, 167936
    buffer_load_dwordx4 v4, s[20:23], s18 offen lds
    s_waitcnt lgkmcnt(3)
    v_mfma_f32_32x32x16_bf16 v[224:239], v[144:147], v[112:115], v[224:239]
    ds_read_b128 v[172:175], v9 offset:3072
    v_cvt_pk_bf16_f32 v24, v184, v185
    v_cvt_pk_bf16_f32 v25, v186, v187
    v_cvt_pk_bf16_f32 v26, v188, v189
    v_cvt_pk_bf16_f32 v27, v190, v191
    v_mfma_f32_32x32x16_bf16 v[224:239], v[148:151], v[116:119], v[224:239]
    ds_read_b128 v[144:147], v9 offset:4096
    buffer_store_dwordx4 v[24:27], v4, s[20:23], s19 offen sc1
    v_mul_f32 v192, v192, v20
    v_mul_f32 v193, v193, v20
    v_mul_f32 v194, v194, v20
    v_mfma_f32_32x32x16_bf16 v[224:239], v[152:155], v[120:123], v[224:239]
    ds_read_b128 v[148:151], v9 offset:5120
    s_add_u32 m0, s100, 46080
    s_add_u32 s18, s99, 172032
    buffer_load_dwordx4 v4, s[20:23], s18 offen lds
    v_mfma_f32_32x32x16_bf16 v[224:239], v[156:159], v[124:127], v[224:239]
PAD_B_19:
    s_cbranch_execz PRET_B
    ds_read_b128 v[152:155], v9 offset:6144
    v_mul_f32 v195, v195, v20
    v_mul_f32 v196, v196, v20
    v_mul_f32 v197, v197, v20
    v_mul_f32 v198, v198, v20
    v_mul_f32 v199, v199, v20
    s_waitcnt lgkmcnt(3)
    v_mfma_f32_32x32x16_bf16 v[224:239], v[160:163], v[128:131], v[224:239]
    ds_read_b128 v[156:159], v9 offset:7168
    v_exp_f32 v192, v192
    v_exp_f32 v193, v193
    v_mfma_f32_32x32x16_bf16 v[224:239], v[164:167], v[132:135], v[224:239]
    s_waitcnt vmcnt(6)
    s_barrier
    ds_read_b128 v[160:163], v9 offset:8192
    s_add_u32 m0, s100, 50176
    s_add_u32 s18, s99, 176128
    buffer_load_dwordx4 v4, s[20:23], s18 offen lds
    v_mfma_f32_32x32x16_bf16 v[224:239], v[168:171], v[136:139], v[224:239]
    ds_read_b128 v[164:167], v9 offset:9216
    v_exp_f32 v194, v194
    v_exp_f32 v195, v195
    v_mfma_f32_32x32x16_bf16 v[224:239], v[172:175], v[140:143], v[224:239]
    ds_read_b128 v[168:171], v9 offset:10240
    v_exp_f32 v196, v196
    v_exp_f32 v197, v197
    v_exp_f32 v198, v198
    v_exp_f32 v199, v199
    v_fma_f32 v192, v192, v21, v21
    v_fma_f32 v193, v193, v21, v21
    s_waitcnt lgkmcnt(3)
    v_mfma_f32_32x32x16_bf16 v[176:191], v[144:147], v[32:35], 0
    ds_read_b128 v[172:175], v9 offset:11264
    s_add_u32 m0, s100, 54272
    s_add_u32 s18, s99, 180224
    buffer_load_dwordx4 v4, s[20:23], s18 offen lds
    v_mfma_f32_32x32x16_bf16 v[176:191], v[148:151], v[36:39], v[176:191]
    ds_read_b128 v[144:147], v9 offset:12288
    v_fma_f32 v194, v194, v21, v21
    v_fma_f32 v195, v195, v21, v21
    v_fma_f32 v196, v196, v21, v21
    v_fma_f32 v197, v197, v21, v21
    v_fma_f32 v198, v198, v21, v21
    v_mfma_f32_32x32x16_bf16 v[176:191], v[152:155], v[40:43], v[176:191]
    ds_read_b128 v[148:151], v9 offset:13312
    v_fma_f32 v199, v199, v21, v21
    v_rcp_f32 v192, v192
    v_rcp_f32 v193, v193
PAD_B_20:
    s_cbranch_execz PAD_B_21
    v_mfma_f32_32x32x16_bf16 v[176:191], v[156:159], v[44:47], v[176:191]
    ds_read_b128 v[152:155], v9 offset:14336
    s_add_u32 m0, s100, 58368
    s_add_u32 s18, s99, 184320
    buffer_load_dwordx4 v4, s[20:23], s18 offen lds
    s_waitcnt lgkmcnt(3)
    v_mfma_f32_32x32x16_bf16 v[176:191], v[160:163], v[48:51], v[176:191]
    ds_read_b128 v[156:159], v9 offset:15360
    v_rcp_f32 v194, v194
    v_rcp_f32 v195, v195
    v_mfma_f32_32x32x16_bf16 v[176:191], v[164:167], v[52:55], v[176:191]
    ds_read_b128 v[160:163], v9 offset:16384
    v_rcp_f32 v196, v196
    v_rcp_f32 v197, v197
    v_mfma_f32_32x32x16_bf16 v[176:191], v[168:171], v[56:59], v[176:191]
    ds_read_b128 v[164:167], v9 offset:17408
    s_add_u32 m0, s100, 62464
    s_add_u32 s18, s99, 188416
    buffer_load_dwordx4 v4, s[20:23], s18 offen lds
    v_mfma_f32_32x32x16_bf16 v[176:191], v[172:175], v[60:63], v[176:191]
    ds_read_b128 v[168:171], v9 offset:18432
    v_rcp_f32 v198, v198
    v_rcp_f32 v199, v199
    v_mul_f32 v200, v200, v192
    s_waitcnt lgkmcnt(3)
    v_mfma_f32_32x32x16_bf16 v[176:191], v[144:147], v[64:67], v[176:191]
    ds_read_b128 v[172:175], v9 offset:19456
    v_mul_f32 v201, v201, v193
    v_mul_f32 v202, v202, v194
    v_mul_f32 v203, v203, v195
    v_mul_f32 v204, v204, v196
    v_mfma_f32_32x32x16_bf16 v[176:191], v[148:151], v[68:71], v[176:191]
    ds_read_b128 v[144:147], v9 offset:20480
    s_add_u32 m0, s100, 115712
    s_add_u32 s18, s99, 192512
    buffer_load_dwordx4 v4, s[20:23], s18 offen lds
    v_mfma_f32_32x32x16_bf16 v[176:191], v[152:155], v[72:75], v[176:191]
    ds_read_b128 v[148:151], v9 offset:21504
    v_mul_f32 v205, v205, v197
    v_mul_f32 v206, v206, v198
    v_mul_f32 v207, v207, v199
    v_cvt_pk_bf16_f32 v28, v200, v201
    v_cvt_pk_bf16_f32 v29, v202, v203
PAD_B_21:
    s_cbranch_execz PRET_B
    v_mfma_f32_32x32x16_bf16 v[176:191], v[156:159], v[76:79], v[176:191]
    ds_read_b128 v[152:155], v9 offset:22528
    v_cvt_pk_bf16_f32 v30, v204, v205
    v_cvt_pk_bf16_f32 v31, v206, v207
    buffer_store_dwordx4 v[28:31], v4, s[20:23], s19 offen offset:1024 sc1
    v_mul_f32 v208, v208, v20
    s_waitcnt lgkmcnt(3)
    v_mfma_f32_32x32x16_bf16 v[176:191], v[160:163], v[80:83], v[176:191]
    ds_read_b128 v[156:159], v9 offset:23552
    s_add_u32 m0, s100, 119808
    s_add_u32 s18, s99, 196608
    buffer_load_dwordx4 v4, s[20:23], s18 offen lds
    v_mfma_f32_32x32x16_bf16 v[176:191], v[164:167], v[84:87], v[176:191]
    ds_read_b128 v[160:163], v9 offset:24576
    v_mul_f32 v209, v209, v20
    v_mul_f32 v210, v210, v20
    v_mul_f32 v211, v211, v20
    v_mul_f32 v212, v212, v20
    v_mul_f32 v213, v213, v20
    v_mfma_f32_32x32x16_bf16 v[176:191], v[168:171], v[88:91], v[176:191]
    ds_read_b128 v[164:167], v9 offset:25600
    buffer_load_dwordx4 a[40:43], v246, s[20:23], s48 offen offset:1024
    v_mul_f32 v214, v214, v20
    v_mul_f32 v215, v215, v20
    v_mfma_f32_32x32x16_bf16 v[176:191], v[172:175], v[92:95], v[176:191]
    ds_read_b128 v[168:171], v9 offset:26624
    v_exp_f32 v208, v208
    v_exp_f32 v209, v209
    s_waitcnt lgkmcnt(3)
    v_mfma_f32_32x32x16_bf16 v[176:191], v[144:147], v[96:99], v[176:191]
    ds_read_b128 v[172:175], v9 offset:27648
    buffer_load_dwordx4 a[44:47], v246, s[20:23], s52 offen offset:1024
    v_exp_f32 v210, v210
    v_mfma_f32_32x32x16_bf16 v[176:191], v[148:151], v[100:103], v[176:191]
    ds_read_b128 v[144:147], v9 offset:28672
    v_exp_f32 v211, v211
    v_exp_f32 v212, v212
    v_mfma_f32_32x32x16_bf16 v[176:191], v[152:155], v[104:107], v[176:191]
    ds_read_b128 v[148:151], v9 offset:29696
    buffer_load_dwordx4 a[96:99], v246, s[20:23], s49 offen offset:1024
    v_exp_f32 v213, v213
    v_mfma_f32_32x32x16_bf16 v[176:191], v[156:159], v[108:111], v[176:191]
    ds_read_b128 v[152:155], v9 offset:30720
    v_exp_f32 v214, v214
    v_exp_f32 v215, v215
    v_fma_f32 v208, v208, v21, v21
    s_waitcnt lgkmcnt(3)
PAD_B_22:
    s_cbranch_execz PRET_B
    v_mfma_f32_32x32x16_bf16 v[176:191], v[160:163], v[112:115], v[176:191]
    ds_read_b128 v[156:159], v9 offset:31744
    buffer_load_dwordx4 a[100:103], v246, s[20:23], s53 offen offset:1024
    v_fma_f32 v209, v209, v21, v21
    v_fma_f32 v210, v210, v21, v21
    v_mfma_f32_32x32x16_bf16 v[176:191], v[164:167], v[116:119], v[176:191]
    ds_read_b128 v[160:163], v8 offset:0
    v_fma_f32 v211, v211, v21, v21
    v_fma_f32 v212, v212, v21, v21
    v_fma_f32 v213, v213, v21, v21
    v_fma_f32 v214, v214, v21, v21
    v_fma_f32 v215, v215, v21, v21
    v_mfma_f32_32x32x16_bf16 v[176:191], v[168:171], v[120:123], v[176:191]
    ds_read_b128 v[164:167], v8 offset:1024
    buffer_load_dwordx4 a[152:155], v246, s[20:23], s50 offen offset:1024
    v_rcp_f32 v208, v208
    v_mfma_f32_32x32x16_bf16 v[176:191], v[172:175], v[124:127], v[176:191]
    ds_read_b128 v[168:171], v8 offset:2048
    v_rcp_f32 v209, v209
    v_rcp_f32 v210, v210
    s_waitcnt lgkmcnt(3)
    v_mfma_f32_32x32x16_bf16 v[176:191], v[144:147], v[128:131], v[176:191]
    ds_read_b128 v[172:175], v8 offset:3072
    buffer_load_dwordx4 a[156:159], v246, s[20:23], s54 offen offset:1024
    v_rcp_f32 v211, v211
    v_mfma_f32_32x32x16_bf16 v[176:191], v[148:151], v[132:135], v[176:191]
    ds_read_b128 v[144:147], v8 offset:4096
    v_rcp_f32 v212, v212
    v_rcp_f32 v213, v213
PAD_B_23:
    s_cbranch_execz PAD_B_24
    v_mfma_f32_32x32x16_bf16 v[176:191], v[152:155], v[136:139], v[176:191]
    ds_read_b128 v[148:151], v8 offset:5120
    buffer_load_dwordx4 a[208:211], v246, s[20:23], s51 offen offset:1024
    v_rcp_f32 v214, v214
    v_mfma_f32_32x32x16_bf16 v[176:191], v[156:159], v[140:143], v[176:191]
    ds_read_b128 v[152:155], v8 offset:6144
    v_rcp_f32 v215, v215
    v_mul_f32 v216, v216, v208
    v_mul_f32 v217, v217, v209
    v_mul_f32 v218, v218, v210
    v_mul_f32 v219, v219, v211
    v_mul_f32 v220, v220, v212
    v_mul_f32 v221, v221, v213
    v_mul_f32 v222, v222, v214
    v_mul_f32 v223, v223, v215
    v_cvt_pk_bf16_f32 v24, v216, v217
    s_waitcnt lgkmcnt(3)
    v_mfma_f32_32x32x16_bf16 v[192:207], v[160:163], v[32:35], 0
    ds_read_b128 v[156:159], v8 offset:7168
    buffer_load_dwordx4 a[212:215], v246, s[20:23], s55 offen offset:1024
    v_cvt_pk_bf16_f32 v25, v218, v219
    v_cvt_pk_bf16_f32 v26, v220, v221
    v_mfma_f32_32x32x16_bf16 v[192:207], v[164:167], v[36:39], v[192:207]
    ds_read_b128 v[160:163], v8 offset:8192
    v_cvt_pk_bf16_f32 v27, v222, v223
    buffer_store_dwordx4 v[24:27], v4, s[20:23], s19 offen offset:2048 sc1
    v_mul_f32 v224, v224, v20
    v_mul_f32 v225, v225, v20
    v_mfma_f32_32x32x16_bf16 v[192:207], v[168:171], v[40:43], v[192:207]
    ds_read_b128 v[164:167], v8 offset:9216
    buffer_load_dwordx4 a[48:51], v246, s[20:23], s48 offen offset:2048
    v_mul_f32 v226, v226, v20
    v_mul_f32 v227, v227, v20
    v_mul_f32 v228, v228, v20
    v_mfma_f32_32x32x16_bf16 v[192:207], v[172:175], v[44:47], v[192:207]
    ds_read_b128 v[168:171], v8 offset:10240
    v_mul_f32 v229, v229, v20
    v_mul_f32 v230, v230, v20
    v_mul_f32 v231, v231, v20
    v_exp_f32 v224, v224
    s_waitcnt lgkmcnt(3)
    v_mfma_f32_32x32x16_bf16 v[192:207], v[144:147], v[48:51], v[192:207]
    ds_read_b128 v[172:175], v8 offset:11264
    buffer_load_dwordx4 a[52:55], v246, s[20:23], s52 offen offset:2048
    v_exp_f32 v225, v225
    v_mfma_f32_32x32x16_bf16 v[192:207], v[148:151], v[52:55], v[192:207]
    s_waitcnt vmcnt(11)
    s_barrier
    ds_read_b128 v[144:147], v8 offset:12288
    v_exp_f32 v226, v226
PAD_B_24:
    s_cbranch_execz PRET_B
    v_mfma_f32_32x32x16_bf16 v[192:207], v[152:155], v[56:59], v[192:207]
    ds_read_b128 v[148:151], v8 offset:13312
    buffer_load_dwordx4 a[104:107], v246, s[20:23], s49 offen offset:2048
    v_exp_f32 v227, v227
    v_mfma_f32_32x32x16_bf16 v[192:207], v[156:159], v[60:63], v[192:207]
    ds_read_b128 v[152:155], v8 offset:14336
    v_exp_f32 v228, v228
    v_exp_f32 v229, v229
    s_waitcnt lgkmcnt(3)
    v_mfma_f32_32x32x16_bf16 v[192:207], v[160:163], v[64:67], v[192:207]
    ds_read_b128 v[156:159], v8 offset:15360
    buffer_load_dwordx4 a[108:111], v246, s[20:23], s53 offen offset:2048
    v_exp_f32 v230, v230
    v_mfma_f32_32x32x16_bf16 v[192:207], v[164:167], v[68:71], v[192:207]
    ds_read_b128 v[160:163], v8 offset:16384
    v_exp_f32 v231, v231
    v_fma_f32 v224, v224, v21, v21
    v_fma_f32 v225, v225, v21, v21
    v_fma_f32 v226, v226, v21, v21
    v_mfma_f32_32x32x16_bf16 v[192:207], v[168:171], v[72:75], v[192:207]
    ds_read_b128 v[164:167], v8 offset:17408
    buffer_load_dwordx4 a[160:163], v246, s[20:23], s50 offen offset:2048
    v_fma_f32 v227, v227, v21, v21
    v_fma_f32 v228, v228, v21, v21
    v_fma_f32 v229, v229, v21, v21
    v_mfma_f32_32x32x16_bf16 v[192:207], v[172:175], v[76:79], v[192:207]
    ds_read_b128 v[168:171], v8 offset:18432
    v_fma_f32 v230, v230, v21, v21
    v_fma_f32 v231, v231, v21, v21
    v_rcp_f32 v224, v224
    s_waitcnt lgkmcnt(3)
    v_mfma_f32_32x32x16_bf16 v[192:207], v[144:147], v[80:83], v[192:207]
    ds_read_b128 v[172:175], v8 offset:19456
    buffer_load_dwordx4 a[164:167], v246, s[20:23], s54 offen offset:2048
    v_rcp_f32 v225, v225
    v_mfma_f32_32x32x16_bf16 v[192:207], v[148:151], v[84:87], v[192:207]
    ds_read_b128 v[144:147], v8 offset:20480
    v_rcp_f32 v226, v226
    v_rcp_f32 v227, v227
    v_mfma_f32_32x32x16_bf16 v[192:207], v[152:155], v[88:91], v[192:207]
    ds_read_b128 v[148:151], v8 offset:21504
    buffer_load_dwordx4 a[216:219], v246, s[20:23], s51 offen offset:2048
    v_rcp_f32 v228, v228
    v_mfma_f32_32x32x16_bf16 v[192:207], v[156:159], v[92:95], v[192:207]
    ds_read_b128 v[152:155], v8 offset:22528
    v_rcp_f32 v229, v229
    v_rcp_f32 v230, v230
PAD_B_25:
    s_cbranch_execz PAD_B_26
    s_waitcnt lgkmcnt(3)
    v_mfma_f32_32x32x16_bf16 v[192:207], v[160:163], v[96:99], v[192:207]
    ds_read_b128 v[156:159], v8 offset:23552
    buffer_load_dwordx4 a[220:223], v246, s[20:23], s55 offen offset:2048
    v_rcp_f32 v231, v231
    v_mfma_f32_32x32x16_bf16 v[192:207], v[164:167], v[100:103], v[192:207]
    ds_read_b128 v[160:163], v8 offset:24576
    v_mul_f32 v232, v232, v224
    v_mul_f32 v233, v233, v225
    v_mul_f32 v234, v234, v226
    v_mul_f32 v235, v235, v227
    v_mul_f32 v236, v236, v228
    v_mfma_f32_32x32x16_bf16 v[192:207], v[168:171], v[104:107], v[192:207]
    ds_read_b128 v[164:167], v8 offset:25600
    v_mul_f32 v237, v237, v229
    v_mul_f32 v238, v238, v230
    v_mul_f32 v239, v239, v231
    v_cvt_pk_bf16_f32 v28, v232, v233
    v_cvt_pk_bf16_f32 v29, v234, v235
    v_mfma_f32_32x32x16_bf16 v[192:207], v[172:175], v[108:111], v[192:207]
    ds_read_b128 v[168:171], v8 offset:26624
    v_cvt_pk_bf16_f32 v30, v236, v237
    v_cvt_pk_bf16_f32 v31, v238, v239
    buffer_store_dwordx4 v[28:31], v4, s[20:23], s19 offen offset:3072 sc1
    v_mul_f32 v176, v176, v20
    s_waitcnt lgkmcnt(3)
    v_mfma_f32_32x32x16_bf16 v[192:207], v[144:147], v[112:115], v[192:207]
    ds_read_b128 v[172:175], v8 offset:27648
    v_mul_f32 v177, v177, v20
    v_mul_f32 v178, v178, v20
    v_mul_f32 v179, v179, v20
    v_mul_f32 v180, v180, v20
    v_mfma_f32_32x32x16_bf16 v[192:207], v[148:151], v[116:119], v[192:207]
    ds_read_b128 v[144:147], v8 offset:28672
    v_mul_f32 v181, v181, v20
    v_mul_f32 v182, v182, v20
    v_mul_f32 v183, v183, v20
    v_exp_f32 v176, v176
    v_mfma_f32_32x32x16_bf16 v[192:207], v[152:155], v[120:123], v[192:207]
    ds_read_b128 v[148:151], v8 offset:29696
    v_exp_f32 v177, v177
    v_exp_f32 v178, v178
    v_mfma_f32_32x32x16_bf16 v[192:207], v[156:159], v[124:127], v[192:207]
    ds_read_b128 v[152:155], v8 offset:30720
    v_exp_f32 v179, v179
    v_exp_f32 v180, v180
    s_waitcnt lgkmcnt(3)
    v_mfma_f32_32x32x16_bf16 v[192:207], v[160:163], v[128:131], v[192:207]
    ds_read_b128 v[156:159], v8 offset:31744
    v_exp_f32 v181, v181
    v_exp_f32 v182, v182
    v_mfma_f32_32x32x16_bf16 v[192:207], v[164:167], v[132:135], v[192:207]
    ds_read_b128 v[160:163], v8 offset:32768
    v_exp_f32 v183, v183
PAD_B_26:
    s_cbranch_execz PRET_B
    v_fma_f32 v176, v176, v21, v21
    v_fma_f32 v177, v177, v21, v21
    v_fma_f32 v178, v178, v21, v21
    v_mfma_f32_32x32x16_bf16 v[192:207], v[168:171], v[136:139], v[192:207]
    ds_read_b128 v[164:167], v8 offset:33792
    v_fma_f32 v179, v179, v21, v21
    v_fma_f32 v180, v180, v21, v21
    v_fma_f32 v181, v181, v21, v21
    v_fma_f32 v182, v182, v21, v21
    v_fma_f32 v183, v183, v21, v21
    v_mfma_f32_32x32x16_bf16 v[192:207], v[172:175], v[140:143], v[192:207]
    ds_read_b128 v[168:171], v8 offset:34816
    v_rcp_f32 v176, v176
    v_rcp_f32 v177, v177
    v_rcp_f32 v178, v178
    v_rcp_f32 v179, v179
    v_rcp_f32 v180, v180
    s_waitcnt lgkmcnt(3)
    v_mfma_f32_32x32x16_bf16 v[208:223], v[144:147], v[32:35], 0
    ds_read_b128 v[172:175], v8 offset:35840
    v_rcp_f32 v181, v181
    v_rcp_f32 v182, v182
    v_mfma_f32_32x32x16_bf16 v[208:223], v[148:151], v[36:39], v[208:223]
    ds_read_b128 v[144:147], v8 offset:36864
    buffer_load_dwordx4 v[32:35], v4, s[20:23], s32 offen
    v_rcp_f32 v183, v183
    v_mul_f32 v184, v184, v176
    v_mfma_f32_32x32x16_bf16 v[208:223], v[152:155], v[40:43], v[208:223]
    ds_read_b128 v[148:151], v8 offset:37888
    v_mul_f32 v185, v185, v177
    v_mul_f32 v186, v186, v178
    v_mul_f32 v187, v187, v179
    v_mul_f32 v188, v188, v180
    v_mul_f32 v189, v189, v181
    v_mfma_f32_32x32x16_bf16 v[208:223], v[156:159], v[44:47], v[208:223]
    ds_read_b128 v[152:155], v8 offset:38912
    buffer_load_dwordx4 v[36:39], v4, s[20:23], s56 offen
    v_mul_f32 v190, v190, v182
    v_mul_f32 v191, v191, v183
    v_cvt_pk_bf16_f32 v24, v184, v185
    s_waitcnt lgkmcnt(3)
    v_mfma_f32_32x32x16_bf16 v[208:223], v[160:163], v[48:51], v[208:223]
    ds_read_b128 v[156:159], v8 offset:39936
    v_cvt_pk_bf16_f32 v25, v186, v187
    v_cvt_pk_bf16_f32 v26, v188, v189
    v_cvt_pk_bf16_f32 v27, v190, v191
PAD_B_27:
    s_cbranch_execz PAD_B_28
    v_mfma_f32_32x32x16_bf16 v[208:223], v[164:167], v[52:55], v[208:223]
    ds_read_b128 v[160:163], v8 offset:40960
    buffer_load_dwordx4 v[40:43], v4, s[20:23], s33 offen
    buffer_store_dwordx4 v[24:27], v22, s[20:23], s19 offen sc1
    v_mul_f32 v192, v192, v20
    v_mfma_f32_32x32x16_bf16 v[208:223], v[168:171], v[56:59], v[208:223]
    ds_read_b128 v[164:167], v8 offset:41984
    v_mul_f32 v193, v193, v20
    v_mul_f32 v194, v194, v20
    v_mul_f32 v195, v195, v20
    v_mul_f32 v196, v196, v20
    v_mul_f32 v197, v197, v20
    v_mfma_f32_32x32x16_bf16 v[208:223], v[172:175], v[60:63], v[208:223]
    ds_read_b128 v[168:171], v8 offset:43008
    buffer_load_dwordx4 v[44:47], v4, s[20:23], s57 offen
    v_mul_f32 v198, v198, v20
    v_mul_f32 v199, v199, v20
    s_waitcnt lgkmcnt(3)
    v_mfma_f32_32x32x16_bf16 v[208:223], v[144:147], v[64:67], v[208:223]
    ds_read_b128 v[172:175], v8 offset:44032
    v_exp_f32 v192, v192
    v_exp_f32 v193, v193
    v_mfma_f32_32x32x16_bf16 v[208:223], v[148:151], v[68:71], v[208:223]
    ds_read_b128 v[144:147], v8 offset:45056
    buffer_load_dwordx4 v[48:51], v4, s[20:23], s34 offen
    v_exp_f32 v194, v194
    v_mfma_f32_32x32x16_bf16 v[208:223], v[152:155], v[72:75], v[208:223]
    ds_read_b128 v[148:151], v8 offset:46080
    v_exp_f32 v195, v195
    v_exp_f32 v196, v196
    v_mfma_f32_32x32x16_bf16 v[208:223], v[156:159], v[76:79], v[208:223]
    ds_read_b128 v[152:155], v8 offset:47104
    buffer_load_dwordx4 v[52:55], v4, s[20:23], s58 offen
    v_exp_f32 v197, v197
    s_waitcnt lgkmcnt(3)
    v_mfma_f32_32x32x16_bf16 v[208:223], v[160:163], v[80:83], v[208:223]
    ds_read_b128 v[156:159], v8 offset:48128
    v_exp_f32 v198, v198
    v_exp_f32 v199, v199
    v_mfma_f32_32x32x16_bf16 v[208:223], v[164:167], v[84:87], v[208:223]
    ds_read_b128 v[160:163], v9 offset:32768
    buffer_load_dwordx4 v[56:59], v4, s[20:23], s35 offen
    v_fma_f32 v192, v192, v21, v21
    v_fma_f32 v193, v193, v21, v21
    v_fma_f32 v194, v194, v21, v21
    v_mfma_f32_32x32x16_bf16 v[208:223], v[168:171], v[88:91], v[208:223]
    ds_read_b128 v[164:167], v9 offset:33792
    v_fma_f32 v195, v195, v21, v21
    v_fma_f32 v196, v196, v21, v21
PAD_B_28:
    s_cbranch_execz PRET_B
    v_fma_f32 v197, v197, v21, v21
    v_fma_f32 v198, v198, v21, v21
    v_fma_f32 v199, v199, v21, v21
    v_mfma_f32_32x32x16_bf16 v[208:223], v[172:175], v[92:95], v[208:223]
    ds_read_b128 v[168:171], v9 offset:34816
    buffer_load_dwordx4 v[60:63], v4, s[20:23], s59 offen
    v_rcp_f32 v192, v192
    s_waitcnt lgkmcnt(3)
    v_mfma_f32_32x32x16_bf16 v[208:223], v[144:147], v[96:99], v[208:223]
    ds_read_b128 v[172:175], v9 offset:35840
    v_rcp_f32 v193, v193
    v_rcp_f32 v194, v194
    v_mfma_f32_32x32x16_bf16 v[208:223], v[148:151], v[100:103], v[208:223]
    ds_read_b128 v[144:147], v9 offset:36864
    buffer_load_dwordx4 v[64:67], v4, s[20:23], s32 offen offset:1024
    v_rcp_f32 v195, v195
    v_mfma_f32_32x32x16_bf16 v[208:223], v[152:155], v[104:107], v[208:223]
    ds_read_b128 v[148:151], v9 offset:37888
    v_rcp_f32 v196, v196
    v_rcp_f32 v197, v197
    v_mfma_f32_32x32x16_bf16 v[208:223], v[156:159], v[108:111], v[208:223]
    ds_read_b128 v[152:155], v9 offset:38912
    buffer_load_dwordx4 v[68:71], v4, s[20:23], s56 offen offset:1024
    v_rcp_f32 v198, v198
    s_waitcnt lgkmcnt(3)
    v_mfma_f32_32x32x16_bf16 v[208:223], v[160:163], v[112:115], v[208:223]
    ds_read_b128 v[156:159], v9 offset:39936
    v_rcp_f32 v199, v199
    v_mul_f32 v200, v200, v192
    v_mul_f32 v201, v201, v193
    v_mfma_f32_32x32x16_bf16 v[208:223], v[164:167], v[116:119], v[208:223]
    buffer_load_dwordx4 v[72:75], v4, s[20:23], s33 offen offset:1024
    v_mul_f32 v202, v202, v194
    v_mul_f32 v203, v203, v195
    v_mul_f32 v204, v204, v196
    v_mul_f32 v205, v205, v197
    v_mfma_f32_32x32x16_bf16 v[208:223], v[168:171], v[120:123], v[208:223]
    v_mul_f32 v206, v206, v198
    v_mul_f32 v207, v207, v199
    v_cvt_pk_bf16_f32 v28, v200, v201
    v_cvt_pk_bf16_f32 v29, v202, v203
    v_cvt_pk_bf16_f32 v30, v204, v205
    v_cvt_pk_bf16_f32 v31, v206, v207
    v_mfma_f32_32x32x16_bf16 v[208:223], v[172:175], v[124:127], v[208:223]
    buffer_load_dwordx4 v[76:79], v4, s[20:23], s57 offen offset:1024
    buffer_store_dwordx4 v[28:31], v22, s[20:23], s19 offen offset:1024 sc1
    s_waitcnt lgkmcnt(0)
    v_mfma_f32_32x32x16_bf16 v[208:223], v[144:147], v[128:131], v[208:223]
PAD_B_29:
    s_cbranch_execz PRET_B
    v_mfma_f32_32x32x16_bf16 v[208:223], v[148:151], v[132:135], v[208:223]
    buffer_load_dwordx4 v[80:83], v4, s[20:23], s34 offen offset:1024
    v_mfma_f32_32x32x16_bf16 v[208:223], v[152:155], v[136:139], v[208:223]
    v_mfma_f32_32x32x16_bf16 v[208:223], v[156:159], v[140:143], v[208:223]
    buffer_load_dwordx4 v[84:87], v4, s[20:23], s58 offen offset:1024
    s_cmp_ge_u32 s2, 224
    s_cbranch_scc1 L_SPARE1
    s_waitcnt vmcnt(15)
    v_max3_u32 v13, v32, v33, v34
    s_waitcnt vmcnt(14)
    v_max3_u32 v14, v36, v37, v38
    v_max3_u32 v13, v13, v35, v39
    v_max_u32 v13, v13, v14
    v_cmp_eq_u32 vcc, -1, v13
    s_cbranch_vccnz VSLOW_45
VRET_46:
    v_mfma_f32_32x32x16_bf16 v[176:191], v[32:35], a[0:3], 0
    s_waitcnt vmcnt(13)
    v_max3_u32 v13, v40, v41, v42
    s_waitcnt vmcnt(11)
    v_max3_u32 v14, v44, v45, v46
    v_mul_f32 v208, v208, v20
    v_mul_f32 v209, v209, v20
    v_mul_f32 v210, v210, v20
    v_mfma_f32_32x32x16_bf16 a[240:255], v[32:35], a[4:7], 0
    v_max3_u32 v13, v13, v43, v47
    v_max_u32 v13, v13, v14
    buffer_load_dwordx4 v[88:91], v4, s[20:23], s35 offen offset:1024
    v_mul_f32 v211, v211, v20
    v_mul_f32 v212, v212, v20
    v_mfma_f32_32x32x16_bf16 v[192:207], v[36:39], a[0:3], 0
    v_cmp_eq_u32 vcc, -1, v13
    v_mul_f32 v213, v213, v20
    v_mul_f32 v214, v214, v20
    v_mul_f32 v215, v215, v20
    v_exp_f32 v208, v208
    v_mfma_f32_32x32x16_bf16 v[224:239], v[36:39], a[4:7], 0
    s_cbranch_vccnz VSLOW_47
VRET_48:
    buffer_load_dwordx4 v[92:95], v4, s[20:23], s59 offen offset:1024
    v_exp_f32 v209, v209
    v_mfma_f32_32x32x16_bf16 v[176:191], v[40:43], a[56:59], v[176:191]
    s_waitcnt vmcnt(12)
    v_max3_u32 v13, v48, v49, v50
    s_waitcnt vmcnt(11)
    v_max3_u32 v14, v52, v53, v54
    v_exp_f32 v210, v210
    v_mfma_f32_32x32x16_bf16 a[240:255], v[40:43], a[60:63], a[240:255]
    v_max3_u32 v13, v13, v51, v55
    v_max_u32 v13, v13, v14
    buffer_load_dwordx4 v[96:99], v4, s[20:23], s32 offen offset:2048
    v_exp_f32 v211, v211
    v_mfma_f32_32x32x16_bf16 v[192:207], v[44:47], a[56:59], v[192:207]
    v_cmp_eq_u32 vcc, -1, v13
    v_exp_f32 v212, v212
    v_exp_f32 v213, v213
PAD_B_30:
    s_cbranch_execz PAD_B_31
    v_mfma_f32_32x32x16_bf16 v[224:239], v[44:47], a[60:63], v[224:239]
    s_cbranch_vccnz VSLOW_49
VRET_50:
    buffer_load_dwordx4 v[100:103], v4, s[20:23], s56 offen offset:2048
    v_exp_f32 v214, v214
    v_mfma_f32_32x32x16_bf16 v[176:191], v[48:51], a[112:115], v[176:191]
    s_waitcnt vmcnt(12)
    v_max3_u32 v13, v56, v57, v58
    s_waitcnt vmcnt(11)
    v_max3_u32 v14, v60, v61, v62
    v_exp_f32 v215, v215
    v_fma_f32 v208, v208, v21, v21
    v_mfma_f32_32x32x16_bf16 a[240:255], v[48:51], a[116:119], a[240:255]
    v_max3_u32 v13, v13, v59, v63
    v_max_u32 v13, v13, v14
    buffer_load_dwordx4 v[104:107], v4, s[20:23], s33 offen offset:2048
    v_fma_f32 v209, v209, v21, v21
    v_fma_f32 v210, v210, v21, v21
    v_mfma_f32_32x32x16_bf16 v[192:207], v[52:55], a[112:115], v[192:207]
    v_cmp_eq_u32 vcc, -1, v13
    v_fma_f32 v211, v211, v21, v21
    v_fma_f32 v212, v212, v21, v21
    v_fma_f32 v213, v213, v21, v21
    v_fma_f32 v214, v214, v21, v21
    v_fma_f32 v215, v215, v21, v21
    v_mfma_f32_32x32x16_bf16 v[224:239], v[52:55], a[116:119], v[224:239]
    s_cbranch_vccnz VSLOW_51
VRET_52:
    buffer_load_dwordx4 v[108:111], v4, s[20:23], s57 offen offset:2048
    v_rcp_f32 v208, v208
    v_mfma_f32_32x32x16_bf16 v[176:191], v[56:59], a[168:171], v[176:191]
    s_waitcnt vmcnt(12)
    v_max3_u32 v13, v64, v65, v66
    s_waitcnt vmcnt(11)
    v_max3_u32 v14, v68, v69, v70
    v_rcp_f32 v209, v209
    v_mfma_f32_32x32x16_bf16 a[240:255], v[56:59], a[172:175], a[240:255]
    v_max3_u32 v13, v13, v67, v71
    v_max_u32 v13, v13, v14
    buffer_load_dwordx4 v[112:115], v4, s[20:23], s34 offen offset:2048
    v_rcp_f32 v210, v210
    v_mfma_f32_32x32x16_bf16 v[192:207], v[60:63], a[168:171], v[192:207]
    v_cmp_eq_u32 vcc, -1, v13
    v_rcp_f32 v211, v211
    v_rcp_f32 v212, v212
    v_mfma_f32_32x32x16_bf16 v[224:239], v[60:63], a[172:175], v[224:239]
    s_cbranch_vccnz VSLOW_53
VRET_54:
    buffer_load_dwordx4 v[116:119], v4, s[20:23], s58 offen offset:2048
    v_rcp_f32 v213, v213
    v_mfma_f32_32x32x16_bf16 v[176:191], v[64:67], a[8:11], v[176:191]
    s_waitcnt vmcnt(12)
    v_max3_u32 v13, v72, v73, v74
PAD_B_31:
    s_cbranch_execz PRET_B
    s_waitcnt vmcnt(11)
    v_max3_u32 v14, v76, v77, v78
    v_rcp_f32 v214, v214
    v_mfma_f32_32x32x16_bf16 a[240:255], v[64:67], a[12:15], a[240:255]
    v_max3_u32 v13, v13, v75, v79
    v_max_u32 v13, v13, v14
    buffer_load_dwordx4 v[120:123], v4, s[20:23], s35 offen offset:2048
    v_rcp_f32 v215, v215
    v_mfma_f32_32x32x16_bf16 v[192:207], v[68:71], a[8:11], v[192:207]
    v_cmp_eq_u32 vcc, -1, v13
    v_mul_f32 v216, v216, v208
    v_mul_f32 v217, v217, v209
    v_mul_f32 v218, v218, v210
    v_mul_f32 v219, v219, v211
    v_mul_f32 v220, v220, v212
    v_mfma_f32_32x32x16_bf16 v[224:239], v[68:71], a[12:15], v[224:239]
    s_cbranch_vccnz VSLOW_55
VRET_56:
    buffer_load_dwordx4 v[124:127], v4, s[20:23], s59 offen offset:2048
    v_mul_f32 v221, v221, v213
    v_mul_f32 v222, v222, v214
    v_mul_f32 v223, v223, v215
    v_mfma_f32_32x32x16_bf16 v[176:191], v[72:75], a[64:67], v[176:191]
    s_waitcnt vmcnt(11)
    v_max3_u32 v13, v80, v81, v82
    s_waitcnt vmcnt(10)
    v_max3_u32 v14, v84, v85, v86
    v_cvt_pk_bf16_f32 v24, v216, v217
    v_cvt_pk_bf16_f32 v25, v218, v219
    v_cvt_pk_bf16_f32 v26, v220, v221
    v_mfma_f32_32x32x16_bf16 a[240:255], v[72:75], a[68:71], a[240:255]
    v_max3_u32 v13, v13, v83, v87
    v_max_u32 v13, v13, v14
    buffer_load_dwordx4 v[128:131], v4, s[20:23], s32 offen offset:3072
    v_cvt_pk_bf16_f32 v27, v222, v223
    v_mfma_f32_32x32x16_bf16 v[192:207], v[76:79], a[64:67], v[192:207]
    v_cmp_eq_u32 vcc, -1, v13
    buffer_store_dwordx4 v[24:27], v22, s[20:23], s19 offen offset:2048 sc1
    v_mfma_f32_32x32x16_bf16 v[224:239], v[76:79], a[68:71], v[224:239]
    s_cbranch_vccnz VSLOW_57
VRET_58:
    buffer_load_dwordx4 v[132:135], v4, s[20:23], s56 offen offset:3072
    v_mfma_f32_32x32x16_bf16 v[176:191], v[80:83], a[120:123], v[176:191]
    s_waitcnt vmcnt(12)
    v_max3_u32 v13, v88, v89, v90
    s_waitcnt vmcnt(11)
    v_max3_u32 v14, v92, v93, v94
    v_mfma_f32_32x32x16_bf16 a[240:255], v[80:83], a[124:127], a[240:255]
    v_max3_u32 v13, v13, v91, v95
    v_max_u32 v13, v13, v14
    buffer_load_dwordx4 v[136:139], v4, s[20:23], s33 offen offset:3072
    v_mfma_f32_32x32x16_bf16 v[192:207], v[84:87], a[120:123], v[192:207]
    v_cmp_eq_u32 vcc, -1, v13
PAD_B_32:
    s_cbranch_execz PAD_B_33
    v_mfma_f32_32x32x16_bf16 v[224:239], v[84:87], a[124:127], v[224:239]
    s_cbranch_vccnz VSLOW_59
VRET_60:
    buffer_load_dwordx4 v[140:143], v4, s[20:23], s57 offen offset:3072
    v_mfma_f32_32x32x16_bf16 v[176:191], v[88:91], a[176:179], v[176:191]
    s_waitcnt vmcnt(12)
    v_max3_u32 v13, v96, v97, v98
    s_waitcnt vmcnt(11)
    v_max3_u32 v14, v100, v101, v102
    v_mfma_f32_32x32x16_bf16 a[240:255], v[88:91], a[180:183], a[240:255]
    v_max3_u32 v13, v13, v99, v103
    v_max_u32 v13, v13, v14
    buffer_load_dwordx4 v[144:147], v4, s[20:23], s34 offen offset:3072
    v_mfma_f32_32x32x16_bf16 v[192:207], v[92:95], a[176:179], v[192:207]
    v_cmp_eq_u32 vcc, -1, v13
    v_mfma_f32_32x32x16_bf16 v[224:239], v[92:95], a[180:183], v[224:239]
    s_cbranch_vccnz VSLOW_61
VRET_62:
    buffer_load_dwordx4 v[148:151], v4, s[20:23], s58 offen offset:3072
    v_mfma_f32_32x32x16_bf16 v[176:191], v[96:99], a[16:19], v[176:191]
    s_waitcnt vmcnt(12)
    v_max3_u32 v13, v104, v105, v106
    s_waitcnt vmcnt(11)
    v_max3_u32 v14, v108, v109, v110
    v_mfma_f32_32x32x16_bf16 a[240:255], v[96:99], a[20:23], a[240:255]
    v_max3_u32 v13, v13, v107, v111
    v_max_u32 v13, v13, v14
    buffer_load_dwordx4 v[152:155], v4, s[20:23], s35 offen offset:3072
    v_mfma_f32_32x32x16_bf16 v[192:207], v[100:103], a[16:19], v[192:207]
    v_cmp_eq_u32 vcc, -1, v13
    v_mfma_f32_32x32x16_bf16 v[224:239], v[100:103], a[20:23], v[224:239]
    s_cbranch_vccnz VSLOW_63
VRET_64:
    buffer_load_dwordx4 v[156:159], v4, s[20:23], s59 offen offset:3072
    v_mfma_f32_32x32x16_bf16 v[176:191], v[104:107], a[72:75], v[176:191]
    s_waitcnt vmcnt(12)
    v_max3_u32 v13, v112, v113, v114
    s_waitcnt vmcnt(11)
    v_max3_u32 v14, v116, v117, v118
    v_mfma_f32_32x32x16_bf16 a[240:255], v[104:107], a[76:79], a[240:255]
    v_max3_u32 v13, v13, v115, v119
    v_max_u32 v13, v13, v14
    buffer_load_dwordx4 v[160:163], v22, s[20:23], s32 offen
    v_mfma_f32_32x32x16_bf16 v[192:207], v[108:111], a[72:75], v[192:207]
    v_cmp_eq_u32 vcc, -1, v13
PAD_B_33:
    s_cbranch_execz PRET_B
    v_mfma_f32_32x32x16_bf16 v[224:239], v[108:111], a[76:79], v[224:239]
    s_cbranch_vccnz VSLOW_65
VRET_66:
    buffer_load_dwordx4 v[164:167], v22, s[20:23], s56 offen
    v_mfma_f32_32x32x16_bf16 v[176:191], v[112:115], a[128:131], v[176:191]
    s_waitcnt vmcnt(12)
    v_max3_u32 v13, v120, v121, v122
    s_waitcnt vmcnt(11)
    v_max3_u32 v14, v124, v125, v126
    v_mfma_f32_32x32x16_bf16 a[240:255], v[112:115], a[132:135], a[240:255]
    v_max3_u32 v13, v13, v123, v127
    v_max_u32 v13, v13, v14
    buffer_load_dwordx4 v[168:171], v22, s[20:23], s33 offen
    v_mfma_f32_32x32x16_bf16 v[192:207], v[116:119], a[128:131], v[192:207]
    v_cmp_eq_u32 vcc, -1, v13
    v_mfma_f32_32x32x16_bf16 v[224:239], v[116:119], a[132:135], v[224:239]
    s_cbranch_vccnz VSLOW_67
VRET_68:
    buffer_load_dwordx4 v[172:175], v22, s[20:23], s57 offen
    v_mfma_f32_32x32x16_bf16 v[176:191], v[120:123], a[184:187], v[176:191]
    s_waitcnt vmcnt(12)
    v_max3_u32 v13, v128, v129, v130
    s_waitcnt vmcnt(10)
    v_max3_u32 v14, v132, v133, v134
    v_mfma_f32_32x32x16_bf16 a[240:255], v[120:123], a[188:191], a[240:255]
    v_max3_u32 v13, v13, v131, v135
    v_max_u32 v13, v13, v14
    buffer_load_dwordx4 v[32:35], v22, s[20:23], s34 offen
    v_mfma_f32_32x32x16_bf16 v[192:207], v[124:127], a[184:187], v[192:207]
    v_cmp_eq_u32 vcc, -1, v13
    v_mfma_f32_32x32x16_bf16 v[224:239], v[124:127], a[188:191], v[224:239]
    s_cbranch_vccnz VSLOW_69
VRET_70:
    buffer_load_dwordx4 v[36:39], v22, s[20:23], s58 offen
    v_mfma_f32_32x32x16_bf16 v[176:191], v[128:131], a[24:27], v[176:191]
    s_waitcnt vmcnt(11)
    v_max3_u32 v13, v136, v137, v138
    s_waitcnt vmcnt(10)
    v_max3_u32 v14, v140, v141, v142
PAD_B_34:
    s_cbranch_execz PAD_B_35
    v_mfma_f32_32x32x16_bf16 a[240:255], v[128:131], a[28:31], a[240:255]
    v_max3_u32 v13, v13, v139, v143
    v_max_u32 v13, v13, v14
    buffer_load_dwordx4 v[40:43], v22, s[20:23], s35 offen
    v_mfma_f32_32x32x16_bf16 v[192:207], v[132:135], a[24:27], v[192:207]
    v_cmp_eq_u32 vcc, -1, v13
    v_and_b32 v5, 31, v2
    v_lshrrev_b32 v6, 5, v2
    v_lshlrev_b32 v5, 12, v5
    v_lshl_add_u32 v5, v6, 4, v5
    buffer_load_dwordx4 v[240:243], v5, s[20:23], s43 offen
    buffer_load_dwordx4 v[244:247], v5, s[20:23], s43 offen offset:32
    v_mfma_f32_32x32x16_bf16 v[224:239], v[132:135], a[28:31], v[224:239]
    s_cbranch_vccnz VSLOW_71
VRET_72:
    buffer_load_dwordx4 v[44:47], v22, s[20:23], s59 offen
    v_mfma_f32_32x32x16_bf16 v[176:191], v[136:139], a[80:83], v[176:191]
    s_waitcnt vmcnt(13)
    v_max3_u32 v13, v144, v145, v146
    s_waitcnt vmcnt(12)
    v_max3_u32 v14, v148, v149, v150
    v_mfma_f32_32x32x16_bf16 a[240:255], v[136:139], a[84:87], a[240:255]
    v_max3_u32 v13, v13, v147, v151
    v_max_u32 v13, v13, v14
    buffer_load_dwordx4 v[48:51], v22, s[20:23], s32 offen offset:1024
    v_mfma_f32_32x32x16_bf16 v[192:207], v[140:143], a[80:83], v[192:207]
    v_cmp_eq_u32 vcc, -1, v13
    v_mfma_f32_32x32x16_bf16 v[224:239], v[140:143], a[84:87], v[224:239]
    s_cbranch_vccnz VSLOW_73
VRET_74:
    buffer_load_dwordx4 v[52:55], v22, s[20:23], s56 offen offset:1024
    v_mfma_f32_32x32x16_bf16 v[176:191], v[144:147], a[136:139], v[176:191]
    s_waitcnt vmcnt(13)
    v_max3_u32 v13, v152, v153, v154
    s_waitcnt vmcnt(12)
    v_max3_u32 v14, v156, v157, v158
    v_mfma_f32_32x32x16_bf16 a[240:255], v[144:147], a[140:143], a[240:255]
    v_max3_u32 v13, v13, v155, v159
    v_max_u32 v13, v13, v14
    buffer_load_dwordx4 v[56:59], v22, s[20:23], s33 offen offset:1024
    v_mfma_f32_32x32x16_bf16 v[192:207], v[148:151], a[136:139], v[192:207]
    v_cmp_eq_u32 vcc, -1, v13
PAD_B_35:
    s_cbranch_execz PRET_B
    v_mfma_f32_32x32x16_bf16 v[224:239], v[148:151], a[140:143], v[224:239]
    s_cbranch_vccnz VSLOW_75
VRET_76:
    buffer_load_dwordx4 v[60:63], v22, s[20:23], s57 offen offset:1024
    v_mfma_f32_32x32x16_bf16 v[176:191], v[152:155], a[192:195], v[176:191]
    s_waitcnt vmcnt(13)
    v_max3_u32 v13, v160, v161, v162
    s_waitcnt vmcnt(12)
    v_max3_u32 v14, v164, v165, v166
    v_mfma_f32_32x32x16_bf16 a[240:255], v[152:155], a[196:199], a[240:255]
    v_max3_u32 v13, v13, v163, v167
    v_max_u32 v13, v13, v14
    buffer_load_dwordx4 v[64:67], v22, s[20:23], s34 offen offset:1024
    v_mfma_f32_32x32x16_bf16 v[192:207], v[156:159], a[192:195], v[192:207]
    v_cmp_eq_u32 vcc, -1, v13
    v_mfma_f32_32x32x16_bf16 v[224:239], v[156:159], a[196:199], v[224:239]
    s_cbranch_vccnz VSLOW_77
VRET_78:
    buffer_load_dwordx4 v[68:71], v22, s[20:23], s58 offen offset:1024
    v_mfma_f32_32x32x16_bf16 v[176:191], v[160:163], a[32:35], v[176:191]
    s_waitcnt vmcnt(13)
    v_max3_u32 v13, v168, v169, v170
    s_waitcnt vmcnt(12)
    v_max3_u32 v14, v172, v173, v174
    v_mfma_f32_32x32x16_bf16 a[240:255], v[160:163], a[36:39], a[240:255]
    v_max3_u32 v13, v13, v171, v175
    v_max_u32 v13, v13, v14
    buffer_load_dwordx4 v[72:75], v22, s[20:23], s35 offen offset:1024
    v_mfma_f32_32x32x16_bf16 v[192:207], v[164:167], a[32:35], v[192:207]
    v_cmp_eq_u32 vcc, -1, v13
    v_mfma_f32_32x32x16_bf16 v[224:239], v[164:167], a[36:39], v[224:239]
    s_cbranch_vccnz VSLOW_79
VRET_80:
    buffer_load_dwordx4 v[76:79], v22, s[20:23], s59 offen offset:1024
    v_mfma_f32_32x32x16_bf16 v[176:191], v[168:171], a[88:91], v[176:191]
    s_waitcnt vmcnt(13)
    v_max3_u32 v13, v32, v33, v34
    s_waitcnt vmcnt(12)
    v_max3_u32 v14, v36, v37, v38
    v_mfma_f32_32x32x16_bf16 a[240:255], v[168:171], a[92:95], a[240:255]
    v_max3_u32 v13, v13, v35, v39
    v_max_u32 v13, v13, v14
    buffer_load_dwordx4 v[80:83], v22, s[20:23], s32 offen offset:2048
    v_mfma_f32_32x32x16_bf16 v[192:207], v[172:175], a[88:91], v[192:207]
    v_cmp_eq_u32 vcc, -1, v13
PAD_B_36:
    s_cbranch_execz PAD_B_37
    v_mfma_f32_32x32x16_bf16 v[224:239], v[172:175], a[92:95], v[224:239]
    s_cbranch_vccnz VSLOW_81
VRET_82:
    buffer_load_dwordx4 v[84:87], v22, s[20:23], s56 offen offset:2048
    v_mfma_f32_32x32x16_bf16 v[176:191], v[32:35], a[144:147], v[176:191]
    s_waitcnt vmcnt(13)
    v_max3_u32 v13, v40, v41, v42
    s_waitcnt vmcnt(10)
    v_max3_u32 v14, v44, v45, v46
    v_mfma_f32_32x32x16_bf16 a[240:255], v[32:35], a[148:151], a[240:255]
    v_max3_u32 v13, v13, v43, v47
    v_max_u32 v13, v13, v14
    buffer_load_dwordx4 v[88:91], v22, s[20:23], s33 offen offset:2048
    v_mfma_f32_32x32x16_bf16 v[192:207], v[36:39], a[144:147], v[192:207]
    v_cmp_eq_u32 vcc, -1, v13
    v_mfma_f32_32x32x16_bf16 v[224:239], v[36:39], a[148:151], v[224:239]
    s_cbranch_vccnz VSLOW_83
VRET_84:
    buffer_load_dwordx4 v[92:95], v22, s[20:23], s57 offen offset:2048
    v_mfma_f32_32x32x16_bf16 v[176:191], v[40:43], a[200:203], v[176:191]
    s_waitcnt vmcnt(11)
    v_max3_u32 v13, v48, v49, v50
    s_waitcnt vmcnt(10)
    v_max3_u32 v14, v52, v53, v54
    v_mfma_f32_32x32x16_bf16 a[240:255], v[40:43], a[204:207], a[240:255]
    v_max3_u32 v13, v13, v51, v55
    v_max_u32 v13, v13, v14
    buffer_load_dwordx4 v[96:99], v22, s[20:23], s34 offen offset:2048
    v_mfma_f32_32x32x16_bf16 v[192:207], v[44:47], a[200:203], v[192:207]
    v_cmp_eq_u32 vcc, -1, v13
    v_mfma_f32_32x32x16_bf16 v[224:239], v[44:47], a[204:207], v[224:239]
    s_cbranch_vccnz VSLOW_85
VRET_86:
    buffer_load_dwordx4 v[100:103], v22, s[20:23], s58 offen offset:2048
    v_mfma_f32_32x32x16_bf16 v[176:191], v[48:51], a[40:43], v[176:191]
    s_waitcnt vmcnt(11)
    v_max3_u32 v13, v56, v57, v58
    s_waitcnt vmcnt(10)
    v_max3_u32 v14, v60, v61, v62
    v_mfma_f32_32x32x16_bf16 a[240:255], v[48:51], a[44:47], a[240:255]
    v_max3_u32 v13, v13, v59, v63
    v_max_u32 v13, v13, v14
    buffer_load_dwordx4 v[104:107], v22, s[20:23], s35 offen offset:2048
    v_mfma_f32_32x32x16_bf16 v[192:207], v[52:55], a[40:43], v[192:207]
    v_cmp_eq_u32 vcc, -1, v13
PAD_B_37:
    s_cbranch_execz PRET_B
    v_mfma_f32_32x32x16_bf16 v[224:239], v[52:55], a[44:47], v[224:239]
    s_cbranch_vccnz VSLOW_87
VRET_88:
    buffer_load_dwordx4 v[108:111], v22, s[20:23], s59 offen offset:2048
    v_mfma_f32_32x32x16_bf16 v[176:191], v[56:59], a[96:99], v[176:191]
    s_waitcnt vmcnt(11)
    v_max3_u32 v13, v64, v65, v66
    s_waitcnt vmcnt(10)
    v_max3_u32 v14, v68, v69, v70
    v_mfma_f32_32x32x16_bf16 a[240:255], v[56:59], a[100:103], a[240:255]
    v_max3_u32 v13, v13, v67, v71
    v_max_u32 v13, v13, v14
    v_mfma_f32_32x32x16_bf16 v[192:207], v[60:63], a[96:99], v[192:207]
    v_cmp_eq_u32 vcc, -1, v13
    v_mfma_f32_32x32x16_bf16 v[224:239], v[60:63], a[100:103], v[224:239]
    s_cbranch_vccnz VSLOW_89
VRET_90:
    v_mfma_f32_32x32x16_bf16 v[176:191], v[64:67], a[152:155], v[176:191]
    s_waitcnt vmcnt(9)
    v_max3_u32 v13, v72, v73, v74
    s_waitcnt vmcnt(8)
    v_max3_u32 v14, v76, v77, v78
    v_mfma_f32_32x32x16_bf16 a[240:255], v[64:67], a[156:159], a[240:255]
    v_max3_u32 v13, v13, v75, v79
    v_max_u32 v13, v13, v14
    v_mfma_f32_32x32x16_bf16 v[192:207], v[68:71], a[152:155], v[192:207]
    v_cmp_eq_u32 vcc, -1, v13
    v_mfma_f32_32x32x16_bf16 v[224:239], v[68:71], a[156:159], v[224:239]
    s_cbranch_vccnz VSLOW_91
VRET_92:
    v_mfma_f32_32x32x16_bf16 v[176:191], v[72:75], a[208:211], v[176:191]
    s_waitcnt vmcnt(7)
    v_max3_u32 v13, v80, v81, v82
    s_waitcnt vmcnt(6)
    v_max3_u32 v14, v84, v85, v86
    v_mfma_f32_32x32x16_bf16 a[240:255], v[72:75], a[212:215], a[240:255]
    v_max3_u32 v13, v13, v83, v87
    v_max_u32 v13, v13, v14
    v_mfma_f32_32x32x16_bf16 v[192:207], v[76:79], a[208:211], v[192:207]
    v_cmp_eq_u32 vcc, -1, v13
    v_mfma_f32_32x32x16_bf16 v[224:239], v[76:79], a[212:215], v[224:239]
    s_cbranch_vccnz VSLOW_93
VRET_94:
    v_mfma_f32_32x32x16_bf16 v[176:191], v[80:83], a[48:51], v[176:191]
    s_waitcnt vmcnt(5)
    v_max3_u32 v13, v88, v89, v90
    s_waitcnt vmcnt(4)
    v_max3_u32 v14, v92, v93, v94
    v_mfma_f32_32x32x16_bf16 a[240:255], v[80:83], a[52:55], a[240:255]
    v_max3_u32 v13, v13, v91, v95
    v_max_u32 v13, v13, v14
    v_mfma_f32_32x32x16_bf16 v[192:207], v[84:87], a[48:51], v[192:207]
    v_cmp_eq_u32 vcc, -1, v13
    v_mfma_f32_32x32x16_bf16 v[224:239], v[84:87], a[52:55], v[224:239]
PAD_B_38:
    s_cbranch_execz PRET_B
    s_cbranch_vccnz VSLOW_95
VRET_96:
    v_mfma_f32_32x32x16_bf16 v[176:191], v[88:91], a[104:107], v[176:191]
    s_waitcnt vmcnt(3)
    v_max3_u32 v13, v96, v97, v98
    s_waitcnt vmcnt(2)
    v_max3_u32 v14, v100, v101, v102
    v_mfma_f32_32x32x16_bf16 a[240:255], v[88:91], a[108:111], a[240:255]
    v_max3_u32 v13, v13, v99, v103
    v_max_u32 v13, v13, v14
    v_mfma_f32_32x32x16_bf16 v[192:207], v[92:95], a[104:107], v[192:207]
    v_cmp_eq_u32 vcc, -1, v13
    v_mfma_f32_32x32x16_bf16 v[224:239], v[92:95], a[108:111], v[224:239]
    s_cbranch_vccnz VSLOW_97
VRET_98:
    v_mfma_f32_32x32x16_bf16 v[176:191], v[96:99], a[160:163], v[176:191]
    s_waitcnt vmcnt(1)
    v_max3_u32 v13, v104, v105, v106
    s_waitcnt vmcnt(0)
    v_max3_u32 v14, v108, v109, v110
    v_mfma_f32_32x32x16_bf16 a[240:255], v[96:99], a[164:167], a[240:255]
    v_max3_u32 v13, v13, v107, v111
    v_max_u32 v13, v13, v14
    v_mfma_f32_32x32x16_bf16 v[192:207], v[100:103], a[160:163], v[192:207]
    v_cmp_eq_u32 vcc, -1, v13
    v_mfma_f32_32x32x16_bf16 v[224:239], v[100:103], a[164:167], v[224:239]
    s_cbranch_vccnz VSLOW_99
VRET_100:
    v_mfma_f32_32x32x16_bf16 v[176:191], v[104:107], a[216:219], v[176:191]
    v_mfma_f32_32x32x16_bf16 a[240:255], v[104:107], a[220:223], a[240:255]
    v_mfma_f32_32x32x16_bf16 v[192:207], v[108:111], a[216:219], v[192:207]
    v_mfma_f32_32x32x16_bf16 v[224:239], v[108:111], a[220:223], v[224:239]
    v_lshrrev_b32 v5, 5, v2
    v_lshlrev_b32 v5, 2, v5
    v_bfe_u32 v6, v2, 2, 2
    v_add_u32 v5, v5, v6
    v_lshlrev_b32 v5, 6, v5
    v_bfe_u32 v6, v2, 4, 1
    v_lshl_add_u32 v5, v6, 5, v5
    v_and_b32 v6, 3, v2
    v_lshl_add_u32 v5, v6, 3, v5
    v_add_u32 v5, s47, v5
    s_xor_b32 s52, s6, 1
    s_mul_i32 s52, s52, 12288
    s_add_u32 s52, s52, 66560
    v_add_u32 v8, s52, v4
    s_xor_b32 s52, s6, 2
    s_mul_i32 s52, s52, 12288
    s_add_u32 s52, s52, 70656
    v_add_u32 v9, s52, v4
    s_xor_b32 s52, s6, 3
    s_mul_i32 s52, s52, 12288
    s_add_u32 s52, s52, 74752
    v_add_u32 v10, s52, v4
PAD_B_39:
    s_cbranch_execz PAD_B_40
    s_mul_i32 s52, s6, 12288
    s_add_u32 s52, s52, 66560
    v_add_u32 v11, s52, v4
    v_permlane32_swap_b32 v240, v242
    v_permlane32_swap_b32 v241, v243
    v_permlane32_swap_b32 v244, v246
    v_permlane32_swap_b32 v245, v247
    ds_write_b128 v8, v[192:195] offset:0
    ds_write_b128 v8, v[196:199] offset:1024
    ds_write_b128 v8, v[200:203] offset:2048
    ds_write_b128 v8, v[204:207] offset:3072
    ds_write_b128 v9, a[240:243] offset:0
    ds_write_b128 v9, a[244:247] offset:1024
    ds_write_b128 v9, a[248:251] offset:2048
    ds_write_b128 v9, a[252:255] offset:3072
    ds_write_b128 v10, v[224:227] offset:0
    ds_write_b128 v10, v[228:231] offset:1024
    ds_write_b128 v10, v[232:235] offset:2048
    ds_write_b128 v10, v[236:239] offset:3072
    v_lshlrev_b32 v16, 16, v240
    v_and_b32 v17, 0xffff0000, v240
    v_lshlrev_b32 v18, 16, v241
    v_and_b32 v19, 0xffff0000, v241
    v_lshlrev_b32 v20, 16, v242
    v_and_b32 v21, 0xffff0000, v242
    v_lshlrev_b32 v22, 16, v243
    v_and_b32 v23, 0xffff0000, v243
    v_lshlrev_b32 v24, 16, v244
    v_and_b32 v25, 0xffff0000, v244
    v_lshlrev_b32 v26, 16, v245
    v_and_b32 v27, 0xffff0000, v245
    v_lshlrev_b32 v28, 16, v246
    v_and_b32 v29, 0xffff0000, v246
    v_lshlrev_b32 v30, 16, v247
    v_and_b32 v31, 0xffff0000, v247
    v_pk_add_f32 v[176:177], v[176:177], v[16:17]
    v_pk_add_f32 v[178:179], v[178:179], v[18:19]
    v_pk_add_f32 v[180:181], v[180:181], v[20:21]
    v_pk_add_f32 v[182:183], v[182:183], v[22:23]
    v_pk_add_f32 v[184:185], v[184:185], v[24:25]
    v_pk_add_f32 v[186:187], v[186:187], v[26:27]
    v_pk_add_f32 v[188:189], v[188:189], v[28:29]
    v_pk_add_f32 v[190:191], v[190:191], v[30:31]
    s_waitcnt lgkmcnt(0)
    s_barrier
    ds_read_b128 v[32:35], v11 offset:0
    ds_read_b128 v[36:39], v11 offset:1024
PAD_B_40:
    s_cbranch_execz PRET_B
    ds_read_b128 v[40:43], v11 offset:2048
    ds_read_b128 v[44:47], v11 offset:3072
    ds_read_b128 v[48:51], v11 offset:4096
    ds_read_b128 v[52:55], v11 offset:5120
    ds_read_b128 v[56:59], v11 offset:6144
    ds_read_b128 v[60:63], v11 offset:7168
    ds_read_b128 v[64:67], v11 offset:8192
    ds_read_b128 v[68:71], v11 offset:9216
    ds_read_b128 v[72:75], v11 offset:10240
    ds_read_b128 v[76:79], v11 offset:11264
    s_waitcnt lgkmcnt(11)
    v_pk_add_f32 v[176:177], v[176:177], v[32:33]
    v_pk_add_f32 v[178:179], v[178:179], v[34:35]
    s_waitcnt lgkmcnt(10)
    v_pk_add_f32 v[180:181], v[180:181], v[36:37]
    v_pk_add_f32 v[182:183], v[182:183], v[38:39]
    s_waitcnt lgkmcnt(9)
    v_pk_add_f32 v[184:185], v[184:185], v[40:41]
    v_pk_add_f32 v[186:187], v[186:187], v[42:43]
    s_waitcnt lgkmcnt(8)
    v_pk_add_f32 v[188:189], v[188:189], v[44:45]
    v_pk_add_f32 v[190:191], v[190:191], v[46:47]
    s_waitcnt lgkmcnt(7)
    v_pk_add_f32 v[176:177], v[176:177], v[48:49]
    v_pk_add_f32 v[178:179], v[178:179], v[50:51]
    s_waitcnt lgkmcnt(6)
    v_pk_add_f32 v[180:181], v[180:181], v[52:53]
    v_pk_add_f32 v[182:183], v[182:183], v[54:55]
    s_waitcnt lgkmcnt(5)
    v_pk_add_f32 v[184:185], v[184:185], v[56:57]
    v_pk_add_f32 v[186:187], v[186:187], v[58:59]
    s_waitcnt lgkmcnt(4)
    v_pk_add_f32 v[188:189], v[188:189], v[60:61]
    v_pk_add_f32 v[190:191], v[190:191], v[62:63]
    s_waitcnt lgkmcnt(3)
    v_pk_add_f32 v[176:177], v[176:177], v[64:65]
    v_pk_add_f32 v[178:179], v[178:179], v[66:67]
    s_waitcnt lgkmcnt(2)
    v_pk_add_f32 v[180:181], v[180:181], v[68:69]
    v_pk_add_f32 v[182:183], v[182:183], v[70:71]
    s_waitcnt lgkmcnt(1)
    v_pk_add_f32 v[184:185], v[184:185], v[72:73]
    v_pk_add_f32 v[186:187], v[186:187], v[74:75]
    s_waitcnt lgkmcnt(0)
    v_pk_add_f32 v[188:189], v[188:189], v[76:77]
    v_pk_add_f32 v[190:191], v[190:191], v[78:79]
PAD_B_41:
    s_cbranch_execz PAD_B_42
    v_cvt_pk_bf16_f32 v80, v176, v177
    v_cvt_pk_bf16_f32 v81, v178, v179
    v_cvt_pk_bf16_f32 v82, v180, v181
    v_cvt_pk_bf16_f32 v83, v182, v183
    v_cvt_pk_bf16_f32 v84, v184, v185
    v_cvt_pk_bf16_f32 v85, v186, v187
    v_cvt_pk_bf16_f32 v86, v188, v189
    v_cvt_pk_bf16_f32 v87, v190, v191
    v_permlane32_swap_b32 v80, v82
    v_permlane32_swap_b32 v81, v83
    v_permlane32_swap_b32 v84, v86
    v_permlane32_swap_b32 v85, v87
    v_and_b32 v8, 31, v2
    v_lshrrev_b32 v6, 5, v2
    v_lshlrev_b32 v7, 12, v8
    v_lshl_add_u32 v7, v6, 4, v7
    s_add_u32 s43, s42, 14680064
    buffer_store_dwordx4 v[80:83], v7, s[20:23], s43 offen sc1
    buffer_store_dwordx4 v[84:87], v7, s[20:23], s43 offen offset:32 sc1
    v_lshlrev_b32 v9, 6, v8
    v_lshl_add_u32 v9, v6, 4, v9
    v_add_u32 v9, s47, v9
    ds_write_b128 v9, v[80:83]
    ds_write_b128 v9, v[84:87] offset:32
    v_mov_b32 v9, 0x3f803f80
    v_mov_b32 v10, 0
    v_mov_b32 v11, 0
    v_lshrrev_b32 v12, 3, v8
    v_lshlrev_b32 v12, 7, v12
    v_lshl_add_u32 v12, v6, 5, v12
    v_and_b32 v13, 7, v2
    v_lshl_add_u32 v12, v13, 2, v12
    s_lshl_b32 s49, s40, 9
    s_and_b32 s48, s41, 0
    s_lshl_b32 s48, s48, 15
    s_add_u32 s49, s49, s48
    s_add_u32 s49, s49, 524288
    s_waitcnt lgkmcnt(0)
    ds_read_b64_tr_b16 v[16:17], v5 offset:0
    ds_read_b64_tr_b16 v[18:19], v5 offset:512
    ds_read_b64_tr_b16 v[20:21], v5 offset:1024
    ds_read_b64_tr_b16 v[22:23], v5 offset:1536
    s_waitcnt lgkmcnt(3)
    v_dot2c_f32_bf16 v10, v16, v9
    v_dot2c_f32_bf16 v11, v16, v16
    v_dot2c_f32_bf16 v10, v17, v9
    v_dot2c_f32_bf16 v11, v17, v17
    s_waitcnt lgkmcnt(2)
    v_dot2c_f32_bf16 v10, v18, v9
    v_dot2c_f32_bf16 v11, v18, v18
    v_dot2c_f32_bf16 v10, v19, v9
    v_dot2c_f32_bf16 v11, v19, v19
    s_waitcnt lgkmcnt(1)
    v_dot2c_f32_bf16 v10, v20, v9
    v_dot2c_f32_bf16 v11, v20, v20
    v_dot2c_f32_bf16 v10, v21, v9
    v_dot2c_f32_bf16 v11, v21, v21
PAD_B_42:
    s_cbranch_execz PRET_B
    s_waitcnt lgkmcnt(0)
    v_dot2c_f32_bf16 v10, v22, v9
    v_dot2c_f32_bf16 v11, v22, v22
    v_dot2c_f32_bf16 v10, v23, v9
    v_dot2c_f32_bf16 v11, v23, v23
    s_nop 2
    v_permlane32_swap_b32 v10, v11
    v_add_f32 v10, v10, v11
    buffer_atomic_add_f32 v10, v12, s[20:23], s49 offen sc1
PAD_C_0:
    s_cbranch_execz PAD_C_1
    v_lshlrev_b32 v3, 4, v0
    v_lshlrev_b32 v4, 4, v2
    v_lshlrev_b32 v5, 7, v0
    v_and_b32 v6, 15, v2
    v_lshrrev_b32 v7, 4, v2
    s_and_b32 s17, s6, 1
    s_lshr_b32 s18, s6, 1
    v_lshlrev_b32 v32, 1, v6
    v_sub_u32 v33, 30, v32
    v_sub_u32 v34, 4188, v32
    v_and_b32 v35, 1, v6
    v_cmp_eq_u32 vcc, 1, v35
    s_nop 1
    v_cndmask_b32 v33, v34, v33, vcc
    v_lshl_add_u32 v33, v7, 4, v33
    s_mul_i32 s19, s17, 8320
    s_lshl_b32 s24, s18, 8
    s_sub_u32 s19, s19, s24
    s_add_u32 s19, s19, 256
    v_add_u32 v36, s19, v33
    v_add_u32 v37, 1024, v36
    v_add_u32 v38, 2048, v36
    v_add_u32 v39, 3072, v36
    v_lshlrev_b32 v32, 5, v6
    v_lshl_add_u32 v32, v7, 4, v32
    s_mul_i32 s19, s17, 4608
    s_sub_u32 s19, s19, s24
    s_add_u32 s19, s19, 17696
    v_add_u32 v40, s19, v32
    s_waitcnt vmcnt(0)
    s_barrier
    s_cmp_lg_u32 s6, 0
    s_cbranch_scc1 SKIP_101
    s_add_u32 s92, s88, 4
    v_mov_b32 v253, s92
    v_lshlrev_b32 v252, 10, v2
    buffer_store_dword v253, v252, s[20:23], s89 offen sc1
    s_mov_b64 exec, -1
    s_add_u32 s3, s88, 4
    s_mov_b32 s92, 30000
    s_mov_b32 exec_lo, 0x7f7f7f7f
    s_mov_b32 exec_hi, 0x7f7f7f7f
POLL_103:
    buffer_load_dwordx4 v[248:251], v254, s[20:23], s90 offen sc1
    s_waitcnt vmcnt(0)
    v_subrev_u32 v248, s3, v248
    v_subrev_u32 v249, s3, v249
    v_subrev_u32 v250, s3, v250
    v_subrev_u32 v251, s3, v251
    v_max3_u32 v248, v248, v249, v250
    v_max_u32 v248, v248, v251
    v_cmp_lt_u32 vcc, 7, v248
    s_and_b64 exec, vcc, exec
    s_cbranch_scc0 PDONE_104
    s_sub_u32 s92, s92, 1
    s_cmp_lg_u32 s92, 0
    s_cbranch_scc1 POLL_103
PDONE_104:
    s_mov_b64 exec, -1
SKIP_101:
    s_barrier
    s_lshl_b32 s11, s93, 13
    s_mov_b32 s13, 524288
    buffer_load_dwordx4 v[16:19], v5, s[20:23], s13 offen
PAD_C_1:
    s_cbranch_execz PAD_C_2
    buffer_load_dwordx4 v[24:27], v5, s[20:23], s13 offen offset:32
    buffer_load_dwordx4 v[20:23], v5, s[20:23], s13 offen offset:16
    buffer_load_dwordx4 v[28:31], v5, s[20:23], s13 offen offset:48
    s_add_u32 s14, s11, 14680064
    s_add_u32 s15, s11, 14684160
    buffer_load_dwordx4 v[8:11], v3, s[20:23], s14 offen sc1
    buffer_load_dwordx4 v[12:15], v3, s[20:23], s15 offen sc1
    v_mov_b32 v32, 0
    v_mov_b32 v33, 0
    v_mov_b32 v34, 0
    v_mov_b32 v35, 0
    v_and_b32 v6, 31, v0
    v_lshlrev_b32 v6, 4, v6
    ds_write_b128 v6, v[32:35] offset:17408
    ds_write_b128 v6, v[32:35] offset:22016
    s_add_u32 s11, s11, 6291456
    s_add_u32 s12, s11, 4096
    s_lshl_b32 s37, s86, 16
    s_and_b32 s38, s86, 0xffff0000
    v_lshrrev_b32 v41, 5, v2
    v_lshlrev_b32 v41, 7, v41
    v_add_u32 v41, v41, v4
    s_mul_i32 s19, s6, 9216
    v_add_u32 v41, s19, v41
    v_lshrrev_b32 v42, 5, v0
    v_mul_u32_u24 v42, 1152, v42
    v_bfe_u32 v32, v0, 1, 4
    v_lshl_add_u32 v42, v32, 4, v42
    v_and_b32 v32, 1, v0
    v_mul_u32_u24 v32, 640, v32
    v_add_u32 v42, v42, v32
    s_waitcnt vmcnt(5)
    v_mul_f32 v16, 0x3b124925, v16
    s_waitcnt vmcnt(4)
    v_mul_f32 v24, 0x3b124925, v24
    v_mul_f32 v17, 0x3b124925, v17
    v_mul_f32 v25, 0x3b124925, v25
    v_mul_f32 v18, 0x3b124925, v18
    v_mul_f32 v26, 0x3b124925, v26
    v_mul_f32 v19, 0x3b124925, v19
    v_mul_f32 v27, 0x3b124925, v27
    s_waitcnt vmcnt(3)
    v_mul_f32 v20, 0x3b124925, v20
    s_waitcnt vmcnt(2)
    v_mul_f32 v28, 0x3b124925, v28
    v_mul_f32 v21, 0x3b124925, v21
    v_mul_f32 v29, 0x3b124925, v29
    v_mul_f32 v22, 0x3b124925, v22
    v_mul_f32 v30, 0x3b124925, v30
PAD_C_2:
    s_cbranch_execz PAD_C_3
    v_mul_f32 v23, 0x3b124925, v23
    v_mul_f32 v31, 0x3b124925, v31
    v_fma_f32 v24, -v16, v16, v24
    v_max_f32 v24, 0, v24
    v_fma_f32 v25, -v17, v17, v25
    v_max_f32 v25, 0, v25
    v_fma_f32 v26, -v18, v18, v26
    v_max_f32 v26, 0, v26
    v_fma_f32 v27, -v19, v19, v27
    v_max_f32 v27, 0, v27
    v_fma_f32 v28, -v20, v20, v28
    v_max_f32 v28, 0, v28
    v_fma_f32 v29, -v21, v21, v29
    v_max_f32 v29, 0, v29
    v_fma_f32 v30, -v22, v22, v30
    v_max_f32 v30, 0, v30
    v_fma_f32 v31, -v23, v23, v31
    v_max_f32 v31, 0, v31
    v_cvt_pk_bf16_f32 v32, v16, v17
    v_lshlrev_b32 v16, 16, v32
    v_and_b32 v17, 0xffff0000, v32
    v_cvt_pk_bf16_f32 v33, v24, v25
    v_lshlrev_b32 v24, 16, v33
    v_and_b32 v25, 0xffff0000, v33
    v_cvt_pk_bf16_f32 v32, v18, v19
    v_lshlrev_b32 v18, 16, v32
    v_and_b32 v19, 0xffff0000, v32
    v_cvt_pk_bf16_f32 v33, v26, v27
    v_lshlrev_b32 v26, 16, v33
    v_and_b32 v27, 0xffff0000, v33
    v_cvt_pk_bf16_f32 v32, v20, v21
    v_lshlrev_b32 v20, 16, v32
    v_and_b32 v21, 0xffff0000, v32
    v_cvt_pk_bf16_f32 v33, v28, v29
    v_lshlrev_b32 v28, 16, v33
    v_and_b32 v29, 0xffff0000, v33
    v_cvt_pk_bf16_f32 v32, v22, v23
    v_lshlrev_b32 v22, 16, v32
    v_and_b32 v23, 0xffff0000, v32
    v_cvt_pk_bf16_f32 v33, v30, v31
    v_lshlrev_b32 v30, 16, v33
    v_and_b32 v31, 0xffff0000, v33
    v_add_f32 v24, 0x3727c5ac, v24
    v_add_f32 v25, 0x3727c5ac, v25
    v_add_f32 v26, 0x3727c5ac, v26
    v_add_f32 v27, 0x3727c5ac, v27
    v_add_f32 v28, 0x3727c5ac, v28
    v_add_f32 v29, 0x3727c5ac, v29
PAD_C_3:
    s_cbranch_execz PRET_C
    v_add_f32 v30, 0x3727c5ac, v30
    v_add_f32 v31, 0x3727c5ac, v31
    v_cvt_pk_bf16_f32 v32, v24, v25
    v_lshlrev_b32 v24, 16, v32
    v_and_b32 v25, 0xffff0000, v32
    v_cvt_pk_bf16_f32 v33, v26, v27
    v_lshlrev_b32 v26, 16, v33
    v_and_b32 v27, 0xffff0000, v33
    v_cvt_pk_bf16_f32 v32, v28, v29
    v_lshlrev_b32 v28, 16, v32
    v_and_b32 v29, 0xffff0000, v32
    v_cvt_pk_bf16_f32 v33, v30, v31
    v_lshlrev_b32 v30, 16, v33
    v_and_b32 v31, 0xffff0000, v33
    v_sqrt_f32 v24, v24
    v_sqrt_f32 v25, v25
    v_sqrt_f32 v26, v26
    v_sqrt_f32 v27, v27
    v_sqrt_f32 v28, v28
    v_sqrt_f32 v29, v29
    v_sqrt_f32 v30, v30
    v_sqrt_f32 v31, v31
    v_cvt_pk_bf16_f32 v32, v24, v25
    v_lshlrev_b32 v24, 16, v32
    v_and_b32 v25, 0xffff0000, v32
    v_cvt_pk_bf16_f32 v33, v26, v27
    v_lshlrev_b32 v26, 16, v33
    v_and_b32 v27, 0xffff0000, v33
    v_cvt_pk_bf16_f32 v32, v28, v29
    v_lshlrev_b32 v28, 16, v32
    v_and_b32 v29, 0xffff0000, v32
    v_cvt_pk_bf16_f32 v33, v30, v31
    v_lshlrev_b32 v30, 16, v33
    v_and_b32 v31, 0xffff0000, v33
    v_rcp_f32 v24, v24
    v_rcp_f32 v25, v25
    v_rcp_f32 v26, v26
    v_rcp_f32 v27, v27
    v_rcp_f32 v28, v28
    v_rcp_f32 v29, v29
    v_rcp_f32 v30, v30
    v_rcp_f32 v31, v31
    v_mul_f32 v16, -v16, v24
    v_mul_f32 v17, -v17, v25
    v_mul_f32 v18, -v18, v26
    v_mul_f32 v19, -v19, v27
    v_mul_f32 v20, -v20, v28
    v_mul_f32 v21, -v21, v29
    v_mul_f32 v22, -v22, v30
    v_mul_f32 v23, -v23, v31
    s_waitcnt vmcnt(1)
    v_lshlrev_b32 v52, 16, v8
    v_and_b32 v53, 0xffff0000, v8
PAD_C_4:
    s_cbranch_execz PAD_C_5
    v_fma_f32 v52, v52, v24, v16
    v_fma_f32 v53, v53, v25, v17
    v_cvt_pk_bf16_f32 v44, v52, v53
    v_lshlrev_b32 v54, 16, v9
    v_and_b32 v55, 0xffff0000, v9
    v_fma_f32 v54, v54, v26, v18
    v_fma_f32 v55, v55, v27, v19
    v_cvt_pk_bf16_f32 v45, v54, v55
    v_lshlrev_b32 v52, 16, v10
    v_and_b32 v53, 0xffff0000, v10
    v_fma_f32 v52, v52, v28, v20
    v_fma_f32 v53, v53, v29, v21
    v_cvt_pk_bf16_f32 v46, v52, v53
    v_lshlrev_b32 v54, 16, v11
    v_and_b32 v55, 0xffff0000, v11
    v_fma_f32 v54, v54, v30, v22
    v_fma_f32 v55, v55, v31, v23
    v_cvt_pk_bf16_f32 v47, v54, v55
    ds_write_b128 v3, v[44:47] offset:17920
    s_waitcnt vmcnt(0)
    v_lshlrev_b32 v56, 16, v12
    v_and_b32 v57, 0xffff0000, v12
    v_fma_f32 v56, v56, v24, v16
    v_fma_f32 v57, v57, v25, v17
    v_cvt_pk_bf16_f32 v48, v56, v57
    v_lshlrev_b32 v58, 16, v13
    v_and_b32 v59, 0xffff0000, v13
    v_fma_f32 v58, v58, v26, v18
    v_fma_f32 v59, v59, v27, v19
    v_cvt_pk_bf16_f32 v49, v58, v59
    v_lshlrev_b32 v56, 16, v14
    v_and_b32 v57, 0xffff0000, v14
    v_fma_f32 v56, v56, v28, v20
    v_fma_f32 v57, v57, v29, v21
    v_cvt_pk_bf16_f32 v50, v56, v57
    v_lshlrev_b32 v58, 16, v15
    v_and_b32 v59, 0xffff0000, v15
    v_fma_f32 v58, v58, v30, v22
    v_fma_f32 v59, v59, v31, v23
    v_cvt_pk_bf16_f32 v51, v58, v59
    ds_write_b128 v3, v[48:51] offset:22528
    s_waitcnt lgkmcnt(0)
    s_barrier
    ds_read2_b32 v[96:97], v39 offset0:176 offset1:177
    ds_read2_b32 v[98:99], v39 offset0:178 offset1:179
PAD_C_5:
    s_cbranch_execz PAD_C_6
    ds_read_b128 v[160:163], v40 offset:192
    ds_read_b128 v[164:167], v40 offset:704
    ds_read_b128 v[168:171], v40 offset:1216
    ds_read_b128 v[172:175], v40 offset:1728
    ds_read_b128 v[176:179], v40 offset:2240
    ds_read_b128 v[180:183], v40 offset:2752
    ds_read_b128 v[184:187], v40 offset:3264
    ds_read_b128 v[188:191], v40 offset:3776
    ds_read2_b32 v[100:101], v39 offset0:48 offset1:49
    ds_read2_b32 v[102:103], v39 offset0:50 offset1:51
    ds_read2_b32 v[104:105], v38 offset0:176 offset1:177
    ds_read2_b32 v[106:107], v38 offset0:178 offset1:179
    ds_read2_b32 v[108:109], v38 offset0:48 offset1:49
    ds_read2_b32 v[110:111], v38 offset0:50 offset1:51
    ds_read2_b32 v[112:113], v37 offset0:176 offset1:177
    ds_read2_b32 v[114:115], v37 offset0:178 offset1:179
    ds_read2_b32 v[116:117], v37 offset0:48 offset1:49
    ds_read2_b32 v[118:119], v37 offset0:50 offset1:51
    ds_read2_b32 v[120:121], v36 offset0:176 offset1:177
    ds_read2_b32 v[122:123], v36 offset0:178 offset1:179
    ds_read2_b32 v[124:125], v36 offset0:48 offset1:49
    ds_read2_b32 v[126:127], v36 offset0:50 offset1:51
    s_waitcnt lgkmcnt(15)
    v_mfma_f32_16x16x32_bf16 v[64:67], v[96:99], v[160:163], 0
    ds_read2_b32 v[128:129], v39 offset0:160 offset1:161
    v_mfma_f32_16x16x32_bf16 v[68:71], v[96:99], v[164:167], 0
    ds_read2_b32 v[130:131], v39 offset0:162 offset1:163
    v_mfma_f32_16x16x32_bf16 v[72:75], v[96:99], v[168:171], 0
    ds_read_b128 v[192:195], v40 offset:128
    v_mfma_f32_16x16x32_bf16 v[76:79], v[96:99], v[172:175], 0
    ds_read_b128 v[196:199], v40 offset:640
    v_mfma_f32_16x16x32_bf16 v[80:83], v[96:99], v[176:179], 0
    ds_read_b128 v[200:203], v40 offset:1152
    v_mfma_f32_16x16x32_bf16 v[84:87], v[96:99], v[180:183], 0
    ds_read_b128 v[204:207], v40 offset:1664
    v_mfma_f32_16x16x32_bf16 v[88:91], v[96:99], v[184:187], 0
    ds_read_b128 v[208:211], v40 offset:2176
    s_waitcnt lgkmcnt(15)
    v_mfma_f32_16x16x32_bf16 v[92:95], v[96:99], v[188:191], 0
    ds_read_b128 v[212:215], v40 offset:2688
    v_mfma_f32_16x16x32_bf16 v[68:71], v[100:103], v[160:163], v[68:71]
PAD_C_6:
    s_cbranch_execz PAD_C_7
    ds_read_b128 v[216:219], v40 offset:3200
    v_mfma_f32_16x16x32_bf16 v[72:75], v[100:103], v[164:167], v[72:75]
    ds_read_b128 v[220:223], v40 offset:3712
    v_mfma_f32_16x16x32_bf16 v[76:79], v[100:103], v[168:171], v[76:79]
    ds_read2_b32 v[132:133], v39 offset0:32 offset1:33
    v_mfma_f32_16x16x32_bf16 v[80:83], v[100:103], v[172:175], v[80:83]
    ds_read2_b32 v[134:135], v39 offset0:34 offset1:35
    v_mfma_f32_16x16x32_bf16 v[84:87], v[100:103], v[176:179], v[84:87]
    ds_read2_b32 v[136:137], v38 offset0:160 offset1:161
    v_mfma_f32_16x16x32_bf16 v[88:91], v[100:103], v[180:183], v[88:91]
    ds_read2_b32 v[138:139], v38 offset0:162 offset1:163
    v_mfma_f32_16x16x32_bf16 v[92:95], v[100:103], v[184:187], v[92:95]
    ds_read2_b32 v[140:141], v38 offset0:32 offset1:33
    v_mfma_f32_16x16x32_bf16 v[72:75], v[104:107], v[160:163], v[72:75]
    ds_read2_b32 v[142:143], v38 offset0:34 offset1:35
    v_mfma_f32_16x16x32_bf16 v[76:79], v[104:107], v[164:167], v[76:79]
    ds_read2_b32 v[144:145], v37 offset0:160 offset1:161
    v_mfma_f32_16x16x32_bf16 v[80:83], v[104:107], v[168:171], v[80:83]
    ds_read2_b32 v[146:147], v37 offset0:162 offset1:163
    v_mfma_f32_16x16x32_bf16 v[84:87], v[104:107], v[172:175], v[84:87]
    ds_read2_b32 v[148:149], v37 offset0:32 offset1:33
    v_mfma_f32_16x16x32_bf16 v[88:91], v[104:107], v[176:179], v[88:91]
    ds_read2_b32 v[150:151], v37 offset0:34 offset1:35
    v_mfma_f32_16x16x32_bf16 v[92:95], v[104:107], v[180:183], v[92:95]
    ds_read2_b32 v[152:153], v36 offset0:160 offset1:161
    v_mfma_f32_16x16x32_bf16 v[76:79], v[108:111], v[160:163], v[76:79]
    ds_read2_b32 v[154:155], v36 offset0:162 offset1:163
    v_mfma_f32_16x16x32_bf16 v[80:83], v[108:111], v[164:167], v[80:83]
    ds_read2_b32 v[156:157], v36 offset0:32 offset1:33
    v_mfma_f32_16x16x32_bf16 v[84:87], v[108:111], v[168:171], v[84:87]
    ds_read2_b32 v[158:159], v36 offset0:34 offset1:35
    v_mfma_f32_16x16x32_bf16 v[88:91], v[108:111], v[172:175], v[88:91]
    s_add_u32 m0, s100, 66560
    s_add_u32 s18, s99, 0
    buffer_load_dwordx4 v4, s[20:23], s18 offen lds
    v_mfma_f32_16x16x32_bf16 v[92:95], v[108:111], v[176:179], v[92:95]
    v_lshlrev_b32 v52, 16, v44
    v_and_b32 v53, 0xffff0000, v44
    s_waitcnt lgkmcnt(15)
PAD_C_7:
    s_cbranch_execz PRET_C
    v_mfma_f32_16x16x32_bf16 v[80:83], v[112:115], v[160:163], v[80:83]
    s_add_u32 m0, s100, 70656
    s_add_u32 s18, s99, 28672
    buffer_load_dwordx4 v4, s[20:23], s18 offen lds
    v_mfma_f32_16x16x32_bf16 v[84:87], v[112:115], v[164:167], v[84:87]
    v_lshlrev_b32 v16, 16, v8
    v_and_b32 v17, 0xffff0000, v8
    v_mfma_f32_16x16x32_bf16 v[88:91], v[112:115], v[168:171], v[88:91]
    s_add_u32 m0, s100, 74752
    s_add_u32 s18, s99, 57344
    buffer_load_dwordx4 v4, s[20:23], s18 offen lds
    v_mfma_f32_16x16x32_bf16 v[92:95], v[112:115], v[172:175], v[92:95]
    v_fma_f32 v16, v52, s37, v16
    v_fma_f32 v17, v53, s37, v17
    v_mfma_f32_16x16x32_bf16 v[84:87], v[116:119], v[160:163], v[84:87]
    s_add_u32 m0, s100, 78848
    s_add_u32 s18, s99, 4096
    buffer_load_dwordx4 v4, s[20:23], s18 offen lds
    v_mfma_f32_16x16x32_bf16 v[88:91], v[116:119], v[164:167], v[88:91]
    v_lshlrev_b32 v54, 16, v45
    v_and_b32 v55, 0xffff0000, v45
    v_mfma_f32_16x16x32_bf16 v[92:95], v[116:119], v[168:171], v[92:95]
    s_add_u32 m0, s100, 82944
    s_add_u32 s18, s99, 32768
    buffer_load_dwordx4 v4, s[20:23], s18 offen lds
    v_mfma_f32_16x16x32_bf16 v[88:91], v[120:123], v[160:163], v[88:91]
    v_lshlrev_b32 v18, 16, v9
    v_and_b32 v19, 0xffff0000, v9
    v_mfma_f32_16x16x32_bf16 v[92:95], v[120:123], v[164:167], v[92:95]
    s_add_u32 m0, s100, 87040
    s_add_u32 s18, s99, 61440
    buffer_load_dwordx4 v4, s[20:23], s18 offen lds
    v_mfma_f32_16x16x32_bf16 v[92:95], v[124:127], v[160:163], v[92:95]
    v_fma_f32 v18, v54, s37, v18
    v_fma_f32 v19, v55, s37, v19
    v_mfma_f32_16x16x32_bf16 v[64:67], v[128:131], v[192:195], v[64:67]
    ds_read2_b32 v[96:97], v39 offset0:144 offset1:145
    v_mfma_f32_16x16x32_bf16 v[68:71], v[128:131], v[196:199], v[68:71]
    ds_read2_b32 v[98:99], v39 offset0:146 offset1:147
    v_mfma_f32_16x16x32_bf16 v[72:75], v[128:131], v[200:203], v[72:75]
    ds_read_b128 v[160:163], v40 offset:64
PAD_C_8:
    s_cbranch_execz PAD_C_9
    v_mfma_f32_16x16x32_bf16 v[76:79], v[128:131], v[204:207], v[76:79]
    ds_read_b128 v[164:167], v40 offset:576
    v_mfma_f32_16x16x32_bf16 v[80:83], v[128:131], v[208:211], v[80:83]
    ds_read_b128 v[168:171], v40 offset:1088
    v_mfma_f32_16x16x32_bf16 v[84:87], v[128:131], v[212:215], v[84:87]
    ds_read_b128 v[172:175], v40 offset:1600
    v_mfma_f32_16x16x32_bf16 v[88:91], v[128:131], v[216:219], v[88:91]
    ds_read_b128 v[176:179], v40 offset:2112
    s_waitcnt lgkmcnt(15)
    v_mfma_f32_16x16x32_bf16 v[92:95], v[128:131], v[220:223], v[92:95]
    ds_read_b128 v[180:183], v40 offset:2624
    v_mfma_f32_16x16x32_bf16 v[68:71], v[132:135], v[192:195], v[68:71]
    ds_read_b128 v[184:187], v40 offset:3136
    v_mfma_f32_16x16x32_bf16 v[72:75], v[132:135], v[196:199], v[72:75]
    ds_read_b128 v[188:191], v40 offset:3648
    v_mfma_f32_16x16x32_bf16 v[76:79], v[132:135], v[200:203], v[76:79]
    ds_read2_b32 v[100:101], v39 offset0:16 offset1:17
    v_mfma_f32_16x16x32_bf16 v[80:83], v[132:135], v[204:207], v[80:83]
    ds_read2_b32 v[102:103], v39 offset0:18 offset1:19
    v_mfma_f32_16x16x32_bf16 v[84:87], v[132:135], v[208:211], v[84:87]
    ds_read2_b32 v[104:105], v38 offset0:144 offset1:145
    v_mfma_f32_16x16x32_bf16 v[88:91], v[132:135], v[212:215], v[88:91]
    ds_read2_b32 v[106:107], v38 offset0:146 offset1:147
    v_mfma_f32_16x16x32_bf16 v[92:95], v[132:135], v[216:219], v[92:95]
    ds_read2_b32 v[108:109], v38 offset0:16 offset1:17
    v_mfma_f32_16x16x32_bf16 v[72:75], v[136:139], v[192:195], v[72:75]
    ds_read2_b32 v[110:111], v38 offset0:18 offset1:19
    v_mfma_f32_16x16x32_bf16 v[76:79], v[136:139], v[196:199], v[76:79]
    ds_read2_b32 v[112:113], v37 offset0:144 offset1:145
    v_mfma_f32_16x16x32_bf16 v[80:83], v[136:139], v[200:203], v[80:83]
    ds_read2_b32 v[114:115], v37 offset0:146 offset1:147
    v_mfma_f32_16x16x32_bf16 v[84:87], v[136:139], v[204:207], v[84:87]
    ds_read2_b32 v[116:117], v37 offset0:16 offset1:17
    v_mfma_f32_16x16x32_bf16 v[88:91], v[136:139], v[208:211], v[88:91]
    ds_read2_b32 v[118:119], v37 offset0:18 offset1:19
    v_mfma_f32_16x16x32_bf16 v[92:95], v[136:139], v[212:215], v[92:95]
    ds_read2_b32 v[120:121], v36 offset0:144 offset1:145
    v_mfma_f32_16x16x32_bf16 v[76:79], v[140:143], v[192:195], v[76:79]
    ds_read2_b32 v[122:123], v36 offset0:146 offset1:147
    v_mfma_f32_16x16x32_bf16 v[80:83], v[140:143], v[196:199], v[80:83]
PAD_C_9:
    s_cbranch_execz PAD_C_10
    ds_read2_b32 v[124:125], v36 offset0:16 offset1:17
    v_mfma_f32_16x16x32_bf16 v[84:87], v[140:143], v[200:203], v[84:87]
    ds_read2_b32 v[126:127], v36 offset0:18 offset1:19
    v_mfma_f32_16x16x32_bf16 v[88:91], v[140:143], v[204:207], v[88:91]
    s_add_u32 m0, s100, 91136
    s_add_u32 s18, s99, 8192
    buffer_load_dwordx4 v4, s[20:23], s18 offen lds
    v_mfma_f32_16x16x32_bf16 v[92:95], v[140:143], v[208:211], v[92:95]
    v_lshlrev_b32 v56, 16, v46
    v_and_b32 v57, 0xffff0000, v46
    s_waitcnt lgkmcnt(15)
    v_mfma_f32_16x16x32_bf16 v[80:83], v[144:147], v[192:195], v[80:83]
    s_add_u32 m0, s100, 95232
    s_add_u32 s18, s99, 36864
    buffer_load_dwordx4 v4, s[20:23], s18 offen lds
    v_mfma_f32_16x16x32_bf16 v[84:87], v[144:147], v[196:199], v[84:87]
    v_lshlrev_b32 v20, 16, v10
    v_and_b32 v21, 0xffff0000, v10
    v_mfma_f32_16x16x32_bf16 v[88:91], v[144:147], v[200:203], v[88:91]
    s_add_u32 m0, s100, 99328
    s_add_u32 s18, s99, 65536
    buffer_load_dwordx4 v4, s[20:23], s18 offen lds
    v_mfma_f32_16x16x32_bf16 v[92:95], v[144:147], v[204:207], v[92:95]
    v_fma_f32 v20, v56, s37, v20
    v_fma_f32 v21, v57, s37, v21
    v_mfma_f32_16x16x32_bf16 v[84:87], v[148:151], v[192:195], v[84:87]
    s_add_u32 m0, s100, 103424
    s_add_u32 s18, s99, 12288
    buffer_load_dwordx4 v4, s[20:23], s18 offen lds
    v_mfma_f32_16x16x32_bf16 v[88:91], v[148:151], v[196:199], v[88:91]
    v_lshlrev_b32 v58, 16, v47
    v_and_b32 v59, 0xffff0000, v47
    v_mfma_f32_16x16x32_bf16 v[92:95], v[148:151], v[200:203], v[92:95]
    s_add_u32 m0, s100, 107520
    s_add_u32 s18, s99, 40960
    buffer_load_dwordx4 v4, s[20:23], s18 offen lds
    v_mfma_f32_16x16x32_bf16 v[88:91], v[152:155], v[192:195], v[88:91]
    v_lshlrev_b32 v22, 16, v11
    v_and_b32 v23, 0xffff0000, v11
PAD_C_10:
    s_cbranch_execz PAD_C_11
    v_mfma_f32_16x16x32_bf16 v[92:95], v[152:155], v[196:199], v[92:95]
    s_add_u32 m0, s100, 111616
    s_add_u32 s18, s99, 69632
    buffer_load_dwordx4 v4, s[20:23], s18 offen lds
    v_mfma_f32_16x16x32_bf16 v[92:95], v[156:159], v[192:195], v[92:95]
    v_fma_f32 v22, v58, s37, v22
    v_fma_f32 v23, v59, s37, v23
    v_mfma_f32_16x16x32_bf16 v[64:67], v[96:99], v[160:163], v[64:67]
    ds_read2_b32 v[128:129], v39 offset0:128 offset1:129
    v_mfma_f32_16x16x32_bf16 v[68:71], v[96:99], v[164:167], v[68:71]
    ds_read2_b32 v[130:131], v39 offset0:130 offset1:131
    v_mfma_f32_16x16x32_bf16 v[72:75], v[96:99], v[168:171], v[72:75]
    ds_read_b128 v[192:195], v40 offset:0
    v_mfma_f32_16x16x32_bf16 v[76:79], v[96:99], v[172:175], v[76:79]
    ds_read_b128 v[196:199], v40 offset:512
    v_mfma_f32_16x16x32_bf16 v[80:83], v[96:99], v[176:179], v[80:83]
    ds_read_b128 v[200:203], v40 offset:1024
    v_mfma_f32_16x16x32_bf16 v[84:87], v[96:99], v[180:183], v[84:87]
    ds_read_b128 v[204:207], v40 offset:1536
    v_mfma_f32_16x16x32_bf16 v[88:91], v[96:99], v[184:187], v[88:91]
    ds_read_b128 v[208:211], v40 offset:2048
    s_waitcnt lgkmcnt(15)
    v_mfma_f32_16x16x32_bf16 v[92:95], v[96:99], v[188:191], v[92:95]
    ds_read_b128 v[212:215], v40 offset:2560
    v_mfma_f32_16x16x32_bf16 v[68:71], v[100:103], v[160:163], v[68:71]
    ds_read_b128 v[216:219], v40 offset:3072
    v_mfma_f32_16x16x32_bf16 v[72:75], v[100:103], v[164:167], v[72:75]
    ds_read_b128 v[220:223], v40 offset:3584
    v_mfma_f32_16x16x32_bf16 v[76:79], v[100:103], v[168:171], v[76:79]
    ds_read2_b32 v[132:133], v39 offset0:0 offset1:1
    v_mfma_f32_16x16x32_bf16 v[80:83], v[100:103], v[172:175], v[80:83]
    ds_read2_b32 v[134:135], v39 offset0:2 offset1:3
    v_mfma_f32_16x16x32_bf16 v[84:87], v[100:103], v[176:179], v[84:87]
    ds_read2_b32 v[136:137], v38 offset0:128 offset1:129
    v_mfma_f32_16x16x32_bf16 v[88:91], v[100:103], v[180:183], v[88:91]
    ds_read2_b32 v[138:139], v38 offset0:130 offset1:131
    v_mfma_f32_16x16x32_bf16 v[92:95], v[100:103], v[184:187], v[92:95]
    ds_read2_b32 v[140:141], v38 offset0:0 offset1:1
    v_mfma_f32_16x16x32_bf16 v[72:75], v[104:107], v[160:163], v[72:75]
    ds_read2_b32 v[142:143], v38 offset0:2 offset1:3
PAD_C_11:
    s_cbranch_execz PRET_C
    v_mfma_f32_16x16x32_bf16 v[76:79], v[104:107], v[164:167], v[76:79]
    ds_read2_b32 v[144:145], v37 offset0:128 offset1:129
    v_mfma_f32_16x16x32_bf16 v[80:83], v[104:107], v[168:171], v[80:83]
    ds_read2_b32 v[146:147], v37 offset0:130 offset1:131
    v_mfma_f32_16x16x32_bf16 v[84:87], v[104:107], v[172:175], v[84:87]
    ds_read2_b32 v[148:149], v37 offset0:0 offset1:1
    v_mfma_f32_16x16x32_bf16 v[88:91], v[104:107], v[176:179], v[88:91]
    ds_read2_b32 v[150:151], v37 offset0:2 offset1:3
    v_mfma_f32_16x16x32_bf16 v[92:95], v[104:107], v[180:183], v[92:95]
    ds_read2_b32 v[152:153], v36 offset0:128 offset1:129
    v_mfma_f32_16x16x32_bf16 v[76:79], v[108:111], v[160:163], v[76:79]
    ds_read2_b32 v[154:155], v36 offset0:130 offset1:131
    v_mfma_f32_16x16x32_bf16 v[80:83], v[108:111], v[164:167], v[80:83]
    ds_read2_b32 v[156:157], v36 offset0:0 offset1:1
    v_mfma_f32_16x16x32_bf16 v[84:87], v[108:111], v[168:171], v[84:87]
    ds_read2_b32 v[158:159], v36 offset0:2 offset1:3
    v_mfma_f32_16x16x32_bf16 v[88:91], v[108:111], v[172:175], v[88:91]
    s_add_u32 m0, s100, 115712
    s_add_u32 s18, s99, 16384
    buffer_load_dwordx4 v4, s[20:23], s18 offen lds
    v_mfma_f32_16x16x32_bf16 v[92:95], v[108:111], v[176:179], v[92:95]
    v_lshlrev_b32 v52, 16, v48
    v_and_b32 v53, 0xffff0000, v48
    s_waitcnt lgkmcnt(15)
    v_mfma_f32_16x16x32_bf16 v[80:83], v[112:115], v[160:163], v[80:83]
    s_add_u32 m0, s100, 119808
    s_add_u32 s18, s99, 45056
    buffer_load_dwordx4 v4, s[20:23], s18 offen lds
    v_mfma_f32_16x16x32_bf16 v[84:87], v[112:115], v[164:167], v[84:87]
    v_lshlrev_b32 v24, 16, v12
    v_and_b32 v25, 0xffff0000, v12
    v_mfma_f32_16x16x32_bf16 v[88:91], v[112:115], v[168:171], v[88:91]
    s_add_u32 m0, s100, 123904
    s_add_u32 s18, s99, 73728
    buffer_load_dwordx4 v4, s[20:23], s18 offen lds
    v_mfma_f32_16x16x32_bf16 v[92:95], v[112:115], v[172:175], v[92:95]
    v_fma_f32 v24, v52, s38, v24
    v_fma_f32 v25, v53, s38, v25
PAD_C_12:
    s_cbranch_execz PAD_C_13
    v_mfma_f32_16x16x32_bf16 v[84:87], v[116:119], v[160:163], v[84:87]
    s_add_u32 m0, s100, 128000
    s_add_u32 s18, s99, 20480
    buffer_load_dwordx4 v4, s[20:23], s18 offen lds
    v_mfma_f32_16x16x32_bf16 v[88:91], v[116:119], v[164:167], v[88:91]
    v_lshlrev_b32 v54, 16, v49
    v_and_b32 v55, 0xffff0000, v49
    v_mfma_f32_16x16x32_bf16 v[92:95], v[116:119], v[168:171], v[92:95]
    s_add_u32 m0, s100, 132096
    s_add_u32 s18, s99, 49152
    buffer_load_dwordx4 v4, s[20:23], s18 offen lds
    v_mfma_f32_16x16x32_bf16 v[88:91], v[120:123], v[160:163], v[88:91]
    v_lshlrev_b32 v26, 16, v13
    v_and_b32 v27, 0xffff0000, v13
    v_mfma_f32_16x16x32_bf16 v[92:95], v[120:123], v[164:167], v[92:95]
    s_add_u32 m0, s100, 136192
    s_add_u32 s18, s99, 77824
    buffer_load_dwordx4 v4, s[20:23], s18 offen lds
    v_mfma_f32_16x16x32_bf16 v[92:95], v[124:127], v[160:163], v[92:95]
    v_fma_f32 v26, v54, s38, v26
    v_fma_f32 v27, v55, s38, v27
    v_mfma_f32_16x16x32_bf16 v[64:67], v[128:131], v[192:195], v[64:67]
    s_add_u32 m0, s100, 140288
    s_add_u32 s18, s99, 24576
    buffer_load_dwordx4 v4, s[20:23], s18 offen lds
    v_mfma_f32_16x16x32_bf16 v[68:71], v[128:131], v[196:199], v[68:71]
    v_lshlrev_b32 v56, 16, v50
    v_and_b32 v57, 0xffff0000, v50
    v_mfma_f32_16x16x32_bf16 v[72:75], v[128:131], v[200:203], v[72:75]
    s_add_u32 m0, s100, 144384
    s_add_u32 s18, s99, 53248
    buffer_load_dwordx4 v4, s[20:23], s18 offen lds
    v_mfma_f32_16x16x32_bf16 v[76:79], v[128:131], v[204:207], v[76:79]
    ds_write_b128 v41, v[64:67] offset:26624
    v_mfma_f32_16x16x32_bf16 v[80:83], v[128:131], v[208:211], v[80:83]
    s_add_u32 m0, s100, 148480
    s_add_u32 s18, s99, 81920
    buffer_load_dwordx4 v4, s[20:23], s18 offen lds
    v_mfma_f32_16x16x32_bf16 v[84:87], v[128:131], v[212:215], v[84:87]
    v_lshlrev_b32 v28, 16, v14
    v_and_b32 v29, 0xffff0000, v14
PAD_C_13:
    s_cbranch_execz PAD_C_14
    v_mfma_f32_16x16x32_bf16 v[88:91], v[128:131], v[216:219], v[88:91]
    s_add_u32 m0, s100, 152576
    s_add_u32 s18, s99, 86016
    buffer_load_dwordx4 v4, s[20:23], s18 offen lds
    s_waitcnt lgkmcnt(15)
    v_mfma_f32_16x16x32_bf16 v[92:95], v[128:131], v[220:223], v[92:95]
    v_fma_f32 v28, v56, s38, v28
    v_fma_f32 v29, v57, s38, v29
    s_waitcnt lgkmcnt(13)
    v_mfma_f32_16x16x32_bf16 v[68:71], v[132:135], v[192:195], v[68:71]
    s_add_u32 m0, s100, 156672
    s_add_u32 s18, s99, 90112
    buffer_load_dwordx4 v4, s[20:23], s18 offen lds
    v_mfma_f32_16x16x32_bf16 v[72:75], v[132:135], v[196:199], v[72:75]
    v_lshlrev_b32 v58, 16, v51
    v_and_b32 v59, 0xffff0000, v51
    v_mfma_f32_16x16x32_bf16 v[76:79], v[132:135], v[200:203], v[76:79]
    s_nop 0
    ds_write_b128 v41, v[68:71] offset:27776
    v_mfma_f32_16x16x32_bf16 v[80:83], v[132:135], v[204:207], v[80:83]
    v_lshlrev_b32 v30, 16, v15
    v_and_b32 v31, 0xffff0000, v15
    v_mfma_f32_16x16x32_bf16 v[84:87], v[132:135], v[208:211], v[84:87]
    v_fma_f32 v30, v58, s38, v30
    v_fma_f32 v31, v59, s38, v31
    v_mfma_f32_16x16x32_bf16 v[88:91], v[132:135], v[212:215], v[88:91]
    v_mfma_f32_16x16x32_bf16 v[92:95], v[132:135], v[216:219], v[92:95]
    s_waitcnt lgkmcnt(12)
    v_mfma_f32_16x16x32_bf16 v[72:75], v[136:139], v[192:195], v[72:75]
    v_mfma_f32_16x16x32_bf16 v[76:79], v[136:139], v[196:199], v[76:79]
    v_mfma_f32_16x16x32_bf16 v[80:83], v[136:139], v[200:203], v[80:83]
    s_nop 5
    ds_write_b128 v41, v[72:75] offset:28928
    v_mfma_f32_16x16x32_bf16 v[84:87], v[136:139], v[204:207], v[84:87]
    v_mfma_f32_16x16x32_bf16 v[88:91], v[136:139], v[208:211], v[88:91]
    v_mfma_f32_16x16x32_bf16 v[92:95], v[136:139], v[212:215], v[92:95]
    s_waitcnt lgkmcnt(11)
    v_mfma_f32_16x16x32_bf16 v[76:79], v[140:143], v[192:195], v[76:79]
    v_mfma_f32_16x16x32_bf16 v[80:83], v[140:143], v[196:199], v[80:83]
    v_mfma_f32_16x16x32_bf16 v[84:87], v[140:143], v[200:203], v[84:87]
    s_nop 5
    ds_write_b128 v41, v[76:79] offset:30080
    v_mfma_f32_16x16x32_bf16 v[88:91], v[140:143], v[204:207], v[88:91]
    v_mfma_f32_16x16x32_bf16 v[92:95], v[140:143], v[208:211], v[92:95]
    s_waitcnt lgkmcnt(10)
PAD_C_14:
    s_cbranch_execz PAD_C_15
    v_mfma_f32_16x16x32_bf16 v[80:83], v[144:147], v[192:195], v[80:83]
    v_mfma_f32_16x16x32_bf16 v[84:87], v[144:147], v[196:199], v[84:87]
    v_mfma_f32_16x16x32_bf16 v[88:91], v[144:147], v[200:203], v[88:91]
    s_nop 5
    ds_write_b128 v41, v[80:83] offset:31232
    v_mfma_f32_16x16x32_bf16 v[92:95], v[144:147], v[204:207], v[92:95]
    s_waitcnt lgkmcnt(9)
    v_mfma_f32_16x16x32_bf16 v[84:87], v[148:151], v[192:195], v[84:87]
    v_mfma_f32_16x16x32_bf16 v[88:91], v[148:151], v[196:199], v[88:91]
    v_mfma_f32_16x16x32_bf16 v[92:95], v[148:151], v[200:203], v[92:95]
    s_nop 5
    ds_write_b128 v41, v[84:87] offset:32384
    s_waitcnt lgkmcnt(8)
    v_mfma_f32_16x16x32_bf16 v[88:91], v[152:155], v[192:195], v[88:91]
    v_mfma_f32_16x16x32_bf16 v[92:95], v[152:155], v[196:199], v[92:95]
    s_waitcnt lgkmcnt(6)
    v_mfma_f32_16x16x32_bf16 v[92:95], v[156:159], v[192:195], v[92:95]
    s_nop 4
    ds_write_b128 v41, v[88:91] offset:33536
    s_nop 1
    ds_write_b128 v41, v[92:95] offset:34688
    s_waitcnt lgkmcnt(0)
    s_barrier
    ds_read_b128 v[96:99], v42 offset:26624
    ds_read_b128 v[100:103], v42 offset:26880
    ds_read_b128 v[104:107], v42 offset:45056
    ds_read_b128 v[108:111], v42 offset:45312
    ds_read_b128 v[112:115], v42 offset:35840
    ds_read_b128 v[116:119], v42 offset:36096
    ds_read_b128 v[120:123], v42 offset:54272
    ds_read_b128 v[124:127], v42 offset:54528
    s_waitcnt lgkmcnt(5)
    v_pk_add_f32 v[96:97], v[96:97], v[104:105]
    v_pk_add_f32 v[98:99], v[98:99], v[106:107]
    s_waitcnt lgkmcnt(4)
    v_pk_add_f32 v[100:101], v[100:101], v[108:109]
    v_pk_add_f32 v[102:103], v[102:103], v[110:111]
    v_pk_add_f32 v[96:97], v[96:97], v[16:17]
    v_pk_add_f32 v[98:99], v[98:99], v[18:19]
    v_pk_add_f32 v[100:101], v[100:101], v[20:21]
    v_pk_add_f32 v[102:103], v[102:103], v[22:23]
    v_cvt_pk_bf16_f32 v128, v96, v97
    v_cvt_pk_bf16_f32 v129, v98, v99
    v_cvt_pk_bf16_f32 v130, v100, v101
    v_cvt_pk_bf16_f32 v131, v102, v103
PAD_C_15:
    s_cbranch_execz PRET_C
    buffer_store_dwordx4 v[128:131], v3, s[20:23], s11 offen sc1
    s_waitcnt lgkmcnt(1)
    v_pk_add_f32 v[112:113], v[112:113], v[120:121]
    v_pk_add_f32 v[114:115], v[114:115], v[122:123]
    s_waitcnt lgkmcnt(0)
    v_pk_add_f32 v[116:117], v[116:117], v[124:125]
    v_pk_add_f32 v[118:119], v[118:119], v[126:127]
    v_pk_add_f32 v[112:113], v[112:113], v[24:25]
    v_pk_add_f32 v[114:115], v[114:115], v[26:27]
    v_pk_add_f32 v[116:117], v[116:117], v[28:29]
    v_pk_add_f32 v[118:119], v[118:119], v[30:31]
    v_cvt_pk_bf16_f32 v132, v112, v113
    v_cvt_pk_bf16_f32 v133, v114, v115
    v_cvt_pk_bf16_f32 v134, v116, v117
    v_cvt_pk_bf16_f32 v135, v118, v119
    buffer_store_dwordx4 v[132:135], v3, s[20:23], s12 offen sc1
    v_lshrrev_b32 v5, 2, v2
    v_lshlrev_b32 v5, 12, v5
    v_and_b32 v6, 3, v2
    v_lshl_add_u32 v3, v6, 4, v5
    v_lshlrev_b32 v4, 4, v2
    v_lshrrev_b32 v16, 5, v2
    v_lshlrev_b32 v16, 3, v16
    v_bfe_u32 v17, v2, 2, 2
    v_add_u32 v16, v16, v17
    v_lshlrev_b32 v16, 6, v16
    v_bfe_u32 v17, v2, 4, 1
    v_lshl_add_u32 v16, v17, 5, v16
    v_lshl_add_u32 v16, v6, 3, v16
    s_add_u32 s12, s100, 17408
    v_add_u32 v12, s12, v16
    v_add_u32 v8, 17408, v4
    v_add_u32 v9, 82944, v4
    v_add_u32 v10, 148480, v4
    s_mov_b32 s60, -1
    s_mov_b32 s61, 0
    v_mov_b32 v241, 0
    v_mov_b32 v242, 0
    v_mov_b32 v243, 0
    v_mov_b32 v16, 0x3f803f80
    v_mov_b32 v17, 0
    v_mov_b32 v13, 0
    v_mov_b32 v18, 0
    v_mov_b32 v14, 0
    s_lshl_b32 s13, s96, 8
    s_lshl_b32 s12, s6, 6
    s_add_u32 s13, s13, s12
    s_add_u32 s13, s13, 6291456
    s_mov_b32 vcc_lo, 0x10100101
    s_mov_b32 vcc_hi, 0x10100101
    v_cndmask_b32 v16, 0, v16, vcc
    v_accvgpr_write_b32 a240, v16
PAD_C_16:
    s_cbranch_execz PAD_C_17
    v_accvgpr_write_b32 a241, v16
    v_accvgpr_write_b32 a242, v16
    v_accvgpr_write_b32 a243, v16
    s_lshl_b32 s19, s96, 2
    s_add_u32 s19, s19, s6
    s_mul_i32 s19, s19, 114688
    s_mul_i32 s24, s97, 7168
    s_add_u32 s19, s19, s24
    s_add_u32 s19, s19, 25165824
    s_and_b32 s11, s6, 1
    s_lshr_b32 s12, s6, 1
    s_lshl_b32 s40, s94, 1
    s_add_u32 s40, s40, s11
    s_lshl_b32 s41, s95, 1
    s_add_u32 s41, s41, s12
    s_lshl_b32 s42, s41, 17
    s_lshl_b32 s43, s40, 6
    s_add_u32 s42, s42, s43
    s_add_u32 s43, s42, 6291456
    s_xor_b32 s45, s40, 1
    s_mul_i32 s44, s40, 114688
    s_mul_i32 s45, s45, 114688
    s_mul_i32 s46, s6, 28672
    s_add_u32 s46, s46, 25165824
    s_add_u32 s32, s44, s46
    s_add_u32 s56, s45, s46
    s_lshl_b32 s47, s6, 11
    s_add_u32 s47, s47, 152576
    v_add_u32 v22, 4096, v4
    s_add_u32 s33, s32, 7168
    s_add_u32 s57, s56, 7168
    s_add_u32 s34, s32, 14336
    s_add_u32 s58, s56, 14336
    s_add_u32 s35, s32, 21504
    s_add_u32 s59, s56, 21504
    s_waitcnt vmcnt(0)
    s_barrier
    s_cmp_lg_u32 s6, 0
    s_cbranch_scc1 SKIP_105
    s_add_u32 s92, s88, 5
    v_mov_b32 v253, s92
    v_lshlrev_b32 v252, 10, v2
    buffer_store_dword v253, v252, s[20:23], s89 offen sc1
    s_mov_b64 exec, -1
    s_add_u32 s3, s88, 5
PAD_C_17:
    s_cbranch_execz PAD_C_18
    s_mov_b32 s92, 30000
POLL_107:
    buffer_load_dwordx4 v[248:251], v254, s[20:23], s90 offen sc1
    s_waitcnt vmcnt(0)
    v_subrev_u32 v248, s3, v248
    v_subrev_u32 v249, s3, v249
    v_subrev_u32 v250, s3, v250
    v_subrev_u32 v251, s3, v251
    v_max3_u32 v248, v248, v249, v250
    v_max_u32 v248, v248, v251
    v_cmp_lt_u32 vcc, 7, v248
    s_and_b64 exec, vcc, exec
    s_cbranch_scc0 PDONE_108
    s_sub_u32 s92, s92, 1
    s_cmp_lg_u32 s92, 0
    s_cbranch_scc1 POLL_107
PDONE_108:
    s_mov_b64 exec, -1
SKIP_105:
    s_barrier
    s_branch L_GLU2
L_SPARE1:
    s_waitcnt vmcnt(0) lgkmcnt(0)
    s_nop 15
    v_mul_f32 v208, v208, v20
    v_mul_f32 v209, v209, v20
    v_mul_f32 v210, v210, v20
    v_mul_f32 v211, v211, v20
    v_mul_f32 v212, v212, v20
    v_mul_f32 v213, v213, v20
    v_mul_f32 v214, v214, v20
    v_mul_f32 v215, v215, v20
    v_exp_f32 v208, v208
    v_exp_f32 v209, v209
    v_exp_f32 v210, v210
    v_exp_f32 v211, v211
    v_exp_f32 v212, v212
    v_exp_f32 v213, v213
    v_exp_f32 v214, v214
    v_exp_f32 v215, v215
    v_fma_f32 v208, v208, v21, v21
    v_fma_f32 v209, v209, v21, v21
    v_fma_f32 v210, v210, v21, v21
    v_fma_f32 v211, v211, v21, v21
    v_fma_f32 v212, v212, v21, v21
    v_fma_f32 v213, v213, v21, v21
    v_fma_f32 v214, v214, v21, v21
    v_fma_f32 v215, v215, v21, v21
    v_rcp_f32 v208, v208
    v_rcp_f32 v209, v209
    v_rcp_f32 v210, v210
    v_rcp_f32 v211, v211
    v_rcp_f32 v212, v212
    v_rcp_f32 v213, v213
    v_rcp_f32 v214, v214
    v_rcp_f32 v215, v215
    v_mul_f32 v216, v216, v208
    v_mul_f32 v217, v217, v209
    v_mul_f32 v218, v218, v210
    v_mul_f32 v219, v219, v211
    v_mul_f32 v220, v220, v212
    v_mul_f32 v221, v221, v213
    v_mul_f32 v222, v222, v214
    v_mul_f32 v223, v223, v215
    v_cvt_pk_bf16_f32 v24, v216, v217
    v_cvt_pk_bf16_f32 v25, v218, v219
    v_cvt_pk_bf16_f32 v26, v220, v221
    v_cvt_pk_bf16_f32 v27, v222, v223
PAD_C_18:
    s_cbranch_execz PAD_C_19
    buffer_store_dwordx4 v[24:27], v22, s[20:23], s19 offen offset:2048 sc1
    s_lshr_b32 s3, s2, 3
    s_and_b32 s3, s3, 3
    s_lshl_b32 s3, s3, 2
    s_add_u32 s3, s3, s6
    s_mov_b64 exec, 0
    s_cmp_ge_u32 s3, 8
    s_cbranch_scc1 PCH_C_8_16
    s_cmp_eq_u32 s3, 0
    s_cbranch_scc1 PAD_C_0
    s_cmp_eq_u32 s3, 1
    s_cbranch_scc1 PAD_C_4
    s_cmp_eq_u32 s3, 2
    s_cbranch_scc1 PAD_C_8
    s_cmp_eq_u32 s3, 3
    s_cbranch_scc1 PAD_C_12
    s_cmp_eq_u32 s3, 4
    s_cbranch_scc1 PAD_C_16
    s_cmp_eq_u32 s3, 5
    s_cbranch_scc1 PAD_C_21
    s_cmp_eq_u32 s3, 6
    s_cbranch_scc1 PAD_C_25
    s_cmp_eq_u32 s3, 7
    s_cbranch_scc1 PAD_C_29
    s_branch PNO_C
PCH_C_8_16:
    s_cmp_eq_u32 s3, 8
    s_cbranch_scc1 PAD_C_33
    s_cmp_eq_u32 s3, 9
    s_cbranch_scc1 PAD_C_37
    s_cmp_eq_u32 s3, 10
    s_cbranch_scc1 PAD_C_41
    s_cmp_eq_u32 s3, 11
    s_cbranch_scc1 PAD_C_45
    s_cmp_eq_u32 s3, 12
    s_cbranch_scc1 PAD_C_50
    s_cmp_eq_u32 s3, 13
    s_cbranch_scc1 PAD_C_54
    s_cmp_eq_u32 s3, 14
    s_cbranch_scc1 PAD_C_58
    s_cmp_eq_u32 s3, 15
    s_cbranch_scc1 PAD_C_62
PNO_C:
PRET_C:
    s_mov_b64 exec, -1
    s_and_b32 s3, s2, 7
    s_lshl_b32 s3, s3, 2
    s_sub_u32 s62, s2, 224
    s_lshr_b32 s62, s62, 3
    s_add_u32 s3, s3, s62
    s_lshl_b32 s3, s3, 2
    s_add_u32 s3, s3, s6
    s_mul_i32 s62, s3, 57344
    s_add_u32 s62, s62, 25165824
    v_lshlrev_b32 v15, 4, v2
    v_mov_b32 v228, -1
    v_mov_b32 v229, -1
    v_mov_b32 v230, -1
    v_mov_b32 v231, -1
    buffer_store_dwordx4 v[228:231], v15, s[20:23], s62 offen sc1
    buffer_store_dwordx4 v[228:231], v15, s[20:23], s62 offen offset:1024 sc1
    buffer_store_dwordx4 v[228:231], v15, s[20:23], s62 offen offset:2048 sc1
    buffer_store_dwordx4 v[228:231], v15, s[20:23], s62 offen offset:3072 sc1
    s_add_u32 s62, s62, 4096
    buffer_store_dwordx4 v[228:231], v15, s[20:23], s62 offen sc1
PAD_C_19:
    s_cbranch_execz PAD_C_20
    buffer_store_dwordx4 v[228:231], v15, s[20:23], s62 offen offset:1024 sc1
    buffer_store_dwordx4 v[228:231], v15, s[20:23], s62 offen offset:2048 sc1
    buffer_store_dwordx4 v[228:231], v15, s[20:23], s62 offen offset:3072 sc1
    s_add_u32 s62, s62, 4096
    buffer_store_dwordx4 v[228:231], v15, s[20:23], s62 offen sc1
    buffer_store_dwordx4 v[228:231], v15, s[20:23], s62 offen offset:1024 sc1
    buffer_store_dwordx4 v[228:231], v15, s[20:23], s62 offen offset:2048 sc1
    buffer_store_dwordx4 v[228:231], v15, s[20:23], s62 offen offset:3072 sc1
    s_add_u32 s62, s62, 4096
    buffer_store_dwordx4 v[228:231], v15, s[20:23], s62 offen sc1
    buffer_store_dwordx4 v[228:231], v15, s[20:23], s62 offen offset:1024 sc1
    buffer_store_dwordx4 v[228:231], v15, s[20:23], s62 offen offset:2048 sc1
    buffer_store_dwordx4 v[228:231], v15, s[20:23], s62 offen offset:3072 sc1
    s_add_u32 s62, s62, 4096
    buffer_store_dwordx4 v[228:231], v15, s[20:23], s62 offen sc1
    buffer_store_dwordx4 v[228:231], v15, s[20:23], s62 offen offset:1024 sc1
    buffer_store_dwordx4 v[228:231], v15, s[20:23], s62 offen offset:2048 sc1
    buffer_store_dwordx4 v[228:231], v15, s[20:23], s62 offen offset:3072 sc1
    s_add_u32 s62, s62, 4096
    buffer_store_dwordx4 v[228:231], v15, s[20:23], s62 offen sc1
    buffer_store_dwordx4 v[228:231], v15, s[20:23], s62 offen offset:1024 sc1
    buffer_store_dwordx4 v[228:231], v15, s[20:23], s62 offen offset:2048 sc1
    buffer_store_dwordx4 v[228:231], v15, s[20:23], s62 offen offset:3072 sc1
    s_add_u32 s62, s62, 4096
    buffer_store_dwordx4 v[228:231], v15, s[20:23], s62 offen sc1
    buffer_store_dwordx4 v[228:231], v15, s[20:23], s62 offen offset:1024 sc1
    buffer_store_dwordx4 v[228:231], v15, s[20:23], s62 offen offset:2048 sc1
    buffer_store_dwordx4 v[228:231], v15, s[20:23], s62 offen offset:3072 sc1
    s_add_u32 s62, s62, 4096
    buffer_store_dwordx4 v[228:231], v15, s[20:23], s62 offen sc1
    buffer_store_dwordx4 v[228:231], v15, s[20:23], s62 offen offset:1024 sc1
    buffer_store_dwordx4 v[228:231], v15, s[20:23], s62 offen offset:2048 sc1
    buffer_store_dwordx4 v[228:231], v15, s[20:23], s62 offen offset:3072 sc1
    s_add_u32 s62, s62, 4096
    buffer_store_dwordx4 v[228:231], v15, s[20:23], s62 offen sc1
    buffer_store_dwordx4 v[228:231], v15, s[20:23], s62 offen offset:1024 sc1
    buffer_store_dwordx4 v[228:231], v15, s[20:23], s62 offen offset:2048 sc1
    buffer_store_dwordx4 v[228:231], v15, s[20:23], s62 offen offset:3072 sc1
    s_add_u32 s62, s62, 4096
    buffer_store_dwordx4 v[228:231], v15, s[20:23], s62 offen sc1
PAD_C_20:
    s_cbranch_execz PRET_C
    buffer_store_dwordx4 v[228:231], v15, s[20:23], s62 offen offset:1024 sc1
    buffer_store_dwordx4 v[228:231], v15, s[20:23], s62 offen offset:2048 sc1
    buffer_store_dwordx4 v[228:231], v15, s[20:23], s62 offen offset:3072 sc1
    s_add_u32 s62, s62, 4096
    buffer_store_dwordx4 v[228:231], v15, s[20:23], s62 offen sc1
    buffer_store_dwordx4 v[228:231], v15, s[20:23], s62 offen offset:1024 sc1
    buffer_store_dwordx4 v[228:231], v15, s[20:23], s62 offen offset:2048 sc1
    buffer_store_dwordx4 v[228:231], v15, s[20:23], s62 offen offset:3072 sc1
    s_add_u32 s62, s62, 4096
    buffer_store_dwordx4 v[228:231], v15, s[20:23], s62 offen sc1
    buffer_store_dwordx4 v[228:231], v15, s[20:23], s62 offen offset:1024 sc1
    buffer_store_dwordx4 v[228:231], v15, s[20:23], s62 offen offset:2048 sc1
    buffer_store_dwordx4 v[228:231], v15, s[20:23], s62 offen offset:3072 sc1
    s_add_u32 s62, s62, 4096
    buffer_store_dwordx4 v[228:231], v15, s[20:23], s62 offen sc1
    buffer_store_dwordx4 v[228:231], v15, s[20:23], s62 offen offset:1024 sc1
    buffer_store_dwordx4 v[228:231], v15, s[20:23], s62 offen offset:2048 sc1
    buffer_store_dwordx4 v[228:231], v15, s[20:23], s62 offen offset:3072 sc1
    s_add_u32 s62, s62, 4096
    buffer_store_dwordx4 v[228:231], v15, s[20:23], s62 offen sc1
    buffer_store_dwordx4 v[228:231], v15, s[20:23], s62 offen offset:1024 sc1
    buffer_store_dwordx4 v[228:231], v15, s[20:23], s62 offen offset:2048 sc1
    buffer_store_dwordx4 v[228:231], v15, s[20:23], s62 offen offset:3072 sc1
    s_waitcnt vmcnt(0)
    s_barrier
    s_cmp_lg_u32 s6, 0
    s_cbranch_scc1 SKIP_109
    s_add_u32 s92, s88, 5
    v_mov_b32 v253, s92
    v_lshlrev_b32 v252, 10, v2
    buffer_store_dword v253, v252, s[20:23], s89 offen sc1
    s_mov_b64 exec, -1
SKIP_109:
    v_lshlrev_b32 v4, 4, v2
    s_add_u32 m0, s100, 66560
    s_add_u32 s18, s99, 0
    buffer_load_dwordx4 v4, s[20:23], s18 offen lds
    s_add_u32 m0, s100, 70656
    s_add_u32 s18, s99, 28672
    buffer_load_dwordx4 v4, s[20:23], s18 offen lds
    s_add_u32 m0, s100, 74752
    s_add_u32 s18, s99, 57344
    buffer_load_dwordx4 v4, s[20:23], s18 offen lds
    s_add_u32 m0, s100, 78848
    s_add_u32 s18, s99, 4096
    buffer_load_dwordx4 v4, s[20:23], s18 offen lds
PAD_C_21:
    s_cbranch_execz PAD_C_22
    s_add_u32 m0, s100, 82944
    s_add_u32 s18, s99, 32768
    buffer_load_dwordx4 v4, s[20:23], s18 offen lds
    s_add_u32 m0, s100, 87040
    s_add_u32 s18, s99, 61440
    buffer_load_dwordx4 v4, s[20:23], s18 offen lds
    s_add_u32 m0, s100, 91136
    s_add_u32 s18, s99, 8192
    buffer_load_dwordx4 v4, s[20:23], s18 offen lds
    s_add_u32 m0, s100, 95232
    s_add_u32 s18, s99, 36864
    buffer_load_dwordx4 v4, s[20:23], s18 offen lds
    s_add_u32 m0, s100, 99328
    s_add_u32 s18, s99, 65536
    buffer_load_dwordx4 v4, s[20:23], s18 offen lds
    s_add_u32 m0, s100, 103424
    s_add_u32 s18, s99, 12288
    buffer_load_dwordx4 v4, s[20:23], s18 offen lds
    s_add_u32 m0, s100, 107520
    s_add_u32 s18, s99, 40960
    buffer_load_dwordx4 v4, s[20:23], s18 offen lds
    s_add_u32 m0, s100, 111616
    s_add_u32 s18, s99, 69632
    buffer_load_dwordx4 v4, s[20:23], s18 offen lds
    s_add_u32 m0, s100, 115712
    s_add_u32 s18, s99, 16384
    buffer_load_dwordx4 v4, s[20:23], s18 offen lds
    s_add_u32 m0, s100, 119808
    s_add_u32 s18, s99, 45056
    buffer_load_dwordx4 v4, s[20:23], s18 offen lds
    s_add_u32 m0, s100, 123904
    s_add_u32 s18, s99, 73728
    buffer_load_dwordx4 v4, s[20:23], s18 offen lds
    s_add_u32 m0, s100, 128000
    s_add_u32 s18, s99, 20480
    buffer_load_dwordx4 v4, s[20:23], s18 offen lds
    s_add_u32 m0, s100, 132096
    s_add_u32 s18, s99, 49152
    buffer_load_dwordx4 v4, s[20:23], s18 offen lds
    s_add_u32 m0, s100, 136192
PAD_C_22:
    s_cbranch_execz PAD_C_23
    s_add_u32 s18, s99, 77824
    buffer_load_dwordx4 v4, s[20:23], s18 offen lds
    s_add_u32 m0, s100, 140288
    s_add_u32 s18, s99, 24576
    buffer_load_dwordx4 v4, s[20:23], s18 offen lds
    s_add_u32 m0, s100, 144384
    s_add_u32 s18, s99, 53248
    buffer_load_dwordx4 v4, s[20:23], s18 offen lds
    s_add_u32 m0, s100, 148480
    s_add_u32 s18, s99, 81920
    buffer_load_dwordx4 v4, s[20:23], s18 offen lds
    s_add_u32 m0, s100, 152576
    s_add_u32 s18, s99, 86016
    buffer_load_dwordx4 v4, s[20:23], s18 offen lds
    s_add_u32 m0, s100, 156672
    s_add_u32 s18, s99, 90112
    buffer_load_dwordx4 v4, s[20:23], s18 offen lds
    v_lshrrev_b32 v5, 2, v2
    v_lshlrev_b32 v5, 12, v5
    v_and_b32 v6, 3, v2
    v_lshl_add_u32 v3, v6, 4, v5
    v_lshlrev_b32 v4, 4, v2
    v_lshrrev_b32 v16, 5, v2
    v_lshlrev_b32 v16, 3, v16
    v_bfe_u32 v17, v2, 2, 2
    v_add_u32 v16, v16, v17
    v_lshlrev_b32 v16, 6, v16
    v_bfe_u32 v17, v2, 4, 1
    v_lshl_add_u32 v16, v17, 5, v16
    v_lshl_add_u32 v16, v6, 3, v16
    s_add_u32 s12, s100, 17408
    v_add_u32 v12, s12, v16
    v_add_u32 v8, 17408, v4
    v_add_u32 v9, 82944, v4
    v_add_u32 v10, 148480, v4
    s_mov_b32 s60, -1
    s_mov_b32 s61, 0
    v_mov_b32 v241, 0
    v_mov_b32 v242, 0
    v_mov_b32 v243, 0
    v_mov_b32 v16, 0x3f803f80
    v_mov_b32 v17, 0
    v_mov_b32 v13, 0
    v_mov_b32 v18, 0
    v_mov_b32 v14, 0
    s_lshl_b32 s13, s96, 8
    s_lshl_b32 s12, s6, 6
    s_add_u32 s13, s13, s12
    s_add_u32 s13, s13, 6291456
    s_mov_b32 vcc_lo, 0x10100101
PAD_C_23:
    s_cbranch_execz PAD_C_24
    s_mov_b32 vcc_hi, 0x10100101
    v_cndmask_b32 v16, 0, v16, vcc
    v_accvgpr_write_b32 a240, v16
    v_accvgpr_write_b32 a241, v16
    v_accvgpr_write_b32 a242, v16
    v_accvgpr_write_b32 a243, v16
    s_lshl_b32 s19, s96, 2
    s_add_u32 s19, s19, s6
    s_mul_i32 s19, s19, 114688
    s_mul_i32 s24, s97, 7168
    s_add_u32 s19, s19, s24
    s_add_u32 s19, s19, 25165824
    s_and_b32 s11, s6, 1
    s_lshr_b32 s12, s6, 1
    s_lshl_b32 s40, s94, 1
    s_add_u32 s40, s40, s11
    s_lshl_b32 s41, s95, 1
    s_add_u32 s41, s41, s12
    s_lshl_b32 s42, s41, 17
    s_lshl_b32 s43, s40, 6
    s_add_u32 s42, s42, s43
    s_add_u32 s43, s42, 6291456
    s_xor_b32 s45, s40, 1
    s_mul_i32 s44, s40, 114688
    s_mul_i32 s45, s45, 114688
    s_mul_i32 s46, s6, 28672
    s_add_u32 s46, s46, 25165824
    s_add_u32 s32, s44, s46
    s_add_u32 s56, s45, s46
    s_lshl_b32 s47, s6, 11
    s_add_u32 s47, s47, 152576
    v_add_u32 v22, 4096, v4
    s_add_u32 s33, s32, 7168
    s_add_u32 s57, s56, 7168
    s_add_u32 s34, s32, 14336
    s_add_u32 s58, s56, 14336
    s_add_u32 s35, s32, 21504
    s_add_u32 s59, s56, 21504
    s_waitcnt vmcnt(0)
    s_cmp_lg_u32 s6, 0
    s_cbranch_scc1 SKIP_111
    s_add_u32 s3, s88, 5
PAD_C_24:
    s_cbranch_execz PRET_C
    s_mov_b32 s92, 30000
POLL_113:
    buffer_load_dwordx4 v[248:251], v254, s[20:23], s90 offen sc1
    s_waitcnt vmcnt(0)
    v_subrev_u32 v248, s3, v248
    v_subrev_u32 v249, s3, v249
    v_subrev_u32 v250, s3, v250
    v_subrev_u32 v251, s3, v251
    v_max3_u32 v248, v248, v249, v250
    v_max_u32 v248, v248, v251
    v_cmp_lt_u32 vcc, 7, v248
    s_and_b64 exec, vcc, exec
    s_cbranch_scc0 PDONE_114
    s_sub_u32 s92, s92, 1
    s_cmp_lg_u32 s92, 0
    s_cbranch_scc1 POLL_113
PDONE_114:
    s_mov_b64 exec, -1
SKIP_111:
    s_barrier
L_GLU2:
    s_nop 7
    s_add_u32 m0, s100, 17408
    s_nop 0
    buffer_load_dwordx4 v3, s[20:23], s13 offen lds
    s_add_u32 m0, s100, 21504
    s_add_u32 s18, s13, 65536
    buffer_load_dwordx4 v3, s[20:23], s18 offen lds
    s_add_u32 m0, s100, 25600
    s_add_u32 s18, s13, 131072
    buffer_load_dwordx4 v3, s[20:23], s18 offen lds
    s_add_u32 m0, s100, 29696
    s_add_u32 s18, s13, 196608
    buffer_load_dwordx4 v3, s[20:23], s18 offen lds
    s_add_u32 m0, s100, 33792
    s_add_u32 s18, s13, 262144
    buffer_load_dwordx4 v3, s[20:23], s18 offen lds
    s_add_u32 m0, s100, 37888
    s_add_u32 s18, s13, 327680
    buffer_load_dwordx4 v3, s[20:23], s18 offen lds
    s_add_u32 m0, s100, 41984
    s_add_u32 s18, s13, 393216
    buffer_load_dwordx4 v3, s[20:23], s18 offen lds
    s_add_u32 m0, s100, 46080
    s_add_u32 s18, s13, 458752
    buffer_load_dwordx4 v3, s[20:23], s18 offen lds
    s_add_u32 m0, s100, 50176
    s_add_u32 s18, s13, 524288
    buffer_load_dwordx4 v3, s[20:23], s18 offen lds
    s_add_u32 m0, s100, 54272
    s_add_u32 s18, s13, 589824
    buffer_load_dwordx4 v3, s[20:23], s18 offen lds
PAD_C_25:
    s_cbranch_execz PAD_C_26
    s_add_u32 m0, s100, 58368
    s_add_u32 s18, s13, 655360
    buffer_load_dwordx4 v3, s[20:23], s18 offen lds
    s_add_u32 m0, s100, 62464
    s_add_u32 s18, s13, 720896
    buffer_load_dwordx4 v3, s[20:23], s18 offen lds
    ds_read_b128 v[144:147], v8 offset:49152
    ds_read_b128 v[148:151], v8 offset:53248
    ds_read_b128 v[152:155], v8 offset:57344
    ds_read_b128 v[156:159], v8 offset:50176
    ds_read_b128 v[160:163], v8 offset:54272
    ds_read_b128 v[164:167], v8 offset:58368
    ds_read_b128 v[168:171], v8 offset:51200
    s_waitcnt vmcnt(11)
    ds_read_b64_tr_b16 v[32:33], v12 offset:0
    ds_read_b64_tr_b16 v[34:35], v12 offset:256
    s_waitcnt vmcnt(10)
    ds_read_b64_tr_b16 v[36:37], v12 offset:4096
    ds_read_b64_tr_b16 v[38:39], v12 offset:4352
    s_waitcnt lgkmcnt(2)
    v_mfma_f32_32x32x16_bf16 v[176:191], v[144:147], v[32:35], 0
    ds_read_b128 v[172:175], v8 offset:55296
    s_waitcnt vmcnt(9)
    ds_read_b64_tr_b16 v[40:41], v12 offset:8192
    v_dot2c_f32_bf16 v18, v32, v32
    v_dot2c_f32_bf16 v14, v33, v33
    v_dot2c_f32_bf16 v18, v34, v34
    v_dot2c_f32_bf16 v14, v35, v35
    v_mfma_f32_32x32x16_bf16 v[192:207], v[148:151], v[32:35], 0
    ds_read_b128 v[144:147], v8 offset:59392
    ds_read_b64_tr_b16 v[42:43], v12 offset:8448
    v_mfma_f32_32x32x16_bf16 v[208:223], v[152:155], v[32:35], 0
    ds_read_b128 v[148:151], v8 offset:52224
    s_add_u32 m0, s100, 17408
    s_add_u32 s18, s13, 786432
    buffer_load_dwordx4 v3, s[20:23], s18 offen lds
    v_mfma_f32_16x16x32_bf16 a[244:247], a[240:243], v[32:35], 0
    s_waitcnt lgkmcnt(5)
PAD_C_26:
    s_cbranch_execz PAD_C_27
    v_mfma_f32_32x32x16_bf16 v[176:191], v[156:159], v[36:39], v[176:191]
    ds_read_b128 v[152:155], v8 offset:56320
    s_waitcnt vmcnt(9)
    ds_read_b64_tr_b16 v[44:45], v12 offset:12288
    v_dot2c_f32_bf16 v18, v36, v36
    v_dot2c_f32_bf16 v14, v37, v37
    v_dot2c_f32_bf16 v18, v38, v38
    v_dot2c_f32_bf16 v14, v39, v39
    v_mfma_f32_32x32x16_bf16 v[192:207], v[160:163], v[36:39], v[192:207]
    ds_read_b128 v[156:159], v8 offset:60416
    ds_read_b64_tr_b16 v[46:47], v12 offset:12544
    v_mfma_f32_32x32x16_bf16 v[208:223], v[164:167], v[36:39], v[208:223]
    ds_read_b128 v[160:163], v8 offset:61440
    s_add_u32 m0, s100, 21504
    s_add_u32 s18, s13, 851968
    buffer_load_dwordx4 v3, s[20:23], s18 offen lds
    v_mfma_f32_16x16x32_bf16 a[244:247], a[240:243], v[36:39], a[244:247]
    s_waitcnt lgkmcnt(6)
    v_mfma_f32_32x32x16_bf16 v[176:191], v[168:171], v[40:43], v[176:191]
    ds_read_b128 v[164:167], v9 offset:0
    s_waitcnt vmcnt(9)
    ds_read_b64_tr_b16 v[48:49], v12 offset:16384
    v_dot2c_f32_bf16 v18, v40, v40
    v_dot2c_f32_bf16 v14, v41, v41
    v_dot2c_f32_bf16 v18, v42, v42
    v_dot2c_f32_bf16 v14, v43, v43
    v_mfma_f32_32x32x16_bf16 v[192:207], v[172:175], v[40:43], v[192:207]
    ds_read_b128 v[168:171], v9 offset:4096
    ds_read_b64_tr_b16 v[50:51], v12 offset:16640
    v_mfma_f32_32x32x16_bf16 v[208:223], v[144:147], v[40:43], v[208:223]
    ds_read_b128 v[172:175], v8 offset:62464
    s_add_u32 m0, s100, 25600
    s_add_u32 s18, s13, 917504
    buffer_load_dwordx4 v3, s[20:23], s18 offen lds
    v_mfma_f32_16x16x32_bf16 a[244:247], a[240:243], v[40:43], a[244:247]
    s_waitcnt lgkmcnt(6)
PAD_C_27:
    s_cbranch_execz PAD_C_28
    v_mfma_f32_32x32x16_bf16 v[176:191], v[148:151], v[44:47], v[176:191]
    ds_read_b128 v[144:147], v9 offset:1024
    s_waitcnt vmcnt(9)
    ds_read_b64_tr_b16 v[52:53], v12 offset:20480
    v_dot2c_f32_bf16 v18, v44, v44
    v_dot2c_f32_bf16 v14, v45, v45
    v_dot2c_f32_bf16 v18, v46, v46
    v_dot2c_f32_bf16 v14, v47, v47
    v_mfma_f32_32x32x16_bf16 v[192:207], v[152:155], v[44:47], v[192:207]
    ds_read_b128 v[148:151], v9 offset:5120
    ds_read_b64_tr_b16 v[54:55], v12 offset:20736
    v_mfma_f32_32x32x16_bf16 v[208:223], v[156:159], v[44:47], v[208:223]
    ds_read_b128 v[152:155], v8 offset:63488
    s_add_u32 m0, s100, 29696
    s_add_u32 s18, s13, 983040
    buffer_load_dwordx4 v3, s[20:23], s18 offen lds
    v_mfma_f32_16x16x32_bf16 a[244:247], a[240:243], v[44:47], a[244:247]
    s_waitcnt lgkmcnt(6)
    v_mfma_f32_32x32x16_bf16 v[176:191], v[160:163], v[48:51], v[176:191]
    ds_read_b128 v[156:159], v9 offset:2048
    s_waitcnt vmcnt(9)
    ds_read_b64_tr_b16 v[56:57], v12 offset:24576
    v_dot2c_f32_bf16 v18, v48, v48
    v_dot2c_f32_bf16 v14, v49, v49
    v_dot2c_f32_bf16 v18, v50, v50
    v_dot2c_f32_bf16 v14, v51, v51
    v_mfma_f32_32x32x16_bf16 v[192:207], v[164:167], v[48:51], v[192:207]
    ds_read_b128 v[160:163], v9 offset:6144
    ds_read_b64_tr_b16 v[58:59], v12 offset:24832
    v_mfma_f32_32x32x16_bf16 v[208:223], v[168:171], v[48:51], v[208:223]
    ds_read_b128 v[164:167], v8 offset:64512
    s_add_u32 m0, s100, 33792
    s_add_u32 s18, s13, 1048576
    buffer_load_dwordx4 v3, s[20:23], s18 offen lds
    v_mfma_f32_16x16x32_bf16 a[244:247], a[240:243], v[48:51], a[244:247]
    s_waitcnt lgkmcnt(6)
PAD_C_28:
    s_cbranch_execz PRET_C
    v_mfma_f32_32x32x16_bf16 v[176:191], v[172:175], v[52:55], v[176:191]
    ds_read_b128 v[168:171], v9 offset:3072
    s_waitcnt vmcnt(9)
    ds_read_b64_tr_b16 v[60:61], v12 offset:28672
    v_dot2c_f32_bf16 v18, v52, v52
    v_dot2c_f32_bf16 v14, v53, v53
    v_dot2c_f32_bf16 v18, v54, v54
    v_dot2c_f32_bf16 v14, v55, v55
    v_mfma_f32_32x32x16_bf16 v[192:207], v[144:147], v[52:55], v[192:207]
    ds_read_b128 v[172:175], v9 offset:7168
    ds_read_b64_tr_b16 v[62:63], v12 offset:28928
    v_mfma_f32_32x32x16_bf16 v[208:223], v[148:151], v[52:55], v[208:223]
    ds_read_b128 v[144:147], v9 offset:8192
    s_add_u32 m0, s100, 37888
    s_add_u32 s18, s13, 1114112
    buffer_load_dwordx4 v3, s[20:23], s18 offen lds
    v_mfma_f32_16x16x32_bf16 a[244:247], a[240:243], v[52:55], a[244:247]
    s_waitcnt lgkmcnt(6)
    v_mfma_f32_32x32x16_bf16 v[176:191], v[152:155], v[56:59], v[176:191]
    ds_read_b128 v[148:151], v9 offset:12288
    s_waitcnt vmcnt(9)
    ds_read_b64_tr_b16 v[64:65], v12 offset:32768
    v_dot2c_f32_bf16 v18, v56, v56
    v_dot2c_f32_bf16 v14, v57, v57
    v_dot2c_f32_bf16 v18, v58, v58
    v_dot2c_f32_bf16 v14, v59, v59
    v_mfma_f32_32x32x16_bf16 v[192:207], v[156:159], v[56:59], v[192:207]
    ds_read_b128 v[152:155], v9 offset:16384
    ds_read_b64_tr_b16 v[66:67], v12 offset:33024
    v_mfma_f32_32x32x16_bf16 v[208:223], v[160:163], v[56:59], v[208:223]
    ds_read_b128 v[156:159], v9 offset:9216
    s_add_u32 m0, s100, 41984
    s_add_u32 s18, s13, 1179648
    buffer_load_dwordx4 v3, s[20:23], s18 offen lds
    v_mfma_f32_16x16x32_bf16 a[244:247], a[240:243], v[56:59], a[244:247]
    s_waitcnt lgkmcnt(6)
PAD_C_29:
    s_cbranch_execz PAD_C_30
    v_mfma_f32_32x32x16_bf16 v[176:191], v[164:167], v[60:63], v[176:191]
    ds_read_b128 v[160:163], v9 offset:13312
    s_waitcnt vmcnt(9)
    ds_read_b64_tr_b16 v[68:69], v12 offset:36864
    v_dot2c_f32_bf16 v18, v60, v60
    v_dot2c_f32_bf16 v14, v61, v61
    v_dot2c_f32_bf16 v18, v62, v62
    v_dot2c_f32_bf16 v14, v63, v63
    v_mfma_f32_32x32x16_bf16 v[192:207], v[168:171], v[60:63], v[192:207]
    ds_read_b128 v[164:167], v9 offset:17408
    ds_read_b64_tr_b16 v[70:71], v12 offset:37120
    v_mfma_f32_32x32x16_bf16 v[208:223], v[172:175], v[60:63], v[208:223]
    ds_read_b128 v[168:171], v9 offset:10240
    s_add_u32 m0, s100, 46080
    s_add_u32 s18, s13, 1245184
    buffer_load_dwordx4 v3, s[20:23], s18 offen lds
    v_mfma_f32_16x16x32_bf16 a[244:247], a[240:243], v[60:63], a[244:247]
    s_waitcnt lgkmcnt(6)
    v_mfma_f32_32x32x16_bf16 v[176:191], v[144:147], v[64:67], v[176:191]
    ds_read_b128 v[172:175], v9 offset:14336
    s_waitcnt vmcnt(9)
    ds_read_b64_tr_b16 v[72:73], v12 offset:40960
    v_dot2c_f32_bf16 v18, v64, v64
    v_dot2c_f32_bf16 v14, v65, v65
    v_dot2c_f32_bf16 v18, v66, v66
    v_dot2c_f32_bf16 v14, v67, v67
    v_mfma_f32_32x32x16_bf16 v[192:207], v[148:151], v[64:67], v[192:207]
    ds_read_b128 v[144:147], v9 offset:18432
    ds_read_b64_tr_b16 v[74:75], v12 offset:41216
    v_mfma_f32_32x32x16_bf16 v[208:223], v[152:155], v[64:67], v[208:223]
    ds_read_b128 v[148:151], v9 offset:11264
    s_add_u32 m0, s100, 50176
    s_add_u32 s18, s13, 1310720
    buffer_load_dwordx4 v3, s[20:23], s18 offen lds
    v_mfma_f32_16x16x32_bf16 a[244:247], a[240:243], v[64:67], a[244:247]
    s_waitcnt lgkmcnt(6)
PAD_C_30:
    s_cbranch_execz PAD_C_31
    v_mfma_f32_32x32x16_bf16 v[176:191], v[156:159], v[68:71], v[176:191]
    ds_read_b128 v[152:155], v9 offset:15360
    s_waitcnt vmcnt(9)
    ds_read_b64_tr_b16 v[76:77], v12 offset:45056
    v_dot2c_f32_bf16 v18, v68, v68
    v_dot2c_f32_bf16 v14, v69, v69
    v_dot2c_f32_bf16 v18, v70, v70
    v_dot2c_f32_bf16 v14, v71, v71
    v_mfma_f32_32x32x16_bf16 v[192:207], v[160:163], v[68:71], v[192:207]
    ds_read_b128 v[156:159], v9 offset:19456
    ds_read_b64_tr_b16 v[78:79], v12 offset:45312
    v_mfma_f32_32x32x16_bf16 v[208:223], v[164:167], v[68:71], v[208:223]
    ds_read_b128 v[160:163], v9 offset:20480
    s_add_u32 m0, s100, 54272
    s_add_u32 s18, s13, 1376256
    buffer_load_dwordx4 v3, s[20:23], s18 offen lds
    v_mfma_f32_16x16x32_bf16 a[244:247], a[240:243], v[68:71], a[244:247]
    s_waitcnt lgkmcnt(6)
    v_mfma_f32_32x32x16_bf16 v[176:191], v[168:171], v[72:75], v[176:191]
    ds_read_b128 v[164:167], v9 offset:24576
    s_waitcnt vmcnt(9)
    ds_read_b64_tr_b16 v[80:81], v12 offset:0
    v_dot2c_f32_bf16 v18, v72, v72
    v_dot2c_f32_bf16 v14, v73, v73
    v_dot2c_f32_bf16 v18, v74, v74
    v_dot2c_f32_bf16 v14, v75, v75
    v_mfma_f32_32x32x16_bf16 v[192:207], v[172:175], v[72:75], v[192:207]
    ds_read_b128 v[168:171], v9 offset:28672
    ds_read_b64_tr_b16 v[82:83], v12 offset:256
    v_mfma_f32_32x32x16_bf16 v[208:223], v[144:147], v[72:75], v[208:223]
    ds_read_b128 v[172:175], v9 offset:21504
    s_add_u32 m0, s100, 58368
    s_add_u32 s18, s13, 1441792
    buffer_load_dwordx4 v3, s[20:23], s18 offen lds
    v_mfma_f32_16x16x32_bf16 a[244:247], a[240:243], v[72:75], a[244:247]
    s_waitcnt lgkmcnt(6)
PAD_C_31:
    s_cbranch_execz PAD_C_32
    v_mfma_f32_32x32x16_bf16 v[176:191], v[148:151], v[76:79], v[176:191]
    ds_read_b128 v[144:147], v9 offset:25600
    s_waitcnt vmcnt(9)
    ds_read_b64_tr_b16 v[84:85], v12 offset:4096
    v_dot2c_f32_bf16 v18, v76, v76
    v_dot2c_f32_bf16 v14, v77, v77
    v_dot2c_f32_bf16 v18, v78, v78
    v_dot2c_f32_bf16 v14, v79, v79
    v_mfma_f32_32x32x16_bf16 v[192:207], v[152:155], v[76:79], v[192:207]
    ds_read_b128 v[148:151], v9 offset:29696
    ds_read_b64_tr_b16 v[86:87], v12 offset:4352
    v_mfma_f32_32x32x16_bf16 v[208:223], v[156:159], v[76:79], v[208:223]
    ds_read_b128 v[152:155], v9 offset:22528
    s_add_u32 m0, s100, 62464
    s_add_u32 s18, s13, 1507328
    buffer_load_dwordx4 v3, s[20:23], s18 offen lds
    v_mfma_f32_16x16x32_bf16 a[244:247], a[240:243], v[76:79], a[244:247]
    s_waitcnt lgkmcnt(6)
    v_mfma_f32_32x32x16_bf16 v[176:191], v[160:163], v[80:83], v[176:191]
    ds_read_b128 v[156:159], v9 offset:26624
    s_waitcnt vmcnt(9)
    ds_read_b64_tr_b16 v[88:89], v12 offset:8192
    v_dot2c_f32_bf16 v18, v80, v80
    v_dot2c_f32_bf16 v14, v81, v81
    v_dot2c_f32_bf16 v18, v82, v82
    v_dot2c_f32_bf16 v14, v83, v83
    v_mfma_f32_32x32x16_bf16 v[192:207], v[164:167], v[80:83], v[192:207]
    ds_read_b128 v[160:163], v9 offset:30720
    ds_read_b64_tr_b16 v[90:91], v12 offset:8448
    v_mfma_f32_32x32x16_bf16 v[208:223], v[168:171], v[80:83], v[208:223]
    ds_read_b128 v[164:167], v9 offset:23552
    s_add_u32 m0, s100, 17408
    s_add_u32 s18, s13, 1572864
    buffer_load_dwordx4 v3, s[20:23], s18 offen lds
    v_mfma_f32_16x16x32_bf16 a[244:247], a[240:243], v[80:83], a[244:247]
    s_waitcnt lgkmcnt(6)
PAD_C_32:
    s_cbranch_execz PRET_C
    v_mfma_f32_32x32x16_bf16 v[176:191], v[172:175], v[84:87], v[176:191]
    ds_read_b128 v[168:171], v9 offset:27648
    s_waitcnt vmcnt(9)
    ds_read_b64_tr_b16 v[92:93], v12 offset:12288
    v_dot2c_f32_bf16 v18, v84, v84
    v_dot2c_f32_bf16 v14, v85, v85
    v_dot2c_f32_bf16 v18, v86, v86
    v_dot2c_f32_bf16 v14, v87, v87
    v_mfma_f32_32x32x16_bf16 v[192:207], v[144:147], v[84:87], v[192:207]
    ds_read_b128 v[172:175], v9 offset:31744
    ds_read_b64_tr_b16 v[94:95], v12 offset:12544
    v_mfma_f32_32x32x16_bf16 v[208:223], v[148:151], v[84:87], v[208:223]
    ds_read_b128 v[144:147], v9 offset:32768
    s_add_u32 m0, s100, 21504
    s_add_u32 s18, s13, 1638400
    buffer_load_dwordx4 v3, s[20:23], s18 offen lds
    v_mfma_f32_16x16x32_bf16 a[244:247], a[240:243], v[84:87], a[244:247]
    s_waitcnt lgkmcnt(6)
    v_mfma_f32_32x32x16_bf16 v[176:191], v[152:155], v[88:91], v[176:191]
    ds_read_b128 v[148:151], v9 offset:36864
    s_waitcnt vmcnt(9)
    ds_read_b64_tr_b16 v[96:97], v12 offset:16384
    v_dot2c_f32_bf16 v18, v88, v88
    v_dot2c_f32_bf16 v14, v89, v89
    v_dot2c_f32_bf16 v18, v90, v90
    v_dot2c_f32_bf16 v14, v91, v91
    v_mfma_f32_32x32x16_bf16 v[192:207], v[156:159], v[88:91], v[192:207]
    ds_read_b128 v[152:155], v9 offset:40960
    ds_read_b64_tr_b16 v[98:99], v12 offset:16640
    v_mfma_f32_32x32x16_bf16 v[208:223], v[160:163], v[88:91], v[208:223]
    ds_read_b128 v[156:159], v9 offset:33792
    s_add_u32 m0, s100, 25600
    s_add_u32 s18, s13, 1703936
    buffer_load_dwordx4 v3, s[20:23], s18 offen lds
    v_mfma_f32_16x16x32_bf16 a[244:247], a[240:243], v[88:91], a[244:247]
    s_waitcnt lgkmcnt(6)
PAD_C_33:
    s_cbranch_execz PAD_C_34
    v_mfma_f32_32x32x16_bf16 v[176:191], v[164:167], v[92:95], v[176:191]
    ds_read_b128 v[160:163], v9 offset:37888
    s_waitcnt vmcnt(9)
    ds_read_b64_tr_b16 v[100:101], v12 offset:20480
    v_dot2c_f32_bf16 v18, v92, v92
    v_dot2c_f32_bf16 v14, v93, v93
    v_dot2c_f32_bf16 v18, v94, v94
    v_dot2c_f32_bf16 v14, v95, v95
    v_mfma_f32_32x32x16_bf16 v[192:207], v[168:171], v[92:95], v[192:207]
    ds_read_b128 v[164:167], v9 offset:41984
    ds_read_b64_tr_b16 v[102:103], v12 offset:20736
    v_mfma_f32_32x32x16_bf16 v[208:223], v[172:175], v[92:95], v[208:223]
    ds_read_b128 v[168:171], v9 offset:34816
    s_add_u32 m0, s100, 29696
    s_add_u32 s18, s13, 1769472
    buffer_load_dwordx4 v3, s[20:23], s18 offen lds
    v_mfma_f32_16x16x32_bf16 a[244:247], a[240:243], v[92:95], a[244:247]
    s_barrier
    s_waitcnt lgkmcnt(6)
    v_mfma_f32_32x32x16_bf16 v[176:191], v[144:147], v[96:99], v[176:191]
    ds_read_b128 v[172:175], v9 offset:38912
    s_waitcnt vmcnt(9)
    ds_read_b64_tr_b16 v[104:105], v12 offset:24576
    v_dot2c_f32_bf16 v18, v96, v96
    v_dot2c_f32_bf16 v14, v97, v97
    v_dot2c_f32_bf16 v18, v98, v98
    v_dot2c_f32_bf16 v14, v99, v99
    v_mfma_f32_32x32x16_bf16 v[192:207], v[148:151], v[96:99], v[192:207]
    ds_read_b128 v[144:147], v9 offset:43008
    ds_read_b64_tr_b16 v[106:107], v12 offset:24832
    v_mfma_f32_32x32x16_bf16 v[208:223], v[152:155], v[96:99], v[208:223]
    ds_read_b128 v[148:151], v9 offset:35840
    s_add_u32 m0, s100, 66560
    s_add_u32 s18, s99, 94208
    buffer_load_dwordx4 v4, s[20:23], s18 offen lds
    v_mfma_f32_16x16x32_bf16 a[244:247], a[240:243], v[96:99], a[244:247]
    s_waitcnt lgkmcnt(6)
PAD_C_34:
    s_cbranch_execz PAD_C_35
    v_mfma_f32_32x32x16_bf16 v[176:191], v[156:159], v[100:103], v[176:191]
    ds_read_b128 v[152:155], v9 offset:39936
    s_waitcnt vmcnt(9)
    ds_read_b64_tr_b16 v[108:109], v12 offset:28672
    v_dot2c_f32_bf16 v18, v100, v100
    v_dot2c_f32_bf16 v14, v101, v101
    v_dot2c_f32_bf16 v18, v102, v102
    v_dot2c_f32_bf16 v14, v103, v103
    v_mfma_f32_32x32x16_bf16 v[192:207], v[160:163], v[100:103], v[192:207]
    ds_read_b128 v[156:159], v9 offset:44032
    ds_read_b64_tr_b16 v[110:111], v12 offset:28928
    v_mfma_f32_32x32x16_bf16 v[208:223], v[164:167], v[100:103], v[208:223]
    ds_read_b128 v[160:163], v9 offset:45056
    s_add_u32 m0, s100, 70656
    s_add_u32 s18, s99, 98304
    buffer_load_dwordx4 v4, s[20:23], s18 offen lds
    v_mfma_f32_16x16x32_bf16 a[244:247], a[240:243], v[100:103], a[244:247]
    s_waitcnt lgkmcnt(6)
    v_mfma_f32_32x32x16_bf16 v[176:191], v[168:171], v[104:107], v[176:191]
    ds_read_b128 v[164:167], v9 offset:49152
    s_waitcnt vmcnt(9)
    ds_read_b64_tr_b16 v[112:113], v12 offset:32768
    v_dot2c_f32_bf16 v18, v104, v104
    v_dot2c_f32_bf16 v14, v105, v105
    v_dot2c_f32_bf16 v18, v106, v106
    v_dot2c_f32_bf16 v14, v107, v107
    v_mfma_f32_32x32x16_bf16 v[192:207], v[172:175], v[104:107], v[192:207]
    ds_read_b128 v[168:171], v9 offset:53248
    ds_read_b64_tr_b16 v[114:115], v12 offset:33024
    v_mfma_f32_32x32x16_bf16 v[208:223], v[144:147], v[104:107], v[208:223]
    ds_read_b128 v[172:175], v9 offset:46080
    s_add_u32 m0, s100, 74752
    s_add_u32 s18, s99, 102400
    buffer_load_dwordx4 v4, s[20:23], s18 offen lds
    v_mfma_f32_16x16x32_bf16 a[244:247], a[240:243], v[104:107], a[244:247]
    s_waitcnt lgkmcnt(6)
PAD_C_35:
    s_cbranch_execz PAD_C_36
    v_mfma_f32_32x32x16_bf16 v[176:191], v[148:151], v[108:111], v[176:191]
    ds_read_b128 v[144:147], v9 offset:50176
    s_waitcnt vmcnt(9)
    ds_read_b64_tr_b16 v[116:117], v12 offset:36864
    v_dot2c_f32_bf16 v18, v108, v108
    v_dot2c_f32_bf16 v14, v109, v109
    v_dot2c_f32_bf16 v18, v110, v110
    v_dot2c_f32_bf16 v14, v111, v111
    v_mfma_f32_32x32x16_bf16 v[192:207], v[152:155], v[108:111], v[192:207]
    ds_read_b128 v[148:151], v9 offset:54272
    ds_read_b64_tr_b16 v[118:119], v12 offset:37120
    v_mfma_f32_32x32x16_bf16 v[208:223], v[156:159], v[108:111], v[208:223]
    ds_read_b128 v[152:155], v9 offset:47104
    s_add_u32 m0, s100, 78848
    s_add_u32 s18, s99, 106496
    buffer_load_dwordx4 v4, s[20:23], s18 offen lds
    v_mfma_f32_16x16x32_bf16 a[244:247], a[240:243], v[108:111], a[244:247]
    s_waitcnt lgkmcnt(6)
    v_mfma_f32_32x32x16_bf16 v[176:191], v[160:163], v[112:115], v[176:191]
    ds_read_b128 v[156:159], v9 offset:51200
    s_waitcnt vmcnt(9)
    ds_read_b64_tr_b16 v[120:121], v12 offset:40960
    v_dot2c_f32_bf16 v18, v112, v112
    v_dot2c_f32_bf16 v14, v113, v113
    v_dot2c_f32_bf16 v18, v114, v114
    v_dot2c_f32_bf16 v14, v115, v115
    v_mfma_f32_32x32x16_bf16 v[192:207], v[164:167], v[112:115], v[192:207]
    ds_read_b128 v[160:163], v9 offset:55296
    ds_read_b64_tr_b16 v[122:123], v12 offset:41216
    v_mfma_f32_32x32x16_bf16 v[208:223], v[168:171], v[112:115], v[208:223]
    ds_read_b128 v[164:167], v9 offset:48128
    s_add_u32 m0, s100, 82944
    s_add_u32 s18, s99, 110592
    buffer_load_dwordx4 v4, s[20:23], s18 offen lds
    v_mfma_f32_16x16x32_bf16 a[244:247], a[240:243], v[112:115], a[244:247]
    s_waitcnt lgkmcnt(6)
PAD_C_36:
    s_cbranch_execz PRET_C
    v_mfma_f32_32x32x16_bf16 v[176:191], v[172:175], v[116:119], v[176:191]
    ds_read_b128 v[168:171], v9 offset:52224
    s_waitcnt vmcnt(9)
    ds_read_b64_tr_b16 v[124:125], v12 offset:45056
    v_dot2c_f32_bf16 v18, v116, v116
    v_dot2c_f32_bf16 v14, v117, v117
    v_dot2c_f32_bf16 v18, v118, v118
    v_dot2c_f32_bf16 v14, v119, v119
    v_mfma_f32_32x32x16_bf16 v[192:207], v[144:147], v[116:119], v[192:207]
    ds_read_b128 v[172:175], v9 offset:56320
    ds_read_b64_tr_b16 v[126:127], v12 offset:45312
    v_mfma_f32_32x32x16_bf16 v[208:223], v[148:151], v[116:119], v[208:223]
    ds_read_b128 v[144:147], v9 offset:57344
    s_add_u32 m0, s100, 87040
    s_add_u32 s18, s99, 114688
    buffer_load_dwordx4 v4, s[20:23], s18 offen lds
    v_mfma_f32_16x16x32_bf16 a[244:247], a[240:243], v[116:119], a[244:247]
    s_waitcnt lgkmcnt(6)
    v_mfma_f32_32x32x16_bf16 v[176:191], v[152:155], v[120:123], v[176:191]
    ds_read_b128 v[148:151], v9 offset:61440
    s_waitcnt vmcnt(9)
    ds_read_b64_tr_b16 v[128:129], v12 offset:0
    v_dot2c_f32_bf16 v18, v120, v120
    v_dot2c_f32_bf16 v14, v121, v121
    v_dot2c_f32_bf16 v18, v122, v122
    v_dot2c_f32_bf16 v14, v123, v123
    v_mfma_f32_32x32x16_bf16 v[192:207], v[156:159], v[120:123], v[192:207]
    ds_read_b128 v[152:155], v10 offset:0
    ds_read_b64_tr_b16 v[130:131], v12 offset:256
    v_mfma_f32_32x32x16_bf16 v[208:223], v[160:163], v[120:123], v[208:223]
    ds_read_b128 v[156:159], v9 offset:58368
    s_add_u32 m0, s100, 91136
    s_add_u32 s18, s99, 118784
    buffer_load_dwordx4 v4, s[20:23], s18 offen lds
    v_mfma_f32_16x16x32_bf16 a[244:247], a[240:243], v[120:123], a[244:247]
    s_waitcnt lgkmcnt(6)
PAD_C_37:
    s_cbranch_execz PAD_C_38
    v_mfma_f32_32x32x16_bf16 v[176:191], v[164:167], v[124:127], v[176:191]
    ds_read_b128 v[160:163], v9 offset:62464
    s_waitcnt vmcnt(9)
    ds_read_b64_tr_b16 v[132:133], v12 offset:4096
    v_dot2c_f32_bf16 v18, v124, v124
    v_dot2c_f32_bf16 v14, v125, v125
    v_dot2c_f32_bf16 v18, v126, v126
    v_dot2c_f32_bf16 v14, v127, v127
    v_mfma_f32_32x32x16_bf16 v[192:207], v[168:171], v[124:127], v[192:207]
    ds_read_b128 v[164:167], v10 offset:1024
    ds_read_b64_tr_b16 v[134:135], v12 offset:4352
    v_mfma_f32_32x32x16_bf16 v[208:223], v[172:175], v[124:127], v[208:223]
    ds_read_b128 v[168:171], v9 offset:59392
    s_add_u32 m0, s100, 95232
    s_add_u32 s18, s99, 122880
    buffer_load_dwordx4 v4, s[20:23], s18 offen lds
    v_mfma_f32_16x16x32_bf16 a[244:247], a[240:243], v[124:127], a[244:247]
    s_waitcnt lgkmcnt(6)
    v_mfma_f32_32x32x16_bf16 v[176:191], v[144:147], v[128:131], v[176:191]
    ds_read_b128 v[172:175], v9 offset:63488
    s_waitcnt vmcnt(9)
    ds_read_b64_tr_b16 v[136:137], v12 offset:8192
    v_dot2c_f32_bf16 v18, v128, v128
    v_dot2c_f32_bf16 v14, v129, v129
    v_dot2c_f32_bf16 v18, v130, v130
    v_dot2c_f32_bf16 v14, v131, v131
    v_mfma_f32_32x32x16_bf16 v[192:207], v[148:151], v[128:131], v[192:207]
    ds_read_b128 v[144:147], v10 offset:2048
    ds_read_b64_tr_b16 v[138:139], v12 offset:8448
    v_mfma_f32_32x32x16_bf16 v[208:223], v[152:155], v[128:131], v[208:223]
    ds_read_b128 v[148:151], v9 offset:60416
    s_add_u32 m0, s100, 99328
    s_add_u32 s18, s99, 126976
    buffer_load_dwordx4 v4, s[20:23], s18 offen lds
    v_mfma_f32_16x16x32_bf16 a[244:247], a[240:243], v[128:131], a[244:247]
    s_waitcnt lgkmcnt(6)
PAD_C_38:
    s_cbranch_execz PAD_C_39
    v_mfma_f32_32x32x16_bf16 v[176:191], v[156:159], v[132:135], v[176:191]
    ds_read_b128 v[152:155], v9 offset:64512
    s_waitcnt vmcnt(9)
    ds_read_b64_tr_b16 v[140:141], v12 offset:12288
    v_dot2c_f32_bf16 v18, v132, v132
    v_dot2c_f32_bf16 v14, v133, v133
    v_dot2c_f32_bf16 v18, v134, v134
    v_dot2c_f32_bf16 v14, v135, v135
    v_mfma_f32_32x32x16_bf16 v[192:207], v[160:163], v[132:135], v[192:207]
    ds_read_b128 v[156:159], v10 offset:3072
    ds_read_b64_tr_b16 v[142:143], v12 offset:12544
    v_mfma_f32_32x32x16_bf16 v[208:223], v[164:167], v[132:135], v[208:223]
    ds_read_b128 v[160:163], v10 offset:4096
    s_add_u32 m0, s100, 103424
    s_add_u32 s18, s99, 131072
    buffer_load_dwordx4 v4, s[20:23], s18 offen lds
    v_mfma_f32_16x16x32_bf16 a[244:247], a[240:243], v[132:135], a[244:247]
    s_waitcnt lgkmcnt(6)
    v_mfma_f32_32x32x16_bf16 v[176:191], v[168:171], v[136:139], v[176:191]
    ds_read_b128 v[164:167], v10 offset:5120
    v_dot2c_f32_bf16 v18, v136, v136
    v_dot2c_f32_bf16 v14, v137, v137
    v_dot2c_f32_bf16 v18, v138, v138
    v_dot2c_f32_bf16 v14, v139, v139
    v_mfma_f32_32x32x16_bf16 v[192:207], v[172:175], v[136:139], v[192:207]
    ds_read_b128 v[168:171], v10 offset:6144
    v_mfma_f32_32x32x16_bf16 v[208:223], v[144:147], v[136:139], v[208:223]
    ds_read_b128 v[172:175], v10 offset:7168
    s_add_u32 m0, s100, 107520
    s_add_u32 s18, s99, 135168
    buffer_load_dwordx4 v4, s[20:23], s18 offen lds
    v_mfma_f32_16x16x32_bf16 a[244:247], a[240:243], v[136:139], a[244:247]
    s_waitcnt lgkmcnt(4)
    v_mfma_f32_32x32x16_bf16 v[176:191], v[148:151], v[140:143], v[176:191]
    ds_read_b128 v[144:147], v10 offset:8192
    v_dot2c_f32_bf16 v18, v140, v140
    v_dot2c_f32_bf16 v14, v141, v141
    v_dot2c_f32_bf16 v18, v142, v142
    v_dot2c_f32_bf16 v14, v143, v143
    v_mfma_f32_32x32x16_bf16 v[192:207], v[152:155], v[140:143], v[192:207]
    ds_read_b128 v[148:151], v10 offset:9216
    v_mfma_f32_32x32x16_bf16 v[208:223], v[156:159], v[140:143], v[208:223]
    ds_read_b128 v[152:155], v10 offset:10240
    s_add_u32 m0, s100, 111616
    s_add_u32 s18, s99, 139264
    buffer_load_dwordx4 v4, s[20:23], s18 offen lds
    v_mfma_f32_16x16x32_bf16 a[244:247], a[240:243], v[140:143], a[244:247]
    s_waitcnt vmcnt(6)
PAD_C_39:
    s_cbranch_execz PAD_C_40
    s_barrier
    s_waitcnt lgkmcnt(3)
    v_mfma_f32_32x32x16_bf16 v[224:239], v[160:163], v[32:35], 0
    ds_read_b128 v[156:159], v10 offset:11264
    s_nop 2
    v_accvgpr_read_b32 v17, a244
    v_add_f32 v18, v18, v14
    v_mov_b32 v13, v18
    s_nop 1
    v_permlane32_swap_b32 v18, v13
    v_add_f32 v18, v18, v13
    v_mfma_f32_32x32x16_bf16 v[224:239], v[164:167], v[36:39], v[224:239]
    ds_read_b128 v[160:163], v8 offset:49152
    s_add_u32 m0, s100, 17408
    s_add_u32 s18, s99, 143360
    buffer_load_dwordx4 v4, s[20:23], s18 offen lds
    v_mul_f32 v17, 0x3b124925, v17
    v_mul_f32 v18, 0x3b124925, v18
    v_fma_f32 v18, -v17, v17, v18
    v_max_f32 v18, 0, v18
    v_cvt_pk_bf16_f32 v19, v18, v18
    v_lshlrev_b32 v18, 16, v19
    v_mfma_f32_32x32x16_bf16 v[224:239], v[168:171], v[40:43], v[224:239]
    ds_read_b128 v[164:167], v8 offset:50176
    v_add_f32 v18, 0x3727c5ac, v18
    v_cvt_pk_bf16_f32 v19, v18, v18
    v_lshlrev_b32 v18, 16, v19
    v_sqrt_f32 v18, v18
    s_nop 0
    v_cvt_pk_bf16_f32 v19, v18, v18
    v_lshlrev_b32 v21, 16, v19
    v_rcp_f32 v20, v21
    s_nop 0
    v_mul_f32 v20, 0xbfb8aa3b, v20
    v_mul_f32 v176, v176, v20
    v_mfma_f32_32x32x16_bf16 v[224:239], v[172:175], v[44:47], v[224:239]
    ds_read_b128 v[168:171], v8 offset:51200
    v_mul_f32 v177, v177, v20
    v_mul_f32 v178, v178, v20
    v_mul_f32 v179, v179, v20
    v_mul_f32 v180, v180, v20
    v_mul_f32 v181, v181, v20
    v_mul_f32 v182, v182, v20
    v_mul_f32 v183, v183, v20
    v_exp_f32 v176, v176
    v_exp_f32 v177, v177
    s_waitcnt lgkmcnt(3)
    v_mfma_f32_32x32x16_bf16 v[224:239], v[144:147], v[48:51], v[224:239]
    ds_read_b128 v[172:175], v8 offset:52224
    s_add_u32 m0, s100, 21504
    s_add_u32 s18, s99, 147456
    buffer_load_dwordx4 v4, s[20:23], s18 offen lds
    v_mfma_f32_32x32x16_bf16 v[224:239], v[148:151], v[52:55], v[224:239]
PAD_C_40:
    s_cbranch_execz PRET_C
    ds_read_b128 v[144:147], v8 offset:53248
    v_exp_f32 v178, v178
    v_exp_f32 v179, v179
    v_mfma_f32_32x32x16_bf16 v[224:239], v[152:155], v[56:59], v[224:239]
    ds_read_b128 v[148:151], v8 offset:54272
    v_exp_f32 v180, v180
    v_exp_f32 v181, v181
    v_mfma_f32_32x32x16_bf16 v[224:239], v[156:159], v[60:63], v[224:239]
    ds_read_b128 v[152:155], v8 offset:55296
    s_add_u32 m0, s100, 25600
    s_add_u32 s18, s99, 151552
    buffer_load_dwordx4 v4, s[20:23], s18 offen lds
    s_waitcnt lgkmcnt(3)
    v_mfma_f32_32x32x16_bf16 v[224:239], v[160:163], v[64:67], v[224:239]
    ds_read_b128 v[156:159], v8 offset:56320
    v_exp_f32 v182, v182
    v_exp_f32 v183, v183
    v_mfma_f32_32x32x16_bf16 v[224:239], v[164:167], v[68:71], v[224:239]
    ds_read_b128 v[160:163], v8 offset:57344
    v_fma_f32 v176, v176, v21, v21
    v_fma_f32 v177, v177, v21, v21
    v_fma_f32 v178, v178, v21, v21
    v_fma_f32 v179, v179, v21, v21
    v_fma_f32 v180, v180, v21, v21
    v_mfma_f32_32x32x16_bf16 v[224:239], v[168:171], v[72:75], v[224:239]
    ds_read_b128 v[164:167], v8 offset:58368
    s_add_u32 m0, s100, 29696
    s_add_u32 s18, s99, 155648
    buffer_load_dwordx4 v4, s[20:23], s18 offen lds
    v_mfma_f32_32x32x16_bf16 v[224:239], v[172:175], v[76:79], v[224:239]
    ds_read_b128 v[168:171], v8 offset:59392
    v_fma_f32 v181, v181, v21, v21
    v_fma_f32 v182, v182, v21, v21
    v_fma_f32 v183, v183, v21, v21
    v_rcp_f32 v176, v176
    s_waitcnt lgkmcnt(3)
    v_mfma_f32_32x32x16_bf16 v[224:239], v[144:147], v[80:83], v[224:239]
    ds_read_b128 v[172:175], v8 offset:60416
    v_rcp_f32 v177, v177
    v_rcp_f32 v178, v178
PAD_C_41:
    s_cbranch_execz PAD_C_42
    v_mfma_f32_32x32x16_bf16 v[224:239], v[148:151], v[84:87], v[224:239]
    ds_read_b128 v[144:147], v8 offset:61440
    s_add_u32 m0, s100, 33792
    s_add_u32 s18, s99, 159744
    buffer_load_dwordx4 v4, s[20:23], s18 offen lds
    v_mfma_f32_32x32x16_bf16 v[224:239], v[152:155], v[88:91], v[224:239]
    ds_read_b128 v[148:151], v8 offset:62464
    v_rcp_f32 v179, v179
    v_rcp_f32 v180, v180
    v_mfma_f32_32x32x16_bf16 v[224:239], v[156:159], v[92:95], v[224:239]
    ds_read_b128 v[152:155], v8 offset:63488
    v_rcp_f32 v181, v181
    v_rcp_f32 v182, v182
    s_waitcnt lgkmcnt(3)
    v_mfma_f32_32x32x16_bf16 v[224:239], v[160:163], v[96:99], v[224:239]
    ds_read_b128 v[156:159], v8 offset:64512
    s_add_u32 m0, s100, 37888
    s_add_u32 s18, s99, 163840
    buffer_load_dwordx4 v4, s[20:23], s18 offen lds
    v_mfma_f32_32x32x16_bf16 v[224:239], v[164:167], v[100:103], v[224:239]
    ds_read_b128 v[160:163], v9 offset:0
    v_rcp_f32 v183, v183
    v_mul_f32 v184, v184, v176
    v_mul_f32 v185, v185, v177
    v_mul_f32 v186, v186, v178
    v_mfma_f32_32x32x16_bf16 v[224:239], v[168:171], v[104:107], v[224:239]
    ds_read_b128 v[164:167], v9 offset:1024
    v_mul_f32 v187, v187, v179
    v_mul_f32 v188, v188, v180
    v_mul_f32 v189, v189, v181
    v_mul_f32 v190, v190, v182
    v_mul_f32 v191, v191, v183
    v_mfma_f32_32x32x16_bf16 v[224:239], v[172:175], v[108:111], v[224:239]
    ds_read_b128 v[168:171], v9 offset:2048
    s_add_u32 m0, s100, 41984
    s_add_u32 s18, s99, 167936
    buffer_load_dwordx4 v4, s[20:23], s18 offen lds
    s_waitcnt lgkmcnt(3)
    v_mfma_f32_32x32x16_bf16 v[224:239], v[144:147], v[112:115], v[224:239]
    ds_read_b128 v[172:175], v9 offset:3072
    v_cvt_pk_bf16_f32 v24, v184, v185
    v_cvt_pk_bf16_f32 v25, v186, v187
    v_cvt_pk_bf16_f32 v26, v188, v189
    v_cvt_pk_bf16_f32 v27, v190, v191
PAD_C_42:
    s_cbranch_execz PAD_C_43
    v_mfma_f32_32x32x16_bf16 v[224:239], v[148:151], v[116:119], v[224:239]
    ds_read_b128 v[144:147], v9 offset:4096
    buffer_store_dwordx4 v[24:27], v4, s[20:23], s19 offen sc1
    v_mul_f32 v192, v192, v20
    v_mul_f32 v193, v193, v20
    v_mul_f32 v194, v194, v20
    v_mfma_f32_32x32x16_bf16 v[224:239], v[152:155], v[120:123], v[224:239]
    ds_read_b128 v[148:151], v9 offset:5120
    s_add_u32 m0, s100, 46080
    s_add_u32 s18, s99, 172032
    buffer_load_dwordx4 v4, s[20:23], s18 offen lds
    v_mfma_f32_32x32x16_bf16 v[224:239], v[156:159], v[124:127], v[224:239]
    ds_read_b128 v[152:155], v9 offset:6144
    v_mul_f32 v195, v195, v20
    v_mul_f32 v196, v196, v20
    v_mul_f32 v197, v197, v20
    v_mul_f32 v198, v198, v20
    v_mul_f32 v199, v199, v20
    s_waitcnt lgkmcnt(3)
    v_mfma_f32_32x32x16_bf16 v[224:239], v[160:163], v[128:131], v[224:239]
    ds_read_b128 v[156:159], v9 offset:7168
    v_exp_f32 v192, v192
    v_exp_f32 v193, v193
    v_mfma_f32_32x32x16_bf16 v[224:239], v[164:167], v[132:135], v[224:239]
    s_waitcnt vmcnt(6)
    s_barrier
    ds_read_b128 v[160:163], v9 offset:8192
    s_add_u32 m0, s100, 50176
    s_add_u32 s18, s99, 176128
    buffer_load_dwordx4 v4, s[20:23], s18 offen lds
    v_mfma_f32_32x32x16_bf16 v[224:239], v[168:171], v[136:139], v[224:239]
    ds_read_b128 v[164:167], v9 offset:9216
    v_exp_f32 v194, v194
    v_exp_f32 v195, v195
    v_mfma_f32_32x32x16_bf16 v[224:239], v[172:175], v[140:143], v[224:239]
    ds_read_b128 v[168:171], v9 offset:10240
    v_exp_f32 v196, v196
    v_exp_f32 v197, v197
    v_exp_f32 v198, v198
    v_exp_f32 v199, v199
    v_fma_f32 v192, v192, v21, v21
    v_fma_f32 v193, v193, v21, v21
    s_waitcnt lgkmcnt(3)
    v_mfma_f32_32x32x16_bf16 v[176:191], v[144:147], v[32:35], 0
    ds_read_b128 v[172:175], v9 offset:11264
    s_add_u32 m0, s100, 54272
    s_add_u32 s18, s99, 180224
    buffer_load_dwordx4 v4, s[20:23], s18 offen lds
    v_mfma_f32_32x32x16_bf16 v[176:191], v[148:151], v[36:39], v[176:191]
    ds_read_b128 v[144:147], v9 offset:12288
PAD_C_43:
    s_cbranch_execz PAD_C_44
    v_fma_f32 v194, v194, v21, v21
    v_fma_f32 v195, v195, v21, v21
    v_fma_f32 v196, v196, v21, v21
    v_fma_f32 v197, v197, v21, v21
    v_fma_f32 v198, v198, v21, v21
    v_mfma_f32_32x32x16_bf16 v[176:191], v[152:155], v[40:43], v[176:191]
    ds_read_b128 v[148:151], v9 offset:13312
    v_fma_f32 v199, v199, v21, v21
    v_rcp_f32 v192, v192
    v_rcp_f32 v193, v193
    v_mfma_f32_32x32x16_bf16 v[176:191], v[156:159], v[44:47], v[176:191]
    ds_read_b128 v[152:155], v9 offset:14336
    s_add_u32 m0, s100, 58368
    s_add_u32 s18, s99, 184320
    buffer_load_dwordx4 v4, s[20:23], s18 offen lds
    s_waitcnt lgkmcnt(3)
    v_mfma_f32_32x32x16_bf16 v[176:191], v[160:163], v[48:51], v[176:191]
    ds_read_b128 v[156:159], v9 offset:15360
    v_rcp_f32 v194, v194
    v_rcp_f32 v195, v195
    v_mfma_f32_32x32x16_bf16 v[176:191], v[164:167], v[52:55], v[176:191]
    ds_read_b128 v[160:163], v9 offset:16384
    v_rcp_f32 v196, v196
    v_rcp_f32 v197, v197
    v_mfma_f32_32x32x16_bf16 v[176:191], v[168:171], v[56:59], v[176:191]
    ds_read_b128 v[164:167], v9 offset:17408
    s_add_u32 m0, s100, 62464
    s_add_u32 s18, s99, 188416
    buffer_load_dwordx4 v4, s[20:23], s18 offen lds
    v_mfma_f32_32x32x16_bf16 v[176:191], v[172:175], v[60:63], v[176:191]
    ds_read_b128 v[168:171], v9 offset:18432
    v_rcp_f32 v198, v198
    v_rcp_f32 v199, v199
    v_mul_f32 v200, v200, v192
    s_waitcnt lgkmcnt(3)
    v_mfma_f32_32x32x16_bf16 v[176:191], v[144:147], v[64:67], v[176:191]
    ds_read_b128 v[172:175], v9 offset:19456
    v_mul_f32 v201, v201, v193
    v_mul_f32 v202, v202, v194
    v_mul_f32 v203, v203, v195
    v_mul_f32 v204, v204, v196
    v_mfma_f32_32x32x16_bf16 v[176:191], v[148:151], v[68:71], v[176:191]
    ds_read_b128 v[144:147], v9 offset:20480
    s_add_u32 m0, s100, 115712
    s_add_u32 s18, s99, 192512
    buffer_load_dwordx4 v4, s[20:23], s18 offen lds
    v_mfma_f32_32x32x16_bf16 v[176:191], v[152:155], v[72:75], v[176:191]
PAD_C_44:
    s_cbranch_execz PRET_C
    ds_read_b128 v[148:151], v9 offset:21504
    v_mul_f32 v205, v205, v197
    v_mul_f32 v206, v206, v198
    v_mul_f32 v207, v207, v199
    v_cvt_pk_bf16_f32 v28, v200, v201
    v_cvt_pk_bf16_f32 v29, v202, v203
    v_mfma_f32_32x32x16_bf16 v[176:191], v[156:159], v[76:79], v[176:191]
    ds_read_b128 v[152:155], v9 offset:22528
    v_cvt_pk_bf16_f32 v30, v204, v205
    v_cvt_pk_bf16_f32 v31, v206, v207
    buffer_store_dwordx4 v[28:31], v4, s[20:23], s19 offen offset:1024 sc1
    v_mul_f32 v208, v208, v20
    s_waitcnt lgkmcnt(3)
    v_mfma_f32_32x32x16_bf16 v[176:191], v[160:163], v[80:83], v[176:191]
    ds_read_b128 v[156:159], v9 offset:23552
    s_add_u32 m0, s100, 119808
    s_add_u32 s18, s99, 196608
    buffer_load_dwordx4 v4, s[20:23], s18 offen lds
    v_mfma_f32_32x32x16_bf16 v[176:191], v[164:167], v[84:87], v[176:191]
    ds_read_b128 v[160:163], v9 offset:24576
    v_mul_f32 v209, v209, v20
    v_mul_f32 v210, v210, v20
    v_mul_f32 v211, v211, v20
    v_mul_f32 v212, v212, v20
    v_mul_f32 v213, v213, v20
    v_mfma_f32_32x32x16_bf16 v[176:191], v[168:171], v[88:91], v[176:191]
    ds_read_b128 v[164:167], v9 offset:25600
    v_mul_f32 v214, v214, v20
    v_mul_f32 v215, v215, v20
    v_exp_f32 v208, v208
    v_mfma_f32_32x32x16_bf16 v[176:191], v[172:175], v[92:95], v[176:191]
    ds_read_b128 v[168:171], v9 offset:26624
    v_exp_f32 v209, v209
    v_exp_f32 v210, v210
    s_waitcnt lgkmcnt(3)
    v_mfma_f32_32x32x16_bf16 v[176:191], v[144:147], v[96:99], v[176:191]
    ds_read_b128 v[172:175], v9 offset:27648
    v_exp_f32 v211, v211
    v_exp_f32 v212, v212
    v_mfma_f32_32x32x16_bf16 v[176:191], v[148:151], v[100:103], v[176:191]
    ds_read_b128 v[144:147], v9 offset:28672
    v_exp_f32 v213, v213
    v_exp_f32 v214, v214
    v_mfma_f32_32x32x16_bf16 v[176:191], v[152:155], v[104:107], v[176:191]
    ds_read_b128 v[148:151], v9 offset:29696
    v_exp_f32 v215, v215
    v_fma_f32 v208, v208, v21, v21
    v_fma_f32 v209, v209, v21, v21
    v_fma_f32 v210, v210, v21, v21
    v_mfma_f32_32x32x16_bf16 v[176:191], v[156:159], v[108:111], v[176:191]
PAD_C_45:
    s_cbranch_execz PAD_C_46
    ds_read_b128 v[152:155], v9 offset:30720
    v_fma_f32 v211, v211, v21, v21
    v_fma_f32 v212, v212, v21, v21
    v_fma_f32 v213, v213, v21, v21
    v_fma_f32 v214, v214, v21, v21
    v_fma_f32 v215, v215, v21, v21
    s_waitcnt lgkmcnt(3)
    v_mfma_f32_32x32x16_bf16 v[176:191], v[160:163], v[112:115], v[176:191]
    ds_read_b128 v[156:159], v9 offset:31744
    v_rcp_f32 v208, v208
    v_rcp_f32 v209, v209
    v_mfma_f32_32x32x16_bf16 v[176:191], v[164:167], v[116:119], v[176:191]
    ds_read_b128 v[160:163], v8 offset:0
    v_rcp_f32 v210, v210
    v_rcp_f32 v211, v211
    v_mfma_f32_32x32x16_bf16 v[176:191], v[168:171], v[120:123], v[176:191]
    ds_read_b128 v[164:167], v8 offset:1024
    v_rcp_f32 v212, v212
    v_rcp_f32 v213, v213
    v_mfma_f32_32x32x16_bf16 v[176:191], v[172:175], v[124:127], v[176:191]
    ds_read_b128 v[168:171], v8 offset:2048
    v_rcp_f32 v214, v214
    v_rcp_f32 v215, v215
    v_mul_f32 v216, v216, v208
    s_waitcnt lgkmcnt(3)
    v_mfma_f32_32x32x16_bf16 v[176:191], v[144:147], v[128:131], v[176:191]
    ds_read_b128 v[172:175], v8 offset:3072
    v_mul_f32 v217, v217, v209
    v_mul_f32 v218, v218, v210
    v_mul_f32 v219, v219, v211
    v_mul_f32 v220, v220, v212
    v_mfma_f32_32x32x16_bf16 v[176:191], v[148:151], v[132:135], v[176:191]
    ds_read_b128 v[144:147], v8 offset:4096
    v_mul_f32 v221, v221, v213
    v_mul_f32 v222, v222, v214
    v_mul_f32 v223, v223, v215
    v_cvt_pk_bf16_f32 v24, v216, v217
    v_cvt_pk_bf16_f32 v25, v218, v219
PAD_C_46:
    s_cbranch_execz PAD_C_47
    v_mfma_f32_32x32x16_bf16 v[176:191], v[152:155], v[136:139], v[176:191]
    ds_read_b128 v[148:151], v8 offset:5120
    v_cvt_pk_bf16_f32 v26, v220, v221
    v_cvt_pk_bf16_f32 v27, v222, v223
    buffer_store_dwordx4 v[24:27], v4, s[20:23], s19 offen offset:2048 sc1
    v_mul_f32 v224, v224, v20
    v_mfma_f32_32x32x16_bf16 v[176:191], v[156:159], v[140:143], v[176:191]
    ds_read_b128 v[152:155], v8 offset:6144
    v_mul_f32 v225, v225, v20
    v_mul_f32 v226, v226, v20
    v_mul_f32 v227, v227, v20
    v_mul_f32 v228, v228, v20
    v_mul_f32 v229, v229, v20
    v_mul_f32 v230, v230, v20
    v_mul_f32 v231, v231, v20
    v_exp_f32 v224, v224
    v_exp_f32 v225, v225
    s_waitcnt lgkmcnt(3)
    v_mfma_f32_32x32x16_bf16 v[192:207], v[160:163], v[32:35], 0
    ds_read_b128 v[156:159], v8 offset:7168
    v_exp_f32 v226, v226
    v_exp_f32 v227, v227
    v_mfma_f32_32x32x16_bf16 v[192:207], v[164:167], v[36:39], v[192:207]
    ds_read_b128 v[160:163], v8 offset:8192
    v_exp_f32 v228, v228
    v_exp_f32 v229, v229
    v_mfma_f32_32x32x16_bf16 v[192:207], v[168:171], v[40:43], v[192:207]
    ds_read_b128 v[164:167], v8 offset:9216
    v_exp_f32 v230, v230
    v_exp_f32 v231, v231
    v_fma_f32 v224, v224, v21, v21
    v_mfma_f32_32x32x16_bf16 v[192:207], v[172:175], v[44:47], v[192:207]
    ds_read_b128 v[168:171], v8 offset:10240
    v_fma_f32 v225, v225, v21, v21
    v_fma_f32 v226, v226, v21, v21
    v_fma_f32 v227, v227, v21, v21
    v_fma_f32 v228, v228, v21, v21
    v_fma_f32 v229, v229, v21, v21
    s_waitcnt lgkmcnt(3)
    v_mfma_f32_32x32x16_bf16 v[192:207], v[144:147], v[48:51], v[192:207]
    ds_read_b128 v[172:175], v8 offset:11264
    v_fma_f32 v230, v230, v21, v21
    v_fma_f32 v231, v231, v21, v21
    v_rcp_f32 v224, v224
    v_mfma_f32_32x32x16_bf16 v[192:207], v[148:151], v[52:55], v[192:207]
    s_waitcnt vmcnt(1)
    s_barrier
    ds_read_b128 v[144:147], v8 offset:12288
    v_rcp_f32 v225, v225
PAD_C_47:
    s_cbranch_execz PAD_C_48
    v_mfma_f32_32x32x16_bf16 v[192:207], v[152:155], v[56:59], v[192:207]
    ds_read_b128 v[148:151], v8 offset:13312
    v_rcp_f32 v226, v226
    v_rcp_f32 v227, v227
    v_mfma_f32_32x32x16_bf16 v[192:207], v[156:159], v[60:63], v[192:207]
    ds_read_b128 v[152:155], v8 offset:14336
    v_rcp_f32 v228, v228
    v_rcp_f32 v229, v229
    s_waitcnt lgkmcnt(3)
    v_mfma_f32_32x32x16_bf16 v[192:207], v[160:163], v[64:67], v[192:207]
    ds_read_b128 v[156:159], v8 offset:15360
    v_rcp_f32 v230, v230
    v_rcp_f32 v231, v231
    v_mfma_f32_32x32x16_bf16 v[192:207], v[164:167], v[68:71], v[192:207]
    ds_read_b128 v[160:163], v8 offset:16384
    v_mul_f32 v232, v232, v224
    v_mul_f32 v233, v233, v225
    v_mul_f32 v234, v234, v226
    v_mul_f32 v235, v235, v227
    v_mul_f32 v236, v236, v228
    v_mfma_f32_32x32x16_bf16 v[192:207], v[168:171], v[72:75], v[192:207]
    ds_read_b128 v[164:167], v8 offset:17408
    v_mul_f32 v237, v237, v229
    v_mul_f32 v238, v238, v230
    v_mul_f32 v239, v239, v231
    v_cvt_pk_bf16_f32 v28, v232, v233
    v_cvt_pk_bf16_f32 v29, v234, v235
    v_mfma_f32_32x32x16_bf16 v[192:207], v[172:175], v[76:79], v[192:207]
    ds_read_b128 v[168:171], v8 offset:18432
    v_cvt_pk_bf16_f32 v30, v236, v237
    v_cvt_pk_bf16_f32 v31, v238, v239
    buffer_store_dwordx4 v[28:31], v4, s[20:23], s19 offen offset:3072 sc1
    v_mul_f32 v176, v176, v20
    s_waitcnt lgkmcnt(3)
    v_mfma_f32_32x32x16_bf16 v[192:207], v[144:147], v[80:83], v[192:207]
    ds_read_b128 v[172:175], v8 offset:19456
    v_mul_f32 v177, v177, v20
    v_mul_f32 v178, v178, v20
    v_mul_f32 v179, v179, v20
    v_mul_f32 v180, v180, v20
    v_mfma_f32_32x32x16_bf16 v[192:207], v[148:151], v[84:87], v[192:207]
    ds_read_b128 v[144:147], v8 offset:20480
    v_mul_f32 v181, v181, v20
    v_mul_f32 v182, v182, v20
    v_mul_f32 v183, v183, v20
    v_exp_f32 v176, v176
    v_mfma_f32_32x32x16_bf16 v[192:207], v[152:155], v[88:91], v[192:207]
    ds_read_b128 v[148:151], v8 offset:21504
    v_exp_f32 v177, v177
    v_exp_f32 v178, v178
    v_mfma_f32_32x32x16_bf16 v[192:207], v[156:159], v[92:95], v[192:207]
    ds_read_b128 v[152:155], v8 offset:22528
    v_exp_f32 v179, v179
    v_exp_f32 v180, v180
    s_waitcnt lgkmcnt(3)
PAD_C_48:
    s_cbranch_execz PAD_C_49
    v_mfma_f32_32x32x16_bf16 v[192:207], v[160:163], v[96:99], v[192:207]
    ds_read_b128 v[156:159], v8 offset:23552
    v_exp_f32 v181, v181
    v_exp_f32 v182, v182
    v_mfma_f32_32x32x16_bf16 v[192:207], v[164:167], v[100:103], v[192:207]
    ds_read_b128 v[160:163], v8 offset:24576
    v_exp_f32 v183, v183
    v_fma_f32 v176, v176, v21, v21
    v_fma_f32 v177, v177, v21, v21
    v_fma_f32 v178, v178, v21, v21
    v_mfma_f32_32x32x16_bf16 v[192:207], v[168:171], v[104:107], v[192:207]
    ds_read_b128 v[164:167], v8 offset:25600
    v_fma_f32 v179, v179, v21, v21
    v_fma_f32 v180, v180, v21, v21
    v_fma_f32 v181, v181, v21, v21
    v_fma_f32 v182, v182, v21, v21
    v_fma_f32 v183, v183, v21, v21
    v_mfma_f32_32x32x16_bf16 v[192:207], v[172:175], v[108:111], v[192:207]
    ds_read_b128 v[168:171], v8 offset:26624
    v_rcp_f32 v176, v176
    v_rcp_f32 v177, v177
    s_waitcnt lgkmcnt(3)
    v_mfma_f32_32x32x16_bf16 v[192:207], v[144:147], v[112:115], v[192:207]
    ds_read_b128 v[172:175], v8 offset:27648
    v_rcp_f32 v178, v178
    v_rcp_f32 v179, v179
    v_mfma_f32_32x32x16_bf16 v[192:207], v[148:151], v[116:119], v[192:207]
    ds_read_b128 v[144:147], v8 offset:28672
    v_rcp_f32 v180, v180
    v_rcp_f32 v181, v181
    v_mfma_f32_32x32x16_bf16 v[192:207], v[152:155], v[120:123], v[192:207]
    ds_read_b128 v[148:151], v8 offset:29696
    v_rcp_f32 v182, v182
    v_rcp_f32 v183, v183
    v_mul_f32 v184, v184, v176
    v_mfma_f32_32x32x16_bf16 v[192:207], v[156:159], v[124:127], v[192:207]
    ds_read_b128 v[152:155], v8 offset:30720
    v_mul_f32 v185, v185, v177
    v_mul_f32 v186, v186, v178
    v_mul_f32 v187, v187, v179
    v_mul_f32 v188, v188, v180
    v_mul_f32 v189, v189, v181
    s_waitcnt lgkmcnt(3)
    v_mfma_f32_32x32x16_bf16 v[192:207], v[160:163], v[128:131], v[192:207]
    ds_read_b128 v[156:159], v8 offset:31744
    v_mul_f32 v190, v190, v182
    v_mul_f32 v191, v191, v183
    v_cvt_pk_bf16_f32 v24, v184, v185
    v_cvt_pk_bf16_f32 v25, v186, v187
PAD_C_49:
    s_cbranch_execz PRET_C
    v_mfma_f32_32x32x16_bf16 v[192:207], v[164:167], v[132:135], v[192:207]
    ds_read_b128 v[160:163], v8 offset:32768
    v_cvt_pk_bf16_f32 v26, v188, v189
    v_cvt_pk_bf16_f32 v27, v190, v191
    buffer_store_dwordx4 v[24:27], v22, s[20:23], s19 offen sc1
    v_mfma_f32_32x32x16_bf16 v[192:207], v[168:171], v[136:139], v[192:207]
    ds_read_b128 v[164:167], v8 offset:33792
    v_mfma_f32_32x32x16_bf16 v[192:207], v[172:175], v[140:143], v[192:207]
    ds_read_b128 v[168:171], v8 offset:34816
    s_waitcnt lgkmcnt(3)
    v_mfma_f32_32x32x16_bf16 v[208:223], v[144:147], v[32:35], 0
    ds_read_b128 v[172:175], v8 offset:35840
    v_mfma_f32_32x32x16_bf16 v[208:223], v[148:151], v[36:39], v[208:223]
    ds_read_b128 v[144:147], v8 offset:36864
    buffer_load_dwordx4 v[32:35], v4, s[20:23], s32 offen
    v_mfma_f32_32x32x16_bf16 v[208:223], v[152:155], v[40:43], v[208:223]
    ds_read_b128 v[148:151], v8 offset:37888
    v_mfma_f32_32x32x16_bf16 v[208:223], v[156:159], v[44:47], v[208:223]
    ds_read_b128 v[152:155], v8 offset:38912
    buffer_load_dwordx4 v[36:39], v4, s[20:23], s56 offen
    s_waitcnt lgkmcnt(3)
    v_mfma_f32_32x32x16_bf16 v[208:223], v[160:163], v[48:51], v[208:223]
    ds_read_b128 v[156:159], v8 offset:39936
    v_mul_f32 v192, v192, v20
    v_mul_f32 v193, v193, v20
    v_mul_f32 v194, v194, v20
    v_mul_f32 v195, v195, v20
    v_mfma_f32_32x32x16_bf16 v[208:223], v[164:167], v[52:55], v[208:223]
    ds_read_b128 v[160:163], v8 offset:40960
    buffer_load_dwordx4 v[40:43], v4, s[20:23], s33 offen
    v_mul_f32 v196, v196, v20
    v_mul_f32 v197, v197, v20
    v_mul_f32 v198, v198, v20
    v_mfma_f32_32x32x16_bf16 v[208:223], v[168:171], v[56:59], v[208:223]
    ds_read_b128 v[164:167], v8 offset:41984
    v_mul_f32 v199, v199, v20
    v_exp_f32 v192, v192
    v_exp_f32 v193, v193
    v_mfma_f32_32x32x16_bf16 v[208:223], v[172:175], v[60:63], v[208:223]
    ds_read_b128 v[168:171], v8 offset:43008
    buffer_load_dwordx4 v[44:47], v4, s[20:23], s57 offen
    v_exp_f32 v194, v194
    s_waitcnt lgkmcnt(3)
    v_mfma_f32_32x32x16_bf16 v[208:223], v[144:147], v[64:67], v[208:223]
    ds_read_b128 v[172:175], v8 offset:44032
    v_exp_f32 v195, v195
    v_exp_f32 v196, v196
PAD_C_50:
    s_cbranch_execz PAD_C_51
    v_mfma_f32_32x32x16_bf16 v[208:223], v[148:151], v[68:71], v[208:223]
    ds_read_b128 v[144:147], v8 offset:45056
    buffer_load_dwordx4 v[48:51], v4, s[20:23], s34 offen
    v_exp_f32 v197, v197
    v_mfma_f32_32x32x16_bf16 v[208:223], v[152:155], v[72:75], v[208:223]
    ds_read_b128 v[148:151], v8 offset:46080
    v_exp_f32 v198, v198
    v_exp_f32 v199, v199
    v_fma_f32 v192, v192, v21, v21
    v_mfma_f32_32x32x16_bf16 v[208:223], v[156:159], v[76:79], v[208:223]
    ds_read_b128 v[152:155], v8 offset:47104
    buffer_load_dwordx4 v[52:55], v4, s[20:23], s58 offen
    v_fma_f32 v193, v193, v21, v21
    v_fma_f32 v194, v194, v21, v21
    v_fma_f32 v195, v195, v21, v21
    s_waitcnt lgkmcnt(3)
    v_mfma_f32_32x32x16_bf16 v[208:223], v[160:163], v[80:83], v[208:223]
    ds_read_b128 v[156:159], v8 offset:48128
    v_fma_f32 v196, v196, v21, v21
    v_fma_f32 v197, v197, v21, v21
    v_fma_f32 v198, v198, v21, v21
    v_fma_f32 v199, v199, v21, v21
    v_mfma_f32_32x32x16_bf16 v[208:223], v[164:167], v[84:87], v[208:223]
    ds_read_b128 v[160:163], v9 offset:32768
    buffer_load_dwordx4 v[56:59], v4, s[20:23], s35 offen
    v_rcp_f32 v192, v192
    v_mfma_f32_32x32x16_bf16 v[208:223], v[168:171], v[88:91], v[208:223]
    ds_read_b128 v[164:167], v9 offset:33792
    v_rcp_f32 v193, v193
    v_rcp_f32 v194, v194
    v_mfma_f32_32x32x16_bf16 v[208:223], v[172:175], v[92:95], v[208:223]
    ds_read_b128 v[168:171], v9 offset:34816
    buffer_load_dwordx4 v[60:63], v4, s[20:23], s59 offen
    v_rcp_f32 v195, v195
    s_waitcnt lgkmcnt(3)
    v_mfma_f32_32x32x16_bf16 v[208:223], v[144:147], v[96:99], v[208:223]
    ds_read_b128 v[172:175], v9 offset:35840
    v_rcp_f32 v196, v196
    v_rcp_f32 v197, v197
    v_mfma_f32_32x32x16_bf16 v[208:223], v[148:151], v[100:103], v[208:223]
    ds_read_b128 v[144:147], v9 offset:36864
    buffer_load_dwordx4 v[64:67], v4, s[20:23], s32 offen offset:1024
    v_rcp_f32 v198, v198
    v_mfma_f32_32x32x16_bf16 v[208:223], v[152:155], v[104:107], v[208:223]
    ds_read_b128 v[148:151], v9 offset:37888
    v_rcp_f32 v199, v199
    v_mul_f32 v200, v200, v192
PAD_C_51:
    s_cbranch_execz PAD_C_52
    v_mul_f32 v201, v201, v193
    v_mul_f32 v202, v202, v194
    v_mfma_f32_32x32x16_bf16 v[208:223], v[156:159], v[108:111], v[208:223]
    ds_read_b128 v[152:155], v9 offset:38912
    buffer_load_dwordx4 v[68:71], v4, s[20:23], s56 offen offset:1024
    v_mul_f32 v203, v203, v195
    v_mul_f32 v204, v204, v196
    v_mul_f32 v205, v205, v197
    s_waitcnt lgkmcnt(3)
    v_mfma_f32_32x32x16_bf16 v[208:223], v[160:163], v[112:115], v[208:223]
    ds_read_b128 v[156:159], v9 offset:39936
    v_mul_f32 v206, v206, v198
    v_mul_f32 v207, v207, v199
    v_cvt_pk_bf16_f32 v28, v200, v201
    v_cvt_pk_bf16_f32 v29, v202, v203
    v_mfma_f32_32x32x16_bf16 v[208:223], v[164:167], v[116:119], v[208:223]
    buffer_load_dwordx4 v[72:75], v4, s[20:23], s33 offen offset:1024
    v_cvt_pk_bf16_f32 v30, v204, v205
    v_cvt_pk_bf16_f32 v31, v206, v207
    buffer_store_dwordx4 v[28:31], v22, s[20:23], s19 offen offset:1024 sc1
    v_mfma_f32_32x32x16_bf16 v[208:223], v[168:171], v[120:123], v[208:223]
    v_mfma_f32_32x32x16_bf16 v[208:223], v[172:175], v[124:127], v[208:223]
    buffer_load_dwordx4 v[76:79], v4, s[20:23], s57 offen offset:1024
    s_waitcnt lgkmcnt(0)
    v_mfma_f32_32x32x16_bf16 v[208:223], v[144:147], v[128:131], v[208:223]
    v_mfma_f32_32x32x16_bf16 v[208:223], v[148:151], v[132:135], v[208:223]
    buffer_load_dwordx4 v[80:83], v4, s[20:23], s34 offen offset:1024
    v_mfma_f32_32x32x16_bf16 v[208:223], v[152:155], v[136:139], v[208:223]
    v_mfma_f32_32x32x16_bf16 v[208:223], v[156:159], v[140:143], v[208:223]
    buffer_load_dwordx4 v[84:87], v4, s[20:23], s58 offen offset:1024
    s_cmp_ge_u32 s2, 224
    s_cbranch_scc1 L_SPARE2
    s_waitcnt vmcnt(14)
    v_max3_u32 v13, v32, v33, v34
    s_waitcnt vmcnt(13)
    v_max3_u32 v14, v36, v37, v38
    v_max3_u32 v13, v13, v35, v39
    v_max_u32 v13, v13, v14
    v_cmp_eq_u32 vcc, -1, v13
    s_cbranch_vccnz VSLOW_115
VRET_116:
    v_mfma_f32_32x32x16_bf16 v[176:191], a[0:3], v[32:35], 0
    s_waitcnt vmcnt(12)
    v_max3_u32 v13, v40, v41, v42
    s_waitcnt vmcnt(11)
    v_max3_u32 v14, v44, v45, v46
    v_mul_f32 v208, v208, v20
    v_mul_f32 v209, v209, v20
    v_mul_f32 v210, v210, v20
PAD_C_52:
    s_cbranch_execz PAD_C_53
    v_mfma_f32_32x32x16_bf16 a[240:255], a[4:7], v[32:35], 0
    v_max3_u32 v13, v13, v43, v47
    v_max_u32 v13, v13, v14
    buffer_load_dwordx4 v[88:91], v4, s[20:23], s35 offen offset:1024
    v_mul_f32 v211, v211, v20
    v_mul_f32 v212, v212, v20
    v_mfma_f32_32x32x16_bf16 v[192:207], a[0:3], v[36:39], 0
    v_cmp_eq_u32 vcc, -1, v13
    v_mul_f32 v213, v213, v20
    v_mul_f32 v214, v214, v20
    v_mul_f32 v215, v215, v20
    v_exp_f32 v208, v208
    v_mfma_f32_32x32x16_bf16 v[224:239], a[4:7], v[36:39], 0
    s_cbranch_vccnz VSLOW_117
VRET_118:
    buffer_load_dwordx4 v[92:95], v4, s[20:23], s59 offen offset:1024
    v_exp_f32 v209, v209
    v_mfma_f32_32x32x16_bf16 v[176:191], a[56:59], v[40:43], v[176:191]
    s_waitcnt vmcnt(12)
    v_max3_u32 v13, v48, v49, v50
    s_waitcnt vmcnt(11)
    v_max3_u32 v14, v52, v53, v54
    v_exp_f32 v210, v210
    v_mfma_f32_32x32x16_bf16 a[240:255], a[60:63], v[40:43], a[240:255]
    v_max3_u32 v13, v13, v51, v55
    v_max_u32 v13, v13, v14
    buffer_load_dwordx4 v[96:99], v4, s[20:23], s32 offen offset:2048
    v_exp_f32 v211, v211
    v_mfma_f32_32x32x16_bf16 v[192:207], a[56:59], v[44:47], v[192:207]
    v_cmp_eq_u32 vcc, -1, v13
    v_exp_f32 v212, v212
    v_exp_f32 v213, v213
    v_mfma_f32_32x32x16_bf16 v[224:239], a[60:63], v[44:47], v[224:239]
    s_cbranch_vccnz VSLOW_119
VRET_120:
    buffer_load_dwordx4 v[100:103], v4, s[20:23], s56 offen offset:2048
    v_exp_f32 v214, v214
    v_mfma_f32_32x32x16_bf16 v[176:191], a[112:115], v[48:51], v[176:191]
    s_waitcnt vmcnt(12)
    v_max3_u32 v13, v56, v57, v58
    s_waitcnt vmcnt(11)
    v_max3_u32 v14, v60, v61, v62
    v_exp_f32 v215, v215
    v_fma_f32 v208, v208, v21, v21
PAD_C_53:
    s_cbranch_execz PRET_C
    v_mfma_f32_32x32x16_bf16 a[240:255], a[116:119], v[48:51], a[240:255]
    v_max3_u32 v13, v13, v59, v63
    v_max_u32 v13, v13, v14
    buffer_load_dwordx4 v[104:107], v4, s[20:23], s33 offen offset:2048
    v_fma_f32 v209, v209, v21, v21
    v_fma_f32 v210, v210, v21, v21
    v_mfma_f32_32x32x16_bf16 v[192:207], a[112:115], v[52:55], v[192:207]
    v_cmp_eq_u32 vcc, -1, v13
    v_fma_f32 v211, v211, v21, v21
    v_fma_f32 v212, v212, v21, v21
    v_fma_f32 v213, v213, v21, v21
    v_fma_f32 v214, v214, v21, v21
    v_fma_f32 v215, v215, v21, v21
    v_mfma_f32_32x32x16_bf16 v[224:239], a[116:119], v[52:55], v[224:239]
    s_cbranch_vccnz VSLOW_121
VRET_122:
    buffer_load_dwordx4 v[108:111], v4, s[20:23], s57 offen offset:2048
    v_rcp_f32 v208, v208
    v_mfma_f32_32x32x16_bf16 v[176:191], a[168:171], v[56:59], v[176:191]
    s_waitcnt vmcnt(12)
    v_max3_u32 v13, v64, v65, v66
    s_waitcnt vmcnt(11)
    v_max3_u32 v14, v68, v69, v70
    v_rcp_f32 v209, v209
    v_mfma_f32_32x32x16_bf16 a[240:255], a[172:175], v[56:59], a[240:255]
    v_max3_u32 v13, v13, v67, v71
    v_max_u32 v13, v13, v14
    buffer_load_dwordx4 v[112:115], v4, s[20:23], s34 offen offset:2048
    v_rcp_f32 v210, v210
    v_mfma_f32_32x32x16_bf16 v[192:207], a[168:171], v[60:63], v[192:207]
    v_cmp_eq_u32 vcc, -1, v13
    v_rcp_f32 v211, v211
    v_rcp_f32 v212, v212
    v_mfma_f32_32x32x16_bf16 v[224:239], a[172:175], v[60:63], v[224:239]
    s_cbranch_vccnz VSLOW_123
VRET_124:
    buffer_load_dwordx4 v[116:119], v4, s[20:23], s58 offen offset:2048
    v_rcp_f32 v213, v213
    v_mfma_f32_32x32x16_bf16 v[176:191], a[8:11], v[64:67], v[176:191]
    s_waitcnt vmcnt(12)
    v_max3_u32 v13, v72, v73, v74
    s_waitcnt vmcnt(10)
    v_max3_u32 v14, v76, v77, v78
    v_rcp_f32 v214, v214
PAD_C_54:
    s_cbranch_execz PAD_C_55
    v_mfma_f32_32x32x16_bf16 a[240:255], a[12:15], v[64:67], a[240:255]
    v_max3_u32 v13, v13, v75, v79
    v_max_u32 v13, v13, v14
    buffer_load_dwordx4 v[120:123], v4, s[20:23], s35 offen offset:2048
    v_rcp_f32 v215, v215
    v_mfma_f32_32x32x16_bf16 v[192:207], a[8:11], v[68:71], v[192:207]
    v_cmp_eq_u32 vcc, -1, v13
    v_mul_f32 v216, v216, v208
    v_mul_f32 v217, v217, v209
    v_mul_f32 v218, v218, v210
    v_mul_f32 v219, v219, v211
    v_mul_f32 v220, v220, v212
    v_mfma_f32_32x32x16_bf16 v[224:239], a[12:15], v[68:71], v[224:239]
    s_cbranch_vccnz VSLOW_125
VRET_126:
    buffer_load_dwordx4 v[124:127], v4, s[20:23], s59 offen offset:2048
    v_mul_f32 v221, v221, v213
    v_mul_f32 v222, v222, v214
    v_mul_f32 v223, v223, v215
    v_mfma_f32_32x32x16_bf16 v[176:191], a[64:67], v[72:75], v[176:191]
    s_waitcnt vmcnt(11)
    v_max3_u32 v13, v80, v81, v82
    s_waitcnt vmcnt(10)
    v_max3_u32 v14, v84, v85, v86
    v_cvt_pk_bf16_f32 v24, v216, v217
    v_cvt_pk_bf16_f32 v25, v218, v219
    v_cvt_pk_bf16_f32 v26, v220, v221
    v_mfma_f32_32x32x16_bf16 a[240:255], a[68:71], v[72:75], a[240:255]
    v_max3_u32 v13, v13, v83, v87
    v_max_u32 v13, v13, v14
    buffer_load_dwordx4 v[128:131], v4, s[20:23], s32 offen offset:3072
    v_cvt_pk_bf16_f32 v27, v222, v223
    v_mfma_f32_32x32x16_bf16 v[192:207], a[64:67], v[76:79], v[192:207]
    v_cmp_eq_u32 vcc, -1, v13
    buffer_store_dwordx4 v[24:27], v22, s[20:23], s19 offen offset:2048 sc1
    v_mfma_f32_32x32x16_bf16 v[224:239], a[68:71], v[76:79], v[224:239]
    s_cbranch_vccnz VSLOW_127
VRET_128:
    buffer_load_dwordx4 v[132:135], v4, s[20:23], s56 offen offset:3072
    v_mfma_f32_32x32x16_bf16 v[176:191], a[120:123], v[80:83], v[176:191]
    s_waitcnt vmcnt(12)
    v_max3_u32 v13, v88, v89, v90
    s_waitcnt vmcnt(11)
    v_max3_u32 v14, v92, v93, v94
    v_mfma_f32_32x32x16_bf16 a[240:255], a[124:127], v[80:83], a[240:255]
    v_max3_u32 v13, v13, v91, v95
    v_max_u32 v13, v13, v14
    buffer_load_dwordx4 v[136:139], v4, s[20:23], s33 offen offset:3072
    v_mfma_f32_32x32x16_bf16 v[192:207], a[120:123], v[84:87], v[192:207]
    v_cmp_eq_u32 vcc, -1, v13
PAD_C_55:
    s_cbranch_execz PAD_C_56
    v_mfma_f32_32x32x16_bf16 v[224:239], a[124:127], v[84:87], v[224:239]
    s_cbranch_vccnz VSLOW_129
VRET_130:
    buffer_load_dwordx4 v[140:143], v4, s[20:23], s57 offen offset:3072
    v_mfma_f32_32x32x16_bf16 v[176:191], a[176:179], v[88:91], v[176:191]
    s_waitcnt vmcnt(12)
    v_max3_u32 v13, v96, v97, v98
    s_waitcnt vmcnt(11)
    v_max3_u32 v14, v100, v101, v102
    v_mfma_f32_32x32x16_bf16 a[240:255], a[180:183], v[88:91], a[240:255]
    v_max3_u32 v13, v13, v99, v103
    v_max_u32 v13, v13, v14
    buffer_load_dwordx4 v[144:147], v4, s[20:23], s34 offen offset:3072
    v_mfma_f32_32x32x16_bf16 v[192:207], a[176:179], v[92:95], v[192:207]
    v_cmp_eq_u32 vcc, -1, v13
    v_mfma_f32_32x32x16_bf16 v[224:239], a[180:183], v[92:95], v[224:239]
    s_cbranch_vccnz VSLOW_131
VRET_132:
    buffer_load_dwordx4 v[148:151], v4, s[20:23], s58 offen offset:3072
    v_mfma_f32_32x32x16_bf16 v[176:191], a[16:19], v[96:99], v[176:191]
    s_waitcnt vmcnt(12)
    v_max3_u32 v13, v104, v105, v106
    s_waitcnt vmcnt(11)
    v_max3_u32 v14, v108, v109, v110
    v_mfma_f32_32x32x16_bf16 a[240:255], a[20:23], v[96:99], a[240:255]
    v_max3_u32 v13, v13, v107, v111
    v_max_u32 v13, v13, v14
    buffer_load_dwordx4 v[152:155], v4, s[20:23], s35 offen offset:3072
    v_mfma_f32_32x32x16_bf16 v[192:207], a[16:19], v[100:103], v[192:207]
    v_cmp_eq_u32 vcc, -1, v13
    v_mfma_f32_32x32x16_bf16 v[224:239], a[20:23], v[100:103], v[224:239]
    s_cbranch_vccnz VSLOW_133
VRET_134:
    buffer_load_dwordx4 v[156:159], v4, s[20:23], s59 offen offset:3072
    v_mfma_f32_32x32x16_bf16 v[176:191], a[72:75], v[104:107], v[176:191]
    s_waitcnt vmcnt(12)
    v_max3_u32 v13, v112, v113, v114
    s_waitcnt vmcnt(11)
    v_max3_u32 v14, v116, v117, v118
    v_mfma_f32_32x32x16_bf16 a[240:255], a[76:79], v[104:107], a[240:255]
    v_max3_u32 v13, v13, v115, v119
    v_max_u32 v13, v13, v14
    buffer_load_dwordx4 v[160:163], v22, s[20:23], s32 offen
    v_mfma_f32_32x32x16_bf16 v[192:207], a[72:75], v[108:111], v[192:207]
    v_cmp_eq_u32 vcc, -1, v13
PAD_C_56:
    s_cbranch_execz PAD_C_57
    v_mfma_f32_32x32x16_bf16 v[224:239], a[76:79], v[108:111], v[224:239]
    s_cbranch_vccnz VSLOW_135
VRET_136:
    buffer_load_dwordx4 v[164:167], v22, s[20:23], s56 offen
    v_mfma_f32_32x32x16_bf16 v[176:191], a[128:131], v[112:115], v[176:191]
    s_waitcnt vmcnt(12)
    v_max3_u32 v13, v120, v121, v122
    s_waitcnt vmcnt(11)
    v_max3_u32 v14, v124, v125, v126
    v_mfma_f32_32x32x16_bf16 a[240:255], a[132:135], v[112:115], a[240:255]
    v_max3_u32 v13, v13, v123, v127
    v_max_u32 v13, v13, v14
    buffer_load_dwordx4 v[168:171], v22, s[20:23], s33 offen
    v_mfma_f32_32x32x16_bf16 v[192:207], a[128:131], v[116:119], v[192:207]
    v_cmp_eq_u32 vcc, -1, v13
    v_mfma_f32_32x32x16_bf16 v[224:239], a[132:135], v[116:119], v[224:239]
    s_cbranch_vccnz VSLOW_137
VRET_138:
    buffer_load_dwordx4 v[172:175], v22, s[20:23], s57 offen
    v_mfma_f32_32x32x16_bf16 v[176:191], a[184:187], v[120:123], v[176:191]
    s_waitcnt vmcnt(12)
    v_max3_u32 v13, v128, v129, v130
    s_waitcnt vmcnt(10)
    v_max3_u32 v14, v132, v133, v134
    v_mfma_f32_32x32x16_bf16 a[240:255], a[188:191], v[120:123], a[240:255]
    v_max3_u32 v13, v13, v131, v135
    v_max_u32 v13, v13, v14
    buffer_load_dwordx4 v[32:35], v22, s[20:23], s34 offen
    v_mfma_f32_32x32x16_bf16 v[192:207], a[184:187], v[124:127], v[192:207]
    v_cmp_eq_u32 vcc, -1, v13
    v_mfma_f32_32x32x16_bf16 v[224:239], a[188:191], v[124:127], v[224:239]
    s_cbranch_vccnz VSLOW_139
VRET_140:
    buffer_load_dwordx4 v[36:39], v22, s[20:23], s58 offen
    v_mfma_f32_32x32x16_bf16 v[176:191], a[24:27], v[128:131], v[176:191]
    s_waitcnt vmcnt(11)
    v_max3_u32 v13, v136, v137, v138
    s_waitcnt vmcnt(10)
    v_max3_u32 v14, v140, v141, v142
PAD_C_57:
    s_cbranch_execz PRET_C
    v_mfma_f32_32x32x16_bf16 a[240:255], a[28:31], v[128:131], a[240:255]
    v_max3_u32 v13, v13, v139, v143
    v_max_u32 v13, v13, v14
    buffer_load_dwordx4 v[40:43], v22, s[20:23], s35 offen
    v_mfma_f32_32x32x16_bf16 v[192:207], a[24:27], v[132:135], v[192:207]
    v_cmp_eq_u32 vcc, -1, v13
    v_lshrrev_b32 v5, 2, v2
    v_and_b32 v6, 3, v2
    v_lshlrev_b32 v5, 12, v5
    v_lshl_add_u32 v5, v6, 4, v5
    s_mov_b32 m0, s47
    s_add_u32 s48, s43, 65536
    buffer_load_dwordx4 v5, s[20:23], s43 offen lds
    s_add_u32 m0, s47, 1024
    s_nop 0
    buffer_load_dwordx4 v5, s[20:23], s48 offen lds
    v_mfma_f32_32x32x16_bf16 v[224:239], a[28:31], v[132:135], v[224:239]
    s_cbranch_vccnz VSLOW_141
VRET_142:
    buffer_load_dwordx4 v[44:47], v22, s[20:23], s59 offen
    v_mfma_f32_32x32x16_bf16 v[176:191], a[80:83], v[136:139], v[176:191]
    s_waitcnt vmcnt(13)
    v_max3_u32 v13, v144, v145, v146
    s_waitcnt vmcnt(12)
    v_max3_u32 v14, v148, v149, v150
    v_mfma_f32_32x32x16_bf16 a[240:255], a[84:87], v[136:139], a[240:255]
    v_max3_u32 v13, v13, v147, v151
    v_max_u32 v13, v13, v14
    buffer_load_dwordx4 v[48:51], v22, s[20:23], s32 offen offset:1024
    v_mfma_f32_32x32x16_bf16 v[192:207], a[80:83], v[140:143], v[192:207]
    v_cmp_eq_u32 vcc, -1, v13
    v_mfma_f32_32x32x16_bf16 v[224:239], a[84:87], v[140:143], v[224:239]
    s_cbranch_vccnz VSLOW_143
VRET_144:
    buffer_load_dwordx4 v[52:55], v22, s[20:23], s56 offen offset:1024
    v_mfma_f32_32x32x16_bf16 v[176:191], a[136:139], v[144:147], v[176:191]
    s_waitcnt vmcnt(13)
    v_max3_u32 v13, v152, v153, v154
    s_waitcnt vmcnt(12)
    v_max3_u32 v14, v156, v157, v158
    v_mfma_f32_32x32x16_bf16 a[240:255], a[140:143], v[144:147], a[240:255]
    v_max3_u32 v13, v13, v155, v159
    v_max_u32 v13, v13, v14
    buffer_load_dwordx4 v[56:59], v22, s[20:23], s33 offen offset:1024
    v_mfma_f32_32x32x16_bf16 v[192:207], a[136:139], v[148:151], v[192:207]
    v_cmp_eq_u32 vcc, -1, v13
PAD_C_58:
    s_cbranch_execz PAD_C_59
    v_mfma_f32_32x32x16_bf16 v[224:239], a[140:143], v[148:151], v[224:239]
    s_cbranch_vccnz VSLOW_145
VRET_146:
    buffer_load_dwordx4 v[60:63], v22, s[20:23], s57 offen offset:1024
    v_mfma_f32_32x32x16_bf16 v[176:191], a[192:195], v[152:155], v[176:191]
    s_waitcnt vmcnt(13)
    v_max3_u32 v13, v160, v161, v162
    s_waitcnt vmcnt(12)
    v_max3_u32 v14, v164, v165, v166
    v_mfma_f32_32x32x16_bf16 a[240:255], a[196:199], v[152:155], a[240:255]
    v_max3_u32 v13, v13, v163, v167
    v_max_u32 v13, v13, v14
    buffer_load_dwordx4 v[64:67], v22, s[20:23], s34 offen offset:1024
    v_mfma_f32_32x32x16_bf16 v[192:207], a[192:195], v[156:159], v[192:207]
    v_cmp_eq_u32 vcc, -1, v13
    v_mfma_f32_32x32x16_bf16 v[224:239], a[196:199], v[156:159], v[224:239]
    s_cbranch_vccnz VSLOW_147
VRET_148:
    buffer_load_dwordx4 v[68:71], v22, s[20:23], s58 offen offset:1024
    v_mfma_f32_32x32x16_bf16 v[176:191], a[32:35], v[160:163], v[176:191]
    s_waitcnt vmcnt(13)
    v_max3_u32 v13, v168, v169, v170
    s_waitcnt vmcnt(12)
    v_max3_u32 v14, v172, v173, v174
    v_mfma_f32_32x32x16_bf16 a[240:255], a[36:39], v[160:163], a[240:255]
    v_max3_u32 v13, v13, v171, v175
    v_max_u32 v13, v13, v14
    buffer_load_dwordx4 v[72:75], v22, s[20:23], s35 offen offset:1024
    v_mfma_f32_32x32x16_bf16 v[192:207], a[32:35], v[164:167], v[192:207]
    v_cmp_eq_u32 vcc, -1, v13
    v_mfma_f32_32x32x16_bf16 v[224:239], a[36:39], v[164:167], v[224:239]
    s_cbranch_vccnz VSLOW_149
VRET_150:
    buffer_load_dwordx4 v[76:79], v22, s[20:23], s59 offen offset:1024
    v_mfma_f32_32x32x16_bf16 v[176:191], a[88:91], v[168:171], v[176:191]
    s_waitcnt vmcnt(13)
    v_max3_u32 v13, v32, v33, v34
    s_waitcnt vmcnt(12)
    v_max3_u32 v14, v36, v37, v38
    v_mfma_f32_32x32x16_bf16 a[240:255], a[92:95], v[168:171], a[240:255]
    v_max3_u32 v13, v13, v35, v39
    v_max_u32 v13, v13, v14
    buffer_load_dwordx4 v[80:83], v22, s[20:23], s32 offen offset:2048
    v_mfma_f32_32x32x16_bf16 v[192:207], a[88:91], v[172:175], v[192:207]
    v_cmp_eq_u32 vcc, -1, v13
PAD_C_59:
    s_cbranch_execz PAD_C_60
    v_mfma_f32_32x32x16_bf16 v[224:239], a[92:95], v[172:175], v[224:239]
    s_cbranch_vccnz VSLOW_151
VRET_152:
    buffer_load_dwordx4 v[84:87], v22, s[20:23], s56 offen offset:2048
    v_mfma_f32_32x32x16_bf16 v[176:191], a[144:147], v[32:35], v[176:191]
    s_waitcnt vmcnt(13)
    v_max3_u32 v13, v40, v41, v42
    s_waitcnt vmcnt(10)
    v_max3_u32 v14, v44, v45, v46
    v_mfma_f32_32x32x16_bf16 a[240:255], a[148:151], v[32:35], a[240:255]
    v_max3_u32 v13, v13, v43, v47
    v_max_u32 v13, v13, v14
    buffer_load_dwordx4 v[88:91], v22, s[20:23], s33 offen offset:2048
    v_mfma_f32_32x32x16_bf16 v[192:207], a[144:147], v[36:39], v[192:207]
    v_cmp_eq_u32 vcc, -1, v13
    v_mfma_f32_32x32x16_bf16 v[224:239], a[148:151], v[36:39], v[224:239]
    s_cbranch_vccnz VSLOW_153
VRET_154:
    buffer_load_dwordx4 v[92:95], v22, s[20:23], s57 offen offset:2048
    v_mfma_f32_32x32x16_bf16 v[176:191], a[200:203], v[40:43], v[176:191]
    s_waitcnt vmcnt(11)
    v_max3_u32 v13, v48, v49, v50
    s_waitcnt vmcnt(10)
    v_max3_u32 v14, v52, v53, v54
    v_mfma_f32_32x32x16_bf16 a[240:255], a[204:207], v[40:43], a[240:255]
    v_max3_u32 v13, v13, v51, v55
    v_max_u32 v13, v13, v14
    buffer_load_dwordx4 v[96:99], v22, s[20:23], s34 offen offset:2048
    v_mfma_f32_32x32x16_bf16 v[192:207], a[200:203], v[44:47], v[192:207]
    v_cmp_eq_u32 vcc, -1, v13
    v_mfma_f32_32x32x16_bf16 v[224:239], a[204:207], v[44:47], v[224:239]
    s_cbranch_vccnz VSLOW_155
VRET_156:
    buffer_load_dwordx4 v[100:103], v22, s[20:23], s58 offen offset:2048
    v_mfma_f32_32x32x16_bf16 v[176:191], a[40:43], v[48:51], v[176:191]
    s_waitcnt vmcnt(11)
    v_max3_u32 v13, v56, v57, v58
    s_waitcnt vmcnt(10)
    v_max3_u32 v14, v60, v61, v62
    v_mfma_f32_32x32x16_bf16 a[240:255], a[44:47], v[48:51], a[240:255]
    v_max3_u32 v13, v13, v59, v63
    v_max_u32 v13, v13, v14
    buffer_load_dwordx4 v[104:107], v22, s[20:23], s35 offen offset:2048
    v_mfma_f32_32x32x16_bf16 v[192:207], a[40:43], v[52:55], v[192:207]
    v_cmp_eq_u32 vcc, -1, v13
PAD_C_60:
    s_cbranch_execz PAD_C_61
    v_mfma_f32_32x32x16_bf16 v[224:239], a[44:47], v[52:55], v[224:239]
    s_cbranch_vccnz VSLOW_157
VRET_158:
    buffer_load_dwordx4 v[108:111], v22, s[20:23], s59 offen offset:2048
    v_mfma_f32_32x32x16_bf16 v[176:191], a[96:99], v[56:59], v[176:191]
    s_waitcnt vmcnt(11)
    v_max3_u32 v13, v64, v65, v66
    s_waitcnt vmcnt(10)
    v_max3_u32 v14, v68, v69, v70
    v_mfma_f32_32x32x16_bf16 a[240:255], a[100:103], v[56:59], a[240:255]
    v_max3_u32 v13, v13, v67, v71
    v_max_u32 v13, v13, v14
    v_mfma_f32_32x32x16_bf16 v[192:207], a[96:99], v[60:63], v[192:207]
    v_cmp_eq_u32 vcc, -1, v13
    v_mfma_f32_32x32x16_bf16 v[224:239], a[100:103], v[60:63], v[224:239]
    s_cbranch_vccnz VSLOW_159
VRET_160:
    v_mfma_f32_32x32x16_bf16 v[176:191], a[152:155], v[64:67], v[176:191]
    s_waitcnt vmcnt(9)
    v_max3_u32 v13, v72, v73, v74
    s_waitcnt vmcnt(8)
    v_max3_u32 v14, v76, v77, v78
    v_mfma_f32_32x32x16_bf16 a[240:255], a[156:159], v[64:67], a[240:255]
    v_max3_u32 v13, v13, v75, v79
    v_max_u32 v13, v13, v14
    v_mfma_f32_32x32x16_bf16 v[192:207], a[152:155], v[68:71], v[192:207]
    v_cmp_eq_u32 vcc, -1, v13
    v_mfma_f32_32x32x16_bf16 v[224:239], a[156:159], v[68:71], v[224:239]
    s_cbranch_vccnz VSLOW_161
VRET_162:
    v_mfma_f32_32x32x16_bf16 v[176:191], a[208:211], v[72:75], v[176:191]
    s_waitcnt vmcnt(7)
    v_max3_u32 v13, v80, v81, v82
    s_waitcnt vmcnt(6)
    v_max3_u32 v14, v84, v85, v86
    v_mfma_f32_32x32x16_bf16 a[240:255], a[212:215], v[72:75], a[240:255]
    v_max3_u32 v13, v13, v83, v87
    v_max_u32 v13, v13, v14
    v_mfma_f32_32x32x16_bf16 v[192:207], a[208:211], v[76:79], v[192:207]
    v_cmp_eq_u32 vcc, -1, v13
    v_mfma_f32_32x32x16_bf16 v[224:239], a[212:215], v[76:79], v[224:239]
    s_cbranch_vccnz VSLOW_163
VRET_164:
    v_mfma_f32_32x32x16_bf16 v[176:191], a[48:51], v[80:83], v[176:191]
    s_waitcnt vmcnt(5)
    v_max3_u32 v13, v88, v89, v90
    s_waitcnt vmcnt(4)
    v_max3_u32 v14, v92, v93, v94
    v_mfma_f32_32x32x16_bf16 a[240:255], a[52:55], v[80:83], a[240:255]
    v_max3_u32 v13, v13, v91, v95
    v_max_u32 v13, v13, v14
    v_mfma_f32_32x32x16_bf16 v[192:207], a[48:51], v[84:87], v[192:207]
    v_cmp_eq_u32 vcc, -1, v13
    v_mfma_f32_32x32x16_bf16 v[224:239], a[52:55], v[84:87], v[224:239]
PAD_C_61:
    s_cbranch_execz PRET_C
    s_cbranch_vccnz VSLOW_165
VRET_166:
    v_mfma_f32_32x32x16_bf16 v[176:191], a[104:107], v[88:91], v[176:191]
    s_waitcnt vmcnt(3)
    v_max3_u32 v13, v96, v97, v98
    s_waitcnt vmcnt(2)
    v_max3_u32 v14, v100, v101, v102
    v_mfma_f32_32x32x16_bf16 a[240:255], a[108:111], v[88:91], a[240:255]
    v_max3_u32 v13, v13, v99, v103
    v_max_u32 v13, v13, v14
    v_mfma_f32_32x32x16_bf16 v[192:207], a[104:107], v[92:95], v[192:207]
    v_cmp_eq_u32 vcc, -1, v13
    v_mfma_f32_32x32x16_bf16 v[224:239], a[108:111], v[92:95], v[224:239]
    s_cbranch_vccnz VSLOW_167
VRET_168:
    v_mfma_f32_32x32x16_bf16 v[176:191], a[160:163], v[96:99], v[176:191]
    s_waitcnt vmcnt(1)
    v_max3_u32 v13, v104, v105, v106
    s_waitcnt vmcnt(0)
    v_max3_u32 v14, v108, v109, v110
    v_mfma_f32_32x32x16_bf16 a[240:255], a[164:167], v[96:99], a[240:255]
    v_max3_u32 v13, v13, v107, v111
    v_max_u32 v13, v13, v14
    v_mfma_f32_32x32x16_bf16 v[192:207], a[160:163], v[100:103], v[192:207]
    v_cmp_eq_u32 vcc, -1, v13
    v_mfma_f32_32x32x16_bf16 v[224:239], a[164:167], v[100:103], v[224:239]
    s_cbranch_vccnz VSLOW_169
VRET_170:
    v_mfma_f32_32x32x16_bf16 v[176:191], a[216:219], v[104:107], v[176:191]
    v_mfma_f32_32x32x16_bf16 a[240:255], a[220:223], v[104:107], a[240:255]
    v_mfma_f32_32x32x16_bf16 v[192:207], a[216:219], v[108:111], v[192:207]
    v_mfma_f32_32x32x16_bf16 v[224:239], a[220:223], v[108:111], v[224:239]
    v_lshrrev_b32 v5, 5, v2
    v_lshlrev_b32 v5, 2, v5
    v_bfe_u32 v6, v2, 2, 2
    v_add_u32 v5, v5, v6
    v_lshlrev_b32 v5, 6, v5
    v_bfe_u32 v6, v2, 4, 1
    v_lshl_add_u32 v5, v6, 5, v5
    v_and_b32 v6, 3, v2
    v_lshl_add_u32 v5, v6, 3, v5
    v_add_u32 v5, s47, v5
    s_xor_b32 s52, s6, 1
    s_mul_i32 s52, s52, 12288
    s_add_u32 s52, s52, 66560
    v_add_u32 v8, s52, v4
    s_xor_b32 s52, s6, 2
    s_mul_i32 s52, s52, 12288
    s_add_u32 s52, s52, 70656
    v_add_u32 v9, s52, v4
    s_xor_b32 s52, s6, 3
    s_mul_i32 s52, s52, 12288
    s_add_u32 s52, s52, 74752
    v_add_u32 v10, s52, v4
PAD_C_62:
    s_cbranch_execz PAD_C_63
    s_mul_i32 s52, s6, 12288
    s_add_u32 s52, s52, 66560
    v_add_u32 v11, s52, v4
    ds_read_b64_tr_b16 v[240:241], v5 offset:0
    ds_read_b64_tr_b16 v[242:243], v5 offset:512
    ds_read_b64_tr_b16 v[244:245], v5 offset:1024
    ds_read_b64_tr_b16 v[246:247], v5 offset:1536
    ds_write_b128 v8, v[192:195] offset:0
    ds_write_b128 v8, v[196:199] offset:1024
    ds_write_b128 v8, v[200:203] offset:2048
    ds_write_b128 v8, v[204:207] offset:3072
    ds_write_b128 v9, a[240:243] offset:0
    ds_write_b128 v9, a[244:247] offset:1024
    ds_write_b128 v9, a[248:251] offset:2048
    ds_write_b128 v9, a[252:255] offset:3072
    ds_write_b128 v10, v[224:227] offset:0
    ds_write_b128 v10, v[228:231] offset:1024
    ds_write_b128 v10, v[232:235] offset:2048
    ds_write_b128 v10, v[236:239] offset:3072
    s_waitcnt lgkmcnt(15)
    v_lshlrev_b32 v16, 16, v240
    v_and_b32 v17, 0xffff0000, v240
    v_lshlrev_b32 v18, 16, v241
    v_and_b32 v19, 0xffff0000, v241
    s_waitcnt lgkmcnt(14)
    v_lshlrev_b32 v20, 16, v242
    v_and_b32 v21, 0xffff0000, v242
    v_lshlrev_b32 v22, 16, v243
    v_and_b32 v23, 0xffff0000, v243
    s_waitcnt lgkmcnt(13)
    v_lshlrev_b32 v24, 16, v244
    v_and_b32 v25, 0xffff0000, v244
    v_lshlrev_b32 v26, 16, v245
    v_and_b32 v27, 0xffff0000, v245
    s_waitcnt lgkmcnt(12)
    v_lshlrev_b32 v28, 16, v246
    v_and_b32 v29, 0xffff0000, v246
    v_lshlrev_b32 v30, 16, v247
    v_and_b32 v31, 0xffff0000, v247
    v_pk_add_f32 v[176:177], v[176:177], v[16:17]
    v_pk_add_f32 v[178:179], v[178:179], v[18:19]
    v_pk_add_f32 v[180:181], v[180:181], v[20:21]
    v_pk_add_f32 v[182:183], v[182:183], v[22:23]
    v_pk_add_f32 v[184:185], v[184:185], v[24:25]
    v_pk_add_f32 v[186:187], v[186:187], v[26:27]
    v_pk_add_f32 v[188:189], v[188:189], v[28:29]
PAD_C_63:
    s_cbranch_execz PAD_C_64
    v_pk_add_f32 v[190:191], v[190:191], v[30:31]
    s_waitcnt lgkmcnt(0)
    s_barrier
    ds_read_b128 v[32:35], v11 offset:0
    ds_read_b128 v[36:39], v11 offset:1024
    ds_read_b128 v[40:43], v11 offset:2048
    ds_read_b128 v[44:47], v11 offset:3072
    ds_read_b128 v[48:51], v11 offset:4096
    ds_read_b128 v[52:55], v11 offset:5120
    ds_read_b128 v[56:59], v11 offset:6144
    ds_read_b128 v[60:63], v11 offset:7168
    ds_read_b128 v[64:67], v11 offset:8192
    ds_read_b128 v[68:71], v11 offset:9216
    ds_read_b128 v[72:75], v11 offset:10240
    ds_read_b128 v[76:79], v11 offset:11264
    s_waitcnt lgkmcnt(11)
    v_pk_add_f32 v[176:177], v[176:177], v[32:33]
    v_pk_add_f32 v[178:179], v[178:179], v[34:35]
    s_waitcnt lgkmcnt(10)
    v_pk_add_f32 v[180:181], v[180:181], v[36:37]
    v_pk_add_f32 v[182:183], v[182:183], v[38:39]
    s_waitcnt lgkmcnt(9)
    v_pk_add_f32 v[184:185], v[184:185], v[40:41]
    v_pk_add_f32 v[186:187], v[186:187], v[42:43]
    s_waitcnt lgkmcnt(8)
    v_pk_add_f32 v[188:189], v[188:189], v[44:45]
    v_pk_add_f32 v[190:191], v[190:191], v[46:47]
    s_waitcnt lgkmcnt(7)
    v_pk_add_f32 v[176:177], v[176:177], v[48:49]
    v_pk_add_f32 v[178:179], v[178:179], v[50:51]
    s_waitcnt lgkmcnt(6)
    v_pk_add_f32 v[180:181], v[180:181], v[52:53]
    v_pk_add_f32 v[182:183], v[182:183], v[54:55]
    s_waitcnt lgkmcnt(5)
    v_pk_add_f32 v[184:185], v[184:185], v[56:57]
    v_pk_add_f32 v[186:187], v[186:187], v[58:59]
    s_waitcnt lgkmcnt(4)
    v_pk_add_f32 v[188:189], v[188:189], v[60:61]
    v_pk_add_f32 v[190:191], v[190:191], v[62:63]
    s_waitcnt lgkmcnt(3)
    v_pk_add_f32 v[176:177], v[176:177], v[64:65]
    v_pk_add_f32 v[178:179], v[178:179], v[66:67]
    s_waitcnt lgkmcnt(2)
    v_pk_add_f32 v[180:181], v[180:181], v[68:69]
    v_pk_add_f32 v[182:183], v[182:183], v[70:71]
    s_waitcnt lgkmcnt(1)
PAD_C_64:
    s_cbranch_execz PAD_C_65
    v_pk_add_f32 v[184:185], v[184:185], v[72:73]
    v_pk_add_f32 v[186:187], v[186:187], v[74:75]
    s_waitcnt lgkmcnt(0)
    v_pk_add_f32 v[188:189], v[188:189], v[76:77]
    v_pk_add_f32 v[190:191], v[190:191], v[78:79]
    v_cvt_pk_bf16_f32 v80, v176, v177
    v_cvt_pk_bf16_f32 v81, v178, v179
    v_cvt_pk_bf16_f32 v82, v180, v181
    v_cvt_pk_bf16_f32 v83, v182, v183
    v_cvt_pk_bf16_f32 v84, v184, v185
    v_cvt_pk_bf16_f32 v85, v186, v187
    v_cvt_pk_bf16_f32 v86, v188, v189
    v_cvt_pk_bf16_f32 v87, v190, v191
    v_permlane32_swap_b32 v80, v82
    v_permlane32_swap_b32 v81, v83
    v_permlane32_swap_b32 v84, v86
    v_permlane32_swap_b32 v85, v87
    s_mov_b32 s24, s84
    s_mov_b32 s25, s85
    s_mov_b32 s26, 1835008
    s_mov_b32 s27, 0x00020000
    v_and_b32 v8, 31, v2
    v_lshrrev_b32 v6, 5, v2
    v_mul_u32_u24 v7, 896, v8
    v_lshl_add_u32 v7, v6, 4, v7
    s_mul_i32 s48, s40, 28672
    s_lshl_b32 s49, s41, 6
    s_add_u32 s48, s48, s49
    buffer_store_dwordx4 v[80:83], v7, s[24:27], s48 offen
    buffer_store_dwordx4 v[84:87], v7, s[24:27], s48 offen offset:32
    s_cmp_lg_u32 s2, 0
    s_cbranch_scc1 L_END
    s_cmp_lg_u32 s6, 0
    s_cbranch_scc1 L_END
    s_add_u32 s8, s87, 1
    v_mov_b32 v8, s8
    v_mov_b32 v9, 0
    s_mov_b64 exec, 1
    s_mov_b32 s9, 262144
    buffer_store_dword v8, v9, s[20:23], s9 offen sc1
    s_mov_b64 exec, -1
    s_branch L_END
L_SPARE2:
    s_waitcnt vmcnt(0) lgkmcnt(0)
    s_nop 15
    v_mul_f32 v208, v208, v20
    v_mul_f32 v209, v209, v20
    v_mul_f32 v210, v210, v20
    v_mul_f32 v211, v211, v20
    v_mul_f32 v212, v212, v20
    v_mul_f32 v213, v213, v20
    v_mul_f32 v214, v214, v20
    v_mul_f32 v215, v215, v20
    v_exp_f32 v208, v208
    v_exp_f32 v209, v209
    v_exp_f32 v210, v210
    v_exp_f32 v211, v211
    v_exp_f32 v212, v212
    v_exp_f32 v213, v213
    v_exp_f32 v214, v214
PAD_C_65:
    s_cbranch_execz PRET_C
    v_exp_f32 v215, v215
    v_fma_f32 v208, v208, v21, v21
    v_fma_f32 v209, v209, v21, v21
    v_fma_f32 v210, v210, v21, v21
    v_fma_f32 v211, v211, v21, v21
    v_fma_f32 v212, v212, v21, v21
    v_fma_f32 v213, v213, v21, v21
    v_fma_f32 v214, v214, v21, v21
    v_fma_f32 v215, v215, v21, v21
    v_rcp_f32 v208, v208
    v_rcp_f32 v209, v209
    v_rcp_f32 v210, v210
    v_rcp_f32 v211, v211
    v_rcp_f32 v212, v212
    v_rcp_f32 v213, v213
    v_rcp_f32 v214, v214
    v_rcp_f32 v215, v215
    v_mul_f32 v216, v216, v208
    v_mul_f32 v217, v217, v209
    v_mul_f32 v218, v218, v210
    v_mul_f32 v219, v219, v211
    v_mul_f32 v220, v220, v212
    v_mul_f32 v221, v221, v213
    v_mul_f32 v222, v222, v214
    v_mul_f32 v223, v223, v215
    v_cvt_pk_bf16_f32 v24, v216, v217
    v_cvt_pk_bf16_f32 v25, v218, v219
    v_cvt_pk_bf16_f32 v26, v220, v221
    v_cvt_pk_bf16_f32 v27, v222, v223
    buffer_store_dwordx4 v[24:27], v22, s[20:23], s19 offen offset:2048 sc1
L_END:
    s_endpgm
VSLOW_45:
    s_mov_b32 s92, 30000
VSLOW_45_l:
    buffer_load_dwordx4 v[32:35], v4, s[20:23], s32 offen sc1
    buffer_load_dwordx4 v[36:39], v4, s[20:23], s56 offen sc1
    s_waitcnt vmcnt(0)
    v_max3_u32 v13, v32, v33, v34
    v_max3_u32 v14, v36, v37, v38
    v_max3_u32 v13, v13, v35, v39
    v_max_u32 v13, v13, v14
    v_cmp_eq_u32 vcc, -1, v13
    s_cbranch_vccz VRET_46
    s_sub_u32 s92, s92, 1
    s_cmp_lg_u32 s92, 0
    s_cbranch_scc1 VSLOW_45_l
    s_branch VRET_46
VSLOW_47:
    s_mov_b32 s92, 30000
VSLOW_47_l:
    buffer_load_dwordx4 v[40:43], v4, s[20:23], s33 offen sc1
    buffer_load_dwordx4 v[44:47], v4, s[20:23], s57 offen sc1
    s_waitcnt vmcnt(0)
    v_max3_u32 v13, v40, v41, v42
    v_max3_u32 v14, v44, v45, v46
    v_max3_u32 v13, v13, v43, v47
    v_max_u32 v13, v13, v14
    v_cmp_eq_u32 vcc, -1, v13
    s_cbranch_vccz VRET_48
    s_sub_u32 s92, s92, 1
    s_cmp_lg_u32 s92, 0
    s_cbranch_scc1 VSLOW_47_l
    s_branch VRET_48
VSLOW_49:
    s_mov_b32 s92, 30000
VSLOW_49_l:
    buffer_load_dwordx4 v[48:51], v4, s[20:23], s34 offen sc1
    buffer_load_dwordx4 v[52:55], v4, s[20:23], s58 offen sc1
    s_waitcnt vmcnt(0)
    v_max3_u32 v13, v48, v49, v50
    v_max3_u32 v14, v52, v53, v54
    v_max3_u32 v13, v13, v51, v55
    v_max_u32 v13, v13, v14
    v_cmp_eq_u32 vcc, -1, v13
    s_cbranch_vccz VRET_50
    s_sub_u32 s92, s92, 1
    s_cmp_lg_u32 s92, 0
    s_cbranch_scc1 VSLOW_49_l
    s_branch VRET_50
VSLOW_51:
    s_mov_b32 s92, 30000
VSLOW_51_l:
    buffer_load_dwordx4 v[56:59], v4, s[20:23], s35 offen sc1
    buffer_load_dwordx4 v[60:63], v4, s[20:23], s59 offen sc1
    s_waitcnt vmcnt(0)
    v_max3_u32 v13, v56, v57, v58
    v_max3_u32 v14, v60, v61, v62
    v_max3_u32 v13, v13, v59, v63
    v_max_u32 v13, v13, v14
    v_cmp_eq_u32 vcc, -1, v13
    s_cbranch_vccz VRET_52
    s_sub_u32 s92, s92, 1
    s_cmp_lg_u32 s92, 0
    s_cbranch_scc1 VSLOW_51_l
    s_branch VRET_52
VSLOW_53:
    s_mov_b32 s92, 30000
VSLOW_53_l:
    buffer_load_dwordx4 v[64:67], v4, s[20:23], s32 offen offset:1024 sc1
    buffer_load_dwordx4 v[68:71], v4, s[20:23], s56 offen offset:1024 sc1
    s_waitcnt vmcnt(0)
    v_max3_u32 v13, v64, v65, v66
    v_max3_u32 v14, v68, v69, v70
    v_max3_u32 v13, v13, v67, v71
    v_max_u32 v13, v13, v14
    v_cmp_eq_u32 vcc, -1, v13
    s_cbranch_vccz VRET_54
    s_sub_u32 s92, s92, 1
    s_cmp_lg_u32 s92, 0
    s_cbranch_scc1 VSLOW_53_l
    s_branch VRET_54
VSLOW_55:
    s_mov_b32 s92, 30000
VSLOW_55_l:
    buffer_load_dwordx4 v[72:75], v4, s[20:23], s33 offen offset:1024 sc1
    buffer_load_dwordx4 v[76:79], v4, s[20:23], s57 offen offset:1024 sc1
    s_waitcnt vmcnt(0)
    v_max3_u32 v13, v72, v73, v74
    v_max3_u32 v14, v76, v77, v78
    v_max3_u32 v13, v13, v75, v79
    v_max_u32 v13, v13, v14
    v_cmp_eq_u32 vcc, -1, v13
    s_cbranch_vccz VRET_56
    s_sub_u32 s92, s92, 1
    s_cmp_lg_u32 s92, 0
    s_cbranch_scc1 VSLOW_55_l
    s_branch VRET_56
VSLOW_57:
    s_mov_b32 s92, 30000
VSLOW_57_l:
    buffer_load_dwordx4 v[80:83], v4, s[20:23], s34 offen offset:1024 sc1
    buffer_load_dwordx4 v[84:87], v4, s[20:23], s58 offen offset:1024 sc1
    s_waitcnt vmcnt(0)
    v_max3_u32 v13, v80, v81, v82
    v_max3_u32 v14, v84, v85, v86
    v_max3_u32 v13, v13, v83, v87
    v_max_u32 v13, v13, v14
    v_cmp_eq_u32 vcc, -1, v13
    s_cbranch_vccz VRET_58
    s_sub_u32 s92, s92, 1
    s_cmp_lg_u32 s92, 0
    s_cbranch_scc1 VSLOW_57_l
    s_branch VRET_58
VSLOW_59:
    s_mov_b32 s92, 30000
VSLOW_59_l:
    buffer_load_dwordx4 v[88:91], v4, s[20:23], s35 offen offset:1024 sc1
    buffer_load_dwordx4 v[92:95], v4, s[20:23], s59 offen offset:1024 sc1
    s_waitcnt vmcnt(0)
    v_max3_u32 v13, v88, v89, v90
    v_max3_u32 v14, v92, v93, v94
    v_max3_u32 v13, v13, v91, v95
    v_max_u32 v13, v13, v14
    v_cmp_eq_u32 vcc, -1, v13
    s_cbranch_vccz VRET_60
    s_sub_u32 s92, s92, 1
    s_cmp_lg_u32 s92, 0
    s_cbranch_scc1 VSLOW_59_l
    s_branch VRET_60
VSLOW_61:
    s_mov_b32 s92, 30000
VSLOW_61_l:
    buffer_load_dwordx4 v[96:99], v4, s[20:23], s32 offen offset:2048 sc1
    buffer_load_dwordx4 v[100:103], v4, s[20:23], s56 offen offset:2048 sc1
    s_waitcnt vmcnt(0)
    v_max3_u32 v13, v96, v97, v98
    v_max3_u32 v14, v100, v101, v102
    v_max3_u32 v13, v13, v99, v103
    v_max_u32 v13, v13, v14
    v_cmp_eq_u32 vcc, -1, v13
    s_cbranch_vccz VRET_62
    s_sub_u32 s92, s92, 1
    s_cmp_lg_u32 s92, 0
    s_cbranch_scc1 VSLOW_61_l
    s_branch VRET_62
VSLOW_63:
    s_mov_b32 s92, 30000
VSLOW_63_l:
    buffer_load_dwordx4 v[104:107], v4, s[20:23], s33 offen offset:2048 sc1
    buffer_load_dwordx4 v[108:111], v4, s[20:23], s57 offen offset:2048 sc1
    s_waitcnt vmcnt(0)
    v_max3_u32 v13, v104, v105, v106
    v_max3_u32 v14, v108, v109, v110
    v_max3_u32 v13, v13, v107, v111
    v_max_u32 v13, v13, v14
    v_cmp_eq_u32 vcc, -1, v13
    s_cbranch_vccz VRET_64
    s_sub_u32 s92, s92, 1
    s_cmp_lg_u32 s92, 0
    s_cbranch_scc1 VSLOW_63_l
    s_branch VRET_64
VSLOW_65:
    s_mov_b32 s92, 30000
VSLOW_65_l:
    buffer_load_dwordx4 v[112:115], v4, s[20:23], s34 offen offset:2048 sc1
    buffer_load_dwordx4 v[116:119], v4, s[20:23], s58 offen offset:2048 sc1
    s_waitcnt vmcnt(0)
    v_max3_u32 v13, v112, v113, v114
    v_max3_u32 v14, v116, v117, v118
    v_max3_u32 v13, v13, v115, v119
    v_max_u32 v13, v13, v14
    v_cmp_eq_u32 vcc, -1, v13
    s_cbranch_vccz VRET_66
    s_sub_u32 s92, s92, 1
    s_cmp_lg_u32 s92, 0
    s_cbranch_scc1 VSLOW_65_l
    s_branch VRET_66
VSLOW_67:
    s_mov_b32 s92, 30000
VSLOW_67_l:
    buffer_load_dwordx4 v[120:123], v4, s[20:23], s35 offen offset:2048 sc1
    buffer_load_dwordx4 v[124:127], v4, s[20:23], s59 offen offset:2048 sc1
    s_waitcnt vmcnt(0)
    v_max3_u32 v13, v120, v121, v122
    v_max3_u32 v14, v124, v125, v126
    v_max3_u32 v13, v13, v123, v127
    v_max_u32 v13, v13, v14
    v_cmp_eq_u32 vcc, -1, v13
    s_cbranch_vccz VRET_68
    s_sub_u32 s92, s92, 1
    s_cmp_lg_u32 s92, 0
    s_cbranch_scc1 VSLOW_67_l
    s_branch VRET_68
VSLOW_69:
    s_mov_b32 s92, 30000
VSLOW_69_l:
    buffer_load_dwordx4 v[128:131], v4, s[20:23], s32 offen offset:3072 sc1
    buffer_load_dwordx4 v[132:135], v4, s[20:23], s56 offen offset:3072 sc1
    s_waitcnt vmcnt(0)
    v_max3_u32 v13, v128, v129, v130
    v_max3_u32 v14, v132, v133, v134
    v_max3_u32 v13, v13, v131, v135
    v_max_u32 v13, v13, v14
    v_cmp_eq_u32 vcc, -1, v13
    s_cbranch_vccz VRET_70
    s_sub_u32 s92, s92, 1
    s_cmp_lg_u32 s92, 0
    s_cbranch_scc1 VSLOW_69_l
    s_branch VRET_70
VSLOW_71:
    s_mov_b32 s92, 30000
VSLOW_71_l:
    buffer_load_dwordx4 v[136:139], v4, s[20:23], s33 offen offset:3072 sc1
    buffer_load_dwordx4 v[140:143], v4, s[20:23], s57 offen offset:3072 sc1
    s_waitcnt vmcnt(0)
    v_max3_u32 v13, v136, v137, v138
    v_max3_u32 v14, v140, v141, v142
    v_max3_u32 v13, v13, v139, v143
    v_max_u32 v13, v13, v14
    v_cmp_eq_u32 vcc, -1, v13
    s_cbranch_vccz VRET_72
    s_sub_u32 s92, s92, 1
    s_cmp_lg_u32 s92, 0
    s_cbranch_scc1 VSLOW_71_l
    s_branch VRET_72
VSLOW_73:
    s_mov_b32 s92, 30000
VSLOW_73_l:
    buffer_load_dwordx4 v[144:147], v4, s[20:23], s34 offen offset:3072 sc1
    buffer_load_dwordx4 v[148:151], v4, s[20:23], s58 offen offset:3072 sc1
    s_waitcnt vmcnt(0)
    v_max3_u32 v13, v144, v145, v146
    v_max3_u32 v14, v148, v149, v150
    v_max3_u32 v13, v13, v147, v151
    v_max_u32 v13, v13, v14
    v_cmp_eq_u32 vcc, -1, v13
    s_cbranch_vccz VRET_74
    s_sub_u32 s92, s92, 1
    s_cmp_lg_u32 s92, 0
    s_cbranch_scc1 VSLOW_73_l
    s_branch VRET_74
VSLOW_75:
    s_mov_b32 s92, 30000
VSLOW_75_l:
    buffer_load_dwordx4 v[152:155], v4, s[20:23], s35 offen offset:3072 sc1
    buffer_load_dwordx4 v[156:159], v4, s[20:23], s59 offen offset:3072 sc1
    s_waitcnt vmcnt(0)
    v_max3_u32 v13, v152, v153, v154
    v_max3_u32 v14, v156, v157, v158
    v_max3_u32 v13, v13, v155, v159
    v_max_u32 v13, v13, v14
    v_cmp_eq_u32 vcc, -1, v13
    s_cbranch_vccz VRET_76
    s_sub_u32 s92, s92, 1
    s_cmp_lg_u32 s92, 0
    s_cbranch_scc1 VSLOW_75_l
    s_branch VRET_76
VSLOW_77:
    s_mov_b32 s92, 30000
VSLOW_77_l:
    buffer_load_dwordx4 v[160:163], v22, s[20:23], s32 offen sc1
    buffer_load_dwordx4 v[164:167], v22, s[20:23], s56 offen sc1
    s_waitcnt vmcnt(0)
    v_max3_u32 v13, v160, v161, v162
    v_max3_u32 v14, v164, v165, v166
    v_max3_u32 v13, v13, v163, v167
    v_max_u32 v13, v13, v14
    v_cmp_eq_u32 vcc, -1, v13
    s_cbranch_vccz VRET_78
    s_sub_u32 s92, s92, 1
    s_cmp_lg_u32 s92, 0
    s_cbranch_scc1 VSLOW_77_l
    s_branch VRET_78
VSLOW_79:
    s_mov_b32 s92, 30000
VSLOW_79_l:
    buffer_load_dwordx4 v[168:171], v22, s[20:23], s33 offen sc1
    buffer_load_dwordx4 v[172:175], v22, s[20:23], s57 offen sc1
    s_waitcnt vmcnt(0)
    v_max3_u32 v13, v168, v169, v170
    v_max3_u32 v14, v172, v173, v174
    v_max3_u32 v13, v13, v171, v175
    v_max_u32 v13, v13, v14
    v_cmp_eq_u32 vcc, -1, v13
    s_cbranch_vccz VRET_80
    s_sub_u32 s92, s92, 1
    s_cmp_lg_u32 s92, 0
    s_cbranch_scc1 VSLOW_79_l
    s_branch VRET_80
VSLOW_81:
    s_mov_b32 s92, 30000
VSLOW_81_l:
    buffer_load_dwordx4 v[32:35], v22, s[20:23], s34 offen sc1
    buffer_load_dwordx4 v[36:39], v22, s[20:23], s58 offen sc1
    s_waitcnt vmcnt(0)
    v_max3_u32 v13, v32, v33, v34
    v_max3_u32 v14, v36, v37, v38
    v_max3_u32 v13, v13, v35, v39
    v_max_u32 v13, v13, v14
    v_cmp_eq_u32 vcc, -1, v13
    s_cbranch_vccz VRET_82
    s_sub_u32 s92, s92, 1
    s_cmp_lg_u32 s92, 0
    s_cbranch_scc1 VSLOW_81_l
    s_branch VRET_82
VSLOW_83:
    s_mov_b32 s92, 30000
VSLOW_83_l:
    buffer_load_dwordx4 v[40:43], v22, s[20:23], s35 offen sc1
    buffer_load_dwordx4 v[44:47], v22, s[20:23], s59 offen sc1
    s_waitcnt vmcnt(0)
    v_max3_u32 v13, v40, v41, v42
    v_max3_u32 v14, v44, v45, v46
    v_max3_u32 v13, v13, v43, v47
    v_max_u32 v13, v13, v14
    v_cmp_eq_u32 vcc, -1, v13
    s_cbranch_vccz VRET_84
    s_sub_u32 s92, s92, 1
    s_cmp_lg_u32 s92, 0
    s_cbranch_scc1 VSLOW_83_l
    s_branch VRET_84
VSLOW_85:
    s_mov_b32 s92, 30000
VSLOW_85_l:
    buffer_load_dwordx4 v[48:51], v22, s[20:23], s32 offen offset:1024 sc1
    buffer_load_dwordx4 v[52:55], v22, s[20:23], s56 offen offset:1024 sc1
    s_waitcnt vmcnt(0)
    v_max3_u32 v13, v48, v49, v50
    v_max3_u32 v14, v52, v53, v54
    v_max3_u32 v13, v13, v51, v55
    v_max_u32 v13, v13, v14
    v_cmp_eq_u32 vcc, -1, v13
    s_cbranch_vccz VRET_86
    s_sub_u32 s92, s92, 1
    s_cmp_lg_u32 s92, 0
    s_cbranch_scc1 VSLOW_85_l
    s_branch VRET_86
VSLOW_87:
    s_mov_b32 s92, 30000
VSLOW_87_l:
    buffer_load_dwordx4 v[56:59], v22, s[20:23], s33 offen offset:1024 sc1
    buffer_load_dwordx4 v[60:63], v22, s[20:23], s57 offen offset:1024 sc1
    s_waitcnt vmcnt(0)
    v_max3_u32 v13, v56, v57, v58
    v_max3_u32 v14, v60, v61, v62
    v_max3_u32 v13, v13, v59, v63
    v_max_u32 v13, v13, v14
    v_cmp_eq_u32 vcc, -1, v13
    s_cbranch_vccz VRET_88
    s_sub_u32 s92, s92, 1
    s_cmp_lg_u32 s92, 0
    s_cbranch_scc1 VSLOW_87_l
    s_branch VRET_88
VSLOW_89:
    s_mov_b32 s92, 30000
VSLOW_89_l:
    buffer_load_dwordx4 v[64:67], v22, s[20:23], s34 offen offset:1024 sc1
    buffer_load_dwordx4 v[68:71], v22, s[20:23], s58 offen offset:1024 sc1
    s_waitcnt vmcnt(0)
    v_max3_u32 v13, v64, v65, v66
    v_max3_u32 v14, v68, v69, v70
    v_max3_u32 v13, v13, v67, v71
    v_max_u32 v13, v13, v14
    v_cmp_eq_u32 vcc, -1, v13
    s_cbranch_vccz VRET_90
    s_sub_u32 s92, s92, 1
    s_cmp_lg_u32 s92, 0
    s_cbranch_scc1 VSLOW_89_l
    s_branch VRET_90
VSLOW_91:
    s_mov_b32 s92, 30000
VSLOW_91_l:
    buffer_load_dwordx4 v[72:75], v22, s[20:23], s35 offen offset:1024 sc1
    buffer_load_dwordx4 v[76:79], v22, s[20:23], s59 offen offset:1024 sc1
    s_waitcnt vmcnt(0)
    v_max3_u32 v13, v72, v73, v74
    v_max3_u32 v14, v76, v77, v78
    v_max3_u32 v13, v13, v75, v79
    v_max_u32 v13, v13, v14
    v_cmp_eq_u32 vcc, -1, v13
    s_cbranch_vccz VRET_92
    s_sub_u32 s92, s92, 1
    s_cmp_lg_u32 s92, 0
    s_cbranch_scc1 VSLOW_91_l
    s_branch VRET_92
VSLOW_93:
    s_mov_b32 s92, 30000
VSLOW_93_l:
    buffer_load_dwordx4 v[80:83], v22, s[20:23], s32 offen offset:2048 sc1
    buffer_load_dwordx4 v[84:87], v22, s[20:23], s56 offen offset:2048 sc1
    s_waitcnt vmcnt(0)
    v_max3_u32 v13, v80, v81, v82
    v_max3_u32 v14, v84, v85, v86
    v_max3_u32 v13, v13, v83, v87
    v_max_u32 v13, v13, v14
    v_cmp_eq_u32 vcc, -1, v13
    s_cbranch_vccz VRET_94
    s_sub_u32 s92, s92, 1
    s_cmp_lg_u32 s92, 0
    s_cbranch_scc1 VSLOW_93_l
    s_branch VRET_94
VSLOW_95:
    s_mov_b32 s92, 30000
VSLOW_95_l:
    buffer_load_dwordx4 v[88:91], v22, s[20:23], s33 offen offset:2048 sc1
    buffer_load_dwordx4 v[92:95], v22, s[20:23], s57 offen offset:2048 sc1
    s_waitcnt vmcnt(0)
    v_max3_u32 v13, v88, v89, v90
    v_max3_u32 v14, v92, v93, v94
    v_max3_u32 v13, v13, v91, v95
    v_max_u32 v13, v13, v14
    v_cmp_eq_u32 vcc, -1, v13
    s_cbranch_vccz VRET_96
    s_sub_u32 s92, s92, 1
    s_cmp_lg_u32 s92, 0
    s_cbranch_scc1 VSLOW_95_l
    s_branch VRET_96
VSLOW_97:
    s_mov_b32 s92, 30000
VSLOW_97_l:
    buffer_load_dwordx4 v[96:99], v22, s[20:23], s34 offen offset:2048 sc1
    buffer_load_dwordx4 v[100:103], v22, s[20:23], s58 offen offset:2048 sc1
    s_waitcnt vmcnt(0)
    v_max3_u32 v13, v96, v97, v98
    v_max3_u32 v14, v100, v101, v102
    v_max3_u32 v13, v13, v99, v103
    v_max_u32 v13, v13, v14
    v_cmp_eq_u32 vcc, -1, v13
    s_cbranch_vccz VRET_98
    s_sub_u32 s92, s92, 1
    s_cmp_lg_u32 s92, 0
    s_cbranch_scc1 VSLOW_97_l
    s_branch VRET_98
VSLOW_99:
    s_mov_b32 s92, 30000
VSLOW_99_l:
    buffer_load_dwordx4 v[104:107], v22, s[20:23], s35 offen offset:2048 sc1
    buffer_load_dwordx4 v[108:111], v22, s[20:23], s59 offen offset:2048 sc1
    s_waitcnt vmcnt(0)
    v_max3_u32 v13, v104, v105, v106
    v_max3_u32 v14, v108, v109, v110
    v_max3_u32 v13, v13, v107, v111
    v_max_u32 v13, v13, v14
    v_cmp_eq_u32 vcc, -1, v13
    s_cbranch_vccz VRET_100
    s_sub_u32 s92, s92, 1
    s_cmp_lg_u32 s92, 0
    s_cbranch_scc1 VSLOW_99_l
    s_branch VRET_100
VSLOW_115:
    s_mov_b32 s92, 30000
VSLOW_115_l:
    buffer_load_dwordx4 v[32:35], v4, s[20:23], s32 offen sc1
    buffer_load_dwordx4 v[36:39], v4, s[20:23], s56 offen sc1
    s_waitcnt vmcnt(0)
    v_max3_u32 v13, v32, v33, v34
    v_max3_u32 v14, v36, v37, v38
    v_max3_u32 v13, v13, v35, v39
    v_max_u32 v13, v13, v14
    v_cmp_eq_u32 vcc, -1, v13
    s_cbranch_vccz VRET_116
    s_sub_u32 s92, s92, 1
    s_cmp_lg_u32 s92, 0
    s_cbranch_scc1 VSLOW_115_l
    s_branch VRET_116
VSLOW_117:
    s_mov_b32 s92, 30000
VSLOW_117_l:
    buffer_load_dwordx4 v[40:43], v4, s[20:23], s33 offen sc1
    buffer_load_dwordx4 v[44:47], v4, s[20:23], s57 offen sc1
    s_waitcnt vmcnt(0)
    v_max3_u32 v13, v40, v41, v42
    v_max3_u32 v14, v44, v45, v46
    v_max3_u32 v13, v13, v43, v47
    v_max_u32 v13, v13, v14
    v_cmp_eq_u32 vcc, -1, v13
    s_cbranch_vccz VRET_118
    s_sub_u32 s92, s92, 1
    s_cmp_lg_u32 s92, 0
    s_cbranch_scc1 VSLOW_117_l
    s_branch VRET_118
VSLOW_119:
    s_mov_b32 s92, 30000
VSLOW_119_l:
    buffer_load_dwordx4 v[48:51], v4, s[20:23], s34 offen sc1
    buffer_load_dwordx4 v[52:55], v4, s[20:23], s58 offen sc1
    s_waitcnt vmcnt(0)
    v_max3_u32 v13, v48, v49, v50
    v_max3_u32 v14, v52, v53, v54
    v_max3_u32 v13, v13, v51, v55
    v_max_u32 v13, v13, v14
    v_cmp_eq_u32 vcc, -1, v13
    s_cbranch_vccz VRET_120
    s_sub_u32 s92, s92, 1
    s_cmp_lg_u32 s92, 0
    s_cbranch_scc1 VSLOW_119_l
    s_branch VRET_120
VSLOW_121:
    s_mov_b32 s92, 30000
VSLOW_121_l:
    buffer_load_dwordx4 v[56:59], v4, s[20:23], s35 offen sc1
    buffer_load_dwordx4 v[60:63], v4, s[20:23], s59 offen sc1
    s_waitcnt vmcnt(0)
    v_max3_u32 v13, v56, v57, v58
    v_max3_u32 v14, v60, v61, v62
    v_max3_u32 v13, v13, v59, v63
    v_max_u32 v13, v13, v14
    v_cmp_eq_u32 vcc, -1, v13
    s_cbranch_vccz VRET_122
    s_sub_u32 s92, s92, 1
    s_cmp_lg_u32 s92, 0
    s_cbranch_scc1 VSLOW_121_l
    s_branch VRET_122
VSLOW_123:
    s_mov_b32 s92, 30000
VSLOW_123_l:
    buffer_load_dwordx4 v[64:67], v4, s[20:23], s32 offen offset:1024 sc1
    buffer_load_dwordx4 v[68:71], v4, s[20:23], s56 offen offset:1024 sc1
    s_waitcnt vmcnt(0)
    v_max3_u32 v13, v64, v65, v66
    v_max3_u32 v14, v68, v69, v70
    v_max3_u32 v13, v13, v67, v71
    v_max_u32 v13, v13, v14
    v_cmp_eq_u32 vcc, -1, v13
    s_cbranch_vccz VRET_124
    s_sub_u32 s92, s92, 1
    s_cmp_lg_u32 s92, 0
    s_cbranch_scc1 VSLOW_123_l
    s_branch VRET_124
VSLOW_125:
    s_mov_b32 s92, 30000
VSLOW_125_l:
    buffer_load_dwordx4 v[72:75], v4, s[20:23], s33 offen offset:1024 sc1
    buffer_load_dwordx4 v[76:79], v4, s[20:23], s57 offen offset:1024 sc1
    s_waitcnt vmcnt(0)
    v_max3_u32 v13, v72, v73, v74
    v_max3_u32 v14, v76, v77, v78
    v_max3_u32 v13, v13, v75, v79
    v_max_u32 v13, v13, v14
    v_cmp_eq_u32 vcc, -1, v13
    s_cbranch_vccz VRET_126
    s_sub_u32 s92, s92, 1
    s_cmp_lg_u32 s92, 0
    s_cbranch_scc1 VSLOW_125_l
    s_branch VRET_126
VSLOW_127:
    s_mov_b32 s92, 30000
VSLOW_127_l:
    buffer_load_dwordx4 v[80:83], v4, s[20:23], s34 offen offset:1024 sc1
    buffer_load_dwordx4 v[84:87], v4, s[20:23], s58 offen offset:1024 sc1
    s_waitcnt vmcnt(0)
    v_max3_u32 v13, v80, v81, v82
    v_max3_u32 v14, v84, v85, v86
    v_max3_u32 v13, v13, v83, v87
    v_max_u32 v13, v13, v14
    v_cmp_eq_u32 vcc, -1, v13
    s_cbranch_vccz VRET_128
    s_sub_u32 s92, s92, 1
    s_cmp_lg_u32 s92, 0
    s_cbranch_scc1 VSLOW_127_l
    s_branch VRET_128
VSLOW_129:
    s_mov_b32 s92, 30000
VSLOW_129_l:
    buffer_load_dwordx4 v[88:91], v4, s[20:23], s35 offen offset:1024 sc1
    buffer_load_dwordx4 v[92:95], v4, s[20:23], s59 offen offset:1024 sc1
    s_waitcnt vmcnt(0)
    v_max3_u32 v13, v88, v89, v90
    v_max3_u32 v14, v92, v93, v94
    v_max3_u32 v13, v13, v91, v95
    v_max_u32 v13, v13, v14
    v_cmp_eq_u32 vcc, -1, v13
    s_cbranch_vccz VRET_130
    s_sub_u32 s92, s92, 1
    s_cmp_lg_u32 s92, 0
    s_cbranch_scc1 VSLOW_129_l
    s_branch VRET_130
VSLOW_131:
    s_mov_b32 s92, 30000
VSLOW_131_l:
    buffer_load_dwordx4 v[96:99], v4, s[20:23], s32 offen offset:2048 sc1
    buffer_load_dwordx4 v[100:103], v4, s[20:23], s56 offen offset:2048 sc1
    s_waitcnt vmcnt(0)
    v_max3_u32 v13, v96, v97, v98
    v_max3_u32 v14, v100, v101, v102
    v_max3_u32 v13, v13, v99, v103
    v_max_u32 v13, v13, v14
    v_cmp_eq_u32 vcc, -1, v13
    s_cbranch_vccz VRET_132
    s_sub_u32 s92, s92, 1
    s_cmp_lg_u32 s92, 0
    s_cbranch_scc1 VSLOW_131_l
    s_branch VRET_132
VSLOW_133:
    s_mov_b32 s92, 30000
VSLOW_133_l:
    buffer_load_dwordx4 v[104:107], v4, s[20:23], s33 offen offset:2048 sc1
    buffer_load_dwordx4 v[108:111], v4, s[20:23], s57 offen offset:2048 sc1
    s_waitcnt vmcnt(0)
    v_max3_u32 v13, v104, v105, v106
    v_max3_u32 v14, v108, v109, v110
    v_max3_u32 v13, v13, v107, v111
    v_max_u32 v13, v13, v14
    v_cmp_eq_u32 vcc, -1, v13
    s_cbranch_vccz VRET_134
    s_sub_u32 s92, s92, 1
    s_cmp_lg_u32 s92, 0
    s_cbranch_scc1 VSLOW_133_l
    s_branch VRET_134
VSLOW_135:
    s_mov_b32 s92, 30000
VSLOW_135_l:
    buffer_load_dwordx4 v[112:115], v4, s[20:23], s34 offen offset:2048 sc1
    buffer_load_dwordx4 v[116:119], v4, s[20:23], s58 offen offset:2048 sc1
    s_waitcnt vmcnt(0)
    v_max3_u32 v13, v112, v113, v114
    v_max3_u32 v14, v116, v117, v118
    v_max3_u32 v13, v13, v115, v119
    v_max_u32 v13, v13, v14
    v_cmp_eq_u32 vcc, -1, v13
    s_cbranch_vccz VRET_136
    s_sub_u32 s92, s92, 1
    s_cmp_lg_u32 s92, 0
    s_cbranch_scc1 VSLOW_135_l
    s_branch VRET_136
VSLOW_137:
    s_mov_b32 s92, 30000
VSLOW_137_l:
    buffer_load_dwordx4 v[120:123], v4, s[20:23], s35 offen offset:2048 sc1
    buffer_load_dwordx4 v[124:127], v4, s[20:23], s59 offen offset:2048 sc1
    s_waitcnt vmcnt(0)
    v_max3_u32 v13, v120, v121, v122
    v_max3_u32 v14, v124, v125, v126
    v_max3_u32 v13, v13, v123, v127
    v_max_u32 v13, v13, v14
    v_cmp_eq_u32 vcc, -1, v13
    s_cbranch_vccz VRET_138
    s_sub_u32 s92, s92, 1
    s_cmp_lg_u32 s92, 0
    s_cbranch_scc1 VSLOW_137_l
    s_branch VRET_138
VSLOW_139:
    s_mov_b32 s92, 30000
VSLOW_139_l:
    buffer_load_dwordx4 v[128:131], v4, s[20:23], s32 offen offset:3072 sc1
    buffer_load_dwordx4 v[132:135], v4, s[20:23], s56 offen offset:3072 sc1
    s_waitcnt vmcnt(0)
    v_max3_u32 v13, v128, v129, v130
    v_max3_u32 v14, v132, v133, v134
    v_max3_u32 v13, v13, v131, v135
    v_max_u32 v13, v13, v14
    v_cmp_eq_u32 vcc, -1, v13
    s_cbranch_vccz VRET_140
    s_sub_u32 s92, s92, 1
    s_cmp_lg_u32 s92, 0
    s_cbranch_scc1 VSLOW_139_l
    s_branch VRET_140
VSLOW_141:
    s_mov_b32 s92, 30000
VSLOW_141_l:
    buffer_load_dwordx4 v[136:139], v4, s[20:23], s33 offen offset:3072 sc1
    buffer_load_dwordx4 v[140:143], v4, s[20:23], s57 offen offset:3072 sc1
    s_waitcnt vmcnt(0)
    v_max3_u32 v13, v136, v137, v138
    v_max3_u32 v14, v140, v141, v142
    v_max3_u32 v13, v13, v139, v143
    v_max_u32 v13, v13, v14
    v_cmp_eq_u32 vcc, -1, v13
    s_cbranch_vccz VRET_142
    s_sub_u32 s92, s92, 1
    s_cmp_lg_u32 s92, 0
    s_cbranch_scc1 VSLOW_141_l
    s_branch VRET_142
VSLOW_143:
    s_mov_b32 s92, 30000
VSLOW_143_l:
    buffer_load_dwordx4 v[144:147], v4, s[20:23], s34 offen offset:3072 sc1
    buffer_load_dwordx4 v[148:151], v4, s[20:23], s58 offen offset:3072 sc1
    s_waitcnt vmcnt(0)
    v_max3_u32 v13, v144, v145, v146
    v_max3_u32 v14, v148, v149, v150
    v_max3_u32 v13, v13, v147, v151
    v_max_u32 v13, v13, v14
    v_cmp_eq_u32 vcc, -1, v13
    s_cbranch_vccz VRET_144
    s_sub_u32 s92, s92, 1
    s_cmp_lg_u32 s92, 0
    s_cbranch_scc1 VSLOW_143_l
    s_branch VRET_144
VSLOW_145:
    s_mov_b32 s92, 30000
VSLOW_145_l:
    buffer_load_dwordx4 v[152:155], v4, s[20:23], s35 offen offset:3072 sc1
    buffer_load_dwordx4 v[156:159], v4, s[20:23], s59 offen offset:3072 sc1
    s_waitcnt vmcnt(0)
    v_max3_u32 v13, v152, v153, v154
    v_max3_u32 v14, v156, v157, v158
    v_max3_u32 v13, v13, v155, v159
    v_max_u32 v13, v13, v14
    v_cmp_eq_u32 vcc, -1, v13
    s_cbranch_vccz VRET_146
    s_sub_u32 s92, s92, 1
    s_cmp_lg_u32 s92, 0
    s_cbranch_scc1 VSLOW_145_l
    s_branch VRET_146
VSLOW_147:
    s_mov_b32 s92, 30000
VSLOW_147_l:
    buffer_load_dwordx4 v[160:163], v22, s[20:23], s32 offen sc1
    buffer_load_dwordx4 v[164:167], v22, s[20:23], s56 offen sc1
    s_waitcnt vmcnt(0)
    v_max3_u32 v13, v160, v161, v162
    v_max3_u32 v14, v164, v165, v166
    v_max3_u32 v13, v13, v163, v167
    v_max_u32 v13, v13, v14
    v_cmp_eq_u32 vcc, -1, v13
    s_cbranch_vccz VRET_148
    s_sub_u32 s92, s92, 1
    s_cmp_lg_u32 s92, 0
    s_cbranch_scc1 VSLOW_147_l
    s_branch VRET_148
VSLOW_149:
    s_mov_b32 s92, 30000
VSLOW_149_l:
    buffer_load_dwordx4 v[168:171], v22, s[20:23], s33 offen sc1
    buffer_load_dwordx4 v[172:175], v22, s[20:23], s57 offen sc1
    s_waitcnt vmcnt(0)
    v_max3_u32 v13, v168, v169, v170
    v_max3_u32 v14, v172, v173, v174
    v_max3_u32 v13, v13, v171, v175
    v_max_u32 v13, v13, v14
    v_cmp_eq_u32 vcc, -1, v13
    s_cbranch_vccz VRET_150
    s_sub_u32 s92, s92, 1
    s_cmp_lg_u32 s92, 0
    s_cbranch_scc1 VSLOW_149_l
    s_branch VRET_150
VSLOW_151:
    s_mov_b32 s92, 30000
VSLOW_151_l:
    buffer_load_dwordx4 v[32:35], v22, s[20:23], s34 offen sc1
    buffer_load_dwordx4 v[36:39], v22, s[20:23], s58 offen sc1
    s_waitcnt vmcnt(0)
    v_max3_u32 v13, v32, v33, v34
    v_max3_u32 v14, v36, v37, v38
    v_max3_u32 v13, v13, v35, v39
    v_max_u32 v13, v13, v14
    v_cmp_eq_u32 vcc, -1, v13
    s_cbranch_vccz VRET_152
    s_sub_u32 s92, s92, 1
    s_cmp_lg_u32 s92, 0
    s_cbranch_scc1 VSLOW_151_l
    s_branch VRET_152
VSLOW_153:
    s_mov_b32 s92, 30000
VSLOW_153_l:
    buffer_load_dwordx4 v[40:43], v22, s[20:23], s35 offen sc1
    buffer_load_dwordx4 v[44:47], v22, s[20:23], s59 offen sc1
    s_waitcnt vmcnt(0)
    v_max3_u32 v13, v40, v41, v42
    v_max3_u32 v14, v44, v45, v46
    v_max3_u32 v13, v13, v43, v47
    v_max_u32 v13, v13, v14
    v_cmp_eq_u32 vcc, -1, v13
    s_cbranch_vccz VRET_154
    s_sub_u32 s92, s92, 1
    s_cmp_lg_u32 s92, 0
    s_cbranch_scc1 VSLOW_153_l
    s_branch VRET_154
VSLOW_155:
    s_mov_b32 s92, 30000
VSLOW_155_l:
    buffer_load_dwordx4 v[48:51], v22, s[20:23], s32 offen offset:1024 sc1
    buffer_load_dwordx4 v[52:55], v22, s[20:23], s56 offen offset:1024 sc1
    s_waitcnt vmcnt(0)
    v_max3_u32 v13, v48, v49, v50
    v_max3_u32 v14, v52, v53, v54
    v_max3_u32 v13, v13, v51, v55
    v_max_u32 v13, v13, v14
    v_cmp_eq_u32 vcc, -1, v13
    s_cbranch_vccz VRET_156
    s_sub_u32 s92, s92, 1
    s_cmp_lg_u32 s92, 0
    s_cbranch_scc1 VSLOW_155_l
    s_branch VRET_156
VSLOW_157:
    s_mov_b32 s92, 30000
VSLOW_157_l:
    buffer_load_dwordx4 v[56:59], v22, s[20:23], s33 offen offset:1024 sc1
    buffer_load_dwordx4 v[60:63], v22, s[20:23], s57 offen offset:1024 sc1
    s_waitcnt vmcnt(0)
    v_max3_u32 v13, v56, v57, v58
    v_max3_u32 v14, v60, v61, v62
    v_max3_u32 v13, v13, v59, v63
    v_max_u32 v13, v13, v14
    v_cmp_eq_u32 vcc, -1, v13
    s_cbranch_vccz VRET_158
    s_sub_u32 s92, s92, 1
    s_cmp_lg_u32 s92, 0
    s_cbranch_scc1 VSLOW_157_l
    s_branch VRET_158
VSLOW_159:
    s_mov_b32 s92, 30000
VSLOW_159_l:
    buffer_load_dwordx4 v[64:67], v22, s[20:23], s34 offen offset:1024 sc1
    buffer_load_dwordx4 v[68:71], v22, s[20:23], s58 offen offset:1024 sc1
    s_waitcnt vmcnt(0)
    v_max3_u32 v13, v64, v65, v66
    v_max3_u32 v14, v68, v69, v70
    v_max3_u32 v13, v13, v67, v71
    v_max_u32 v13, v13, v14
    v_cmp_eq_u32 vcc, -1, v13
    s_cbranch_vccz VRET_160
    s_sub_u32 s92, s92, 1
    s_cmp_lg_u32 s92, 0
    s_cbranch_scc1 VSLOW_159_l
    s_branch VRET_160
VSLOW_161:
    s_mov_b32 s92, 30000
VSLOW_161_l:
    buffer_load_dwordx4 v[72:75], v22, s[20:23], s35 offen offset:1024 sc1
    buffer_load_dwordx4 v[76:79], v22, s[20:23], s59 offen offset:1024 sc1
    s_waitcnt vmcnt(0)
    v_max3_u32 v13, v72, v73, v74
    v_max3_u32 v14, v76, v77, v78
    v_max3_u32 v13, v13, v75, v79
    v_max_u32 v13, v13, v14
    v_cmp_eq_u32 vcc, -1, v13
    s_cbranch_vccz VRET_162
    s_sub_u32 s92, s92, 1
    s_cmp_lg_u32 s92, 0
    s_cbranch_scc1 VSLOW_161_l
    s_branch VRET_162
VSLOW_163:
    s_mov_b32 s92, 30000
VSLOW_163_l:
    buffer_load_dwordx4 v[80:83], v22, s[20:23], s32 offen offset:2048 sc1
    buffer_load_dwordx4 v[84:87], v22, s[20:23], s56 offen offset:2048 sc1
    s_waitcnt vmcnt(0)
    v_max3_u32 v13, v80, v81, v82
    v_max3_u32 v14, v84, v85, v86
    v_max3_u32 v13, v13, v83, v87
    v_max_u32 v13, v13, v14
    v_cmp_eq_u32 vcc, -1, v13
    s_cbranch_vccz VRET_164
    s_sub_u32 s92, s92, 1
    s_cmp_lg_u32 s92, 0
    s_cbranch_scc1 VSLOW_163_l
    s_branch VRET_164
VSLOW_165:
    s_mov_b32 s92, 30000
VSLOW_165_l:
    buffer_load_dwordx4 v[88:91], v22, s[20:23], s33 offen offset:2048 sc1
    buffer_load_dwordx4 v[92:95], v22, s[20:23], s57 offen offset:2048 sc1
    s_waitcnt vmcnt(0)
    v_max3_u32 v13, v88, v89, v90
    v_max3_u32 v14, v92, v93, v94
    v_max3_u32 v13, v13, v91, v95
    v_max_u32 v13, v13, v14
    v_cmp_eq_u32 vcc, -1, v13
    s_cbranch_vccz VRET_166
    s_sub_u32 s92, s92, 1
    s_cmp_lg_u32 s92, 0
    s_cbranch_scc1 VSLOW_165_l
    s_branch VRET_166
VSLOW_167:
    s_mov_b32 s92, 30000
VSLOW_167_l:
    buffer_load_dwordx4 v[96:99], v22, s[20:23], s34 offen offset:2048 sc1
    buffer_load_dwordx4 v[100:103], v22, s[20:23], s58 offen offset:2048 sc1
    s_waitcnt vmcnt(0)
    v_max3_u32 v13, v96, v97, v98
    v_max3_u32 v14, v100, v101, v102
    v_max3_u32 v13, v13, v99, v103
    v_max_u32 v13, v13, v14
    v_cmp_eq_u32 vcc, -1, v13
    s_cbranch_vccz VRET_168
    s_sub_u32 s92, s92, 1
    s_cmp_lg_u32 s92, 0
    s_cbranch_scc1 VSLOW_167_l
    s_branch VRET_168
VSLOW_169:
    s_mov_b32 s92, 30000
VSLOW_169_l:
    buffer_load_dwordx4 v[104:107], v22, s[20:23], s35 offen offset:2048 sc1
    buffer_load_dwordx4 v[108:111], v22, s[20:23], s59 offen offset:2048 sc1
    s_waitcnt vmcnt(0)
    v_max3_u32 v13, v104, v105, v106
    v_max3_u32 v14, v108, v109, v110
    v_max3_u32 v13, v13, v107, v111
    v_max_u32 v13, v13, v14
    v_cmp_eq_u32 vcc, -1, v13
    s_cbranch_vccz VRET_170
    s_sub_u32 s92, s92, 1
    s_cmp_lg_u32 s92, 0
    s_cbranch_scc1 VSLOW_169_l
    s_branch VRET_170
.section .rodata,"a"
.p2align 6
.amdhsa_kernel interleave_layers__ssm_conv_s4d__glu_gated_glu__prompt_kernel
  .amdhsa_next_free_vgpr 512
  .amdhsa_next_free_sgpr 102
  .amdhsa_accum_offset 256
  .amdhsa_group_segment_fixed_size 0
  .amdhsa_kernarg_size 112
  .amdhsa_user_sgpr_count 2
  .amdhsa_user_sgpr_kernarg_segment_ptr 1
  .amdhsa_system_sgpr_workgroup_id_x 1
.end_amdhsa_kernel
```
